```python
import torch

def _softmax(x, axis=-1):
    return torch.softmax(x, dim=axis)
def _gelu(x):
    return torch.nn.functional.gelu(x, approximate="tanh")
def _silu(x):
    return torch.nn.functional.silu(x)
def _sigmoid(x):
    return torch.sigmoid(x)
def _layernorm(x, axis=-1, eps=1e-5):
    m = x.mean(dim=axis, keepdim=True)
    v = x.var(dim=axis, keepdim=True, unbiased=False)
    return (x - m) / torch.sqrt(v + eps)
def _scatter_add(tgt, idx, src, axis=0):
    return tgt.clone().index_add_(axis, idx, src)
def _segment_sum(src, seg, n):
    out = torch.zeros((n,) + src.shape[1:], dtype=src.dtype)
    return out.index_add_(0, seg, src)
def _pad(x, pw):
    flat = tuple(v for pair in reversed(pw) for v in pair)
    return torch.nn.functional.pad(x, flat)

kernel_name = 'gated_mix__linear_attn_block__dense_activation_gelu__prompt'

def setup_inputs():

    _w = (lambda a: (lambda t: t.to(torch.bfloat16) if t.is_floating_point() else t)(torch.as_tensor(a)))
    def _A_setup():
        B, S, D = 1, 2048, 512
        return {
            "x": _w((lambda *s: torch.randn(*s, dtype=torch.bfloat16) * 0.05)(B, S, D)),
            "wqkv": _w((lambda *s: torch.randn(*s, dtype=torch.bfloat16) * 0.8)(D, 3 * D)),
            "wo": _w((lambda *s: torch.randn(*s, dtype=torch.bfloat16) * 0.05)(D, D)),
        }
    _A_in = _A_setup()

    def _B_setup():
        B, S, D, F = 1, 2048, 512, 1376
        return {
            "x": _w((lambda *s: torch.randn(*s, dtype=torch.bfloat16) * 0.05)(B, S, D)),
            "w1": _w((lambda *s: torch.randn(*s, dtype=torch.bfloat16) * 3.2)(D, F) * (D ** -0.5)),
            "b1": _w((lambda *s: torch.randn(*s, dtype=torch.bfloat16) * 3.2)(F) * 0.01),
            "w2": _w((lambda *s: torch.randn(*s, dtype=torch.bfloat16) * 0.4)(F, D) * (F ** -0.5)),
            "b2": _w((lambda *s: torch.randn(*s, dtype=torch.bfloat16) * 0.8)(D) * 0.01),
        }
    _B_in = _B_setup()

    return {
        "A_x": _A_in["x"],
        "A_wqkv": _A_in["wqkv"],
        "A_wo": _A_in["wo"],
        "B_x": _B_in["x"],
        "B_w1": _B_in["w1"],
        "B_b1": _B_in["b1"],
        "B_w2": _B_in["w2"],
        "B_b2": _B_in["b2"],
        "gate_w": _w((lambda *s: torch.randn(*s, dtype=torch.bfloat16) * 0.05)(512) * 16.0),
    }

def reference(A_x, A_wqkv, A_wo, B_x, B_w1, B_b1, B_w2, B_b2, gate_w):
    def _A_ref(x, wqkv, wo):
        B, S, D = x.shape
        H = 32; Dh = D // H
        qkv = (lambda x, *d: x.permute(*d))((x @ wqkv).reshape(B, S, 3, H, Dh), 2, 0, 3, 1, 4)
        q, k, v = qkv[0], qkv[1], qkv[2]
        phi = lambda t: torch.where(t > 0, t + 1, torch.exp(t)) + 1e-6
        pq, pk = phi(q), phi(k)
        kv = torch.einsum("bhsd,bhse->bhde", pk, v)
        z = torch.einsum("bhsd->bhd", pk)
        num = torch.einsum("bhqd,bhde->bhqe", pq, kv)
        den = torch.einsum("bhqd,bhd->bhq", pq, z)[..., None] + 1e-6
        o = num / den
        return (lambda x, *d: x.permute(*d))(o, 0, 2, 1, 3).reshape(B, S, D) @ wo

    def _B_ref(x, w1, b1, w2, b2):
        h = torch.einsum("bsd,df->bsf", x, w1) + b1
        h = _gelu(h)
        return torch.einsum("bsf,fd->bsd", h, w2) + b2

    x = A_x
    g = _sigmoid((x * gate_w).sum(-1, keepdims=True))
    a = _A_ref(x, A_wqkv, A_wo)
    b = _B_ref(x, B_w1, B_b1, B_w2, B_b2)
    return g * a + (1 - g) * b
```

```asm
; @launch grid=(256,1,1) block=(512,1,1) lds=163840
.amdgcn_target "amdgcn-amd-amdhsa--gfx950"
.text
.globl gated_mix__linear_attn_block__dense_activation_gelu__prompt_kernel
.p2align 12
.type gated_mix__linear_attn_block__dense_activation_gelu__prompt_kernel,@function
gated_mix__linear_attn_block__dense_activation_gelu__prompt_kernel:
    s_cmp_ge_u32 s2, 256
    s_cbranch_scc1 L_end
    s_load_dwordx2 s[4:5], s[0:1], 0
    s_load_dwordx2 s[8:9], s[0:1], 8
    s_load_dwordx2 s[20:21], s[0:1], 32
    s_load_dwordx2 s[36:37], s[0:1], 88
    v_lshrrev_b32 v1, 6, v0
    s_and_b32 s92, s2, 7
    v_readfirstlane_b32 s64, v1
    s_lshr_b32 s93, s2, 3
    v_and_b32 v1, 63, v0
    s_and_b32 s66, s92, 1
    s_lshl_b32 s66, s66, 3
    s_and_b32 s76, s93, 7
    s_add_u32 s66, s66, s76
    s_and_b32 s67, s92, 6
    s_bfe_u32 s76, s93, 0x10003
    s_add_u32 s67, s67, s76
    s_lshr_b32 s76, s93, 1
    s_and_b32 s76, s76, 8
    s_add_u32 s67, s67, s76
    s_xor_b32 s67, s67, 8
    s_cmp_lt_u32 s67, 8
    s_cselect_b32 s76, 2, 0
    s_xor_b32 s67, s67, s76
    s_and_b32 s68, s67, 7
    s_cmp_lt_u32 s64, 4
    s_cbranch_scc1 L_rolea
    s_cmp_lt_u32 s67, 8
    s_cbranch_scc1 L_pathAb
    s_cmp_lt_u32 s67, 11
    s_cbranch_scc1 L_pathFb
    s_branch L_pathGb
L_rolea:
    s_cmp_lt_u32 s67, 8
    s_cbranch_scc1 L_pathAa
L_pathFa:
    s_load_dwordx2 s[12:13], s[0:1], 40
    s_load_dwordx2 s[24:25], s[0:1], 80
    s_load_dwordx2 s[28:29], s[0:1], 48
    s_load_dwordx2 s[40:41], s[0:1], 16
    s_load_dwordx2 s[32:33], s[0:1], 72
    s_load_dwordx2 s[16:17], s[0:1], 56
    v_lshrrev_b32 v20, 3, v1
    v_and_b32 v21, 7, v1
    v_lshrrev_b32 v22, 4, v1
    v_xor_b32 v23, v21, v22
    v_lshlrev_b32 v23, 4, v23
    v_lshl_add_u32 v23, v20, 10, v23
    s_lshl_b32 s76, s66, 3
    s_add_u32 s76, s76, s64
    s_lshl_b32 s77, s76, 14
    v_add_u32 v96, s77, v23
    v_xor_b32 v97, 64, v96
    v_add_u32 v97, 7168, v97
    v_and_b32 v22, 1, v22
    v_lshlrev_b32 v22, 2, v22
    v_xor_b32 v21, v21, v22
    v_lshlrev_b32 v21, 4, v21
    s_and_b32 s62, s92, 7
    s_and_b32 s75, s93, 6
    s_xor_b32 s62, s62, s75
    s_lshl_b32 s62, s62, 7
    s_mul_i32 s75, s62, 1376
    s_lshl_b32 s72, s64, 11
    s_lshl_b32 s71, s64, 10
    s_add_u32 s73, s71, 65536
    s_mov_b32 m0, s72
    s_mov_b32 s6, 0x200000
    s_mov_b32 s7, 0x20000
    s_mov_b32 s22, 0x158000
    s_mov_b32 s23, 0x20000
    s_mul_i32 s3, s68, 5
    s_min_u32 s77, s68, 3
    s_add_u32 s3, s3, s77
    s_lshl_b32 s3, s3, 6
    s_mul_i32 s77, s64, 22016
    s_add_u32 s77, s77, s3
    v_mul_u32_u24 v98, 2752, v20
    v_lshl_add_u32 v4, v20, 10, v21
    s_and_b32 s76, s64, 1
    s_lshl_b32 s76, s76, 5
    v_xor_b32 v21, s76, v21
    s_cmp_lt_u32 s68, 3
    s_cselect_b32 s76, 0x70, 0x30
    v_and_b32 v22, s76, v21
    v_add3_u32 v99, v98, v22, s77
    v_add3_u32 v98, v98, v21, s77
    v_lshrrev_b32 v23, 4, v1
    v_lshlrev_b32 v15, 3, v23
    s_mov_b32 s14, 0xac0
    s_mov_b32 s15, 0x20000
    s_waitcnt lgkmcnt(0)
    buffer_load_dwordx4 v96, s[4:7], s62 offen offset:0 lds
    buffer_load_dwordx4 v97, s[4:7], s62 offen offset:1024 lds
    s_add_u32 m0, s73, 0
    s_nop 0
    buffer_load_dwordx4 v98, s[20:23], s75 offen offset:0 lds
    s_add_u32 m0, s73, 8064
    s_nop 0
    buffer_load_dwordx4 v98, s[20:23], s75 offen offset:128 lds
    s_add_u32 m0, s73, 16128
    s_nop 0
    buffer_load_dwordx4 v99, s[20:23], s75 offen offset:256 lds
    s_or_b32 s77, s2, s64
    s_cbranch_scc1 Lnopub_1
    s_mov_b32 s77, 0x900000
    s_load_dword s94, s[36:37], s77
Lnopub_1:
    s_lshl_b32 s76, s2, 3
    s_add_u32 s76, s76, s64
    s_lshl_b32 s77, s76, 10
    s_add_u32 s77, s77, 0x800000
    s_lshl_b32 s76, s76, 7
    s_add_u32 s76, s76, 0x77a000
    s_cmp_lt_u32 s2, 64
    s_cselect_b32 s76, s77, s76
    s_cmp_lt_u32 s2, 80
    s_cbranch_scc0 Lnop_2
    s_load_dword s95, s[36:37], s76 glc
Lnop_2:
    s_mov_b32 s63, 1
    s_and_b32 s76, s93, 3
    s_lshl_b32 s76, s76, 2
    s_add_u32 s76, s76, s64
    s_cmp_eq_u32 s76, 0
    s_cbranch_scc1 LIFa_0
    s_cmp_eq_u32 s76, 1
    s_cbranch_scc1 LIFa_1
    s_cmp_eq_u32 s76, 2
    s_cbranch_scc1 LIFa_2
    s_cmp_eq_u32 s76, 3
    s_cbranch_scc1 LIFa_3
    s_cmp_eq_u32 s76, 4
    s_cbranch_scc1 LIFa_4
    s_cmp_eq_u32 s76, 5
    s_cbranch_scc1 LIFa_5
    s_cmp_eq_u32 s76, 6
    s_cbranch_scc1 LIFa_6
    s_cmp_eq_u32 s76, 7
    s_cbranch_scc1 LIFa_7
    s_cmp_eq_u32 s76, 8
    s_cbranch_scc1 LIFa_8
    s_cmp_eq_u32 s76, 9
    s_cbranch_scc1 LIFa_9
    s_cmp_eq_u32 s76, 10
    s_cbranch_scc1 LIFa_10
    s_cmp_eq_u32 s76, 11
    s_cbranch_scc1 LIFa_11
    s_cmp_eq_u32 s76, 12
    s_cbranch_scc1 LIFa_12
LIFa_11:
LIFa_12:
LIFa_ret:
    s_mov_b32 s63, 0
    s_barrier
    buffer_load_dwordx2 v[150:151], v15, s[12:15], s3 offen offset:0
    buffer_load_dwordx2 v[154:155], v15, s[12:15], s3 offen offset:32
    buffer_load_dwordx2 v[158:159], v15, s[12:15], s3 offen offset:128
    buffer_load_dwordx2 v[162:163], v15, s[12:15], s3 offen offset:160
    buffer_load_dwordx2 v[166:167], v15, s[12:15], s3 offen offset:256
    buffer_load_dwordx2 v[170:171], v15, s[12:15], s3 offen offset:288
    s_add_u32 m0, s72, 16384
    s_xor_b32 s74, s62, 128
    buffer_load_dwordx4 v96, s[4:7], s74 offen offset:0 lds
    buffer_load_dwordx4 v97, s[4:7], s74 offen offset:1024 lds
    s_add_u32 m0, s73, 24576
    s_xor_b32 s75, s62, 128
    s_mul_i32 s75, s75, 1376
    buffer_load_dwordx4 v98, s[20:23], s75 offen offset:0 lds
    s_add_u32 m0, s73, 32640
    s_nop 0
    buffer_load_dwordx4 v98, s[20:23], s75 offen offset:128 lds
    s_add_u32 m0, s73, 40704
    s_nop 0
    buffer_load_dwordx4 v99, s[20:23], s75 offen offset:256 lds
    s_and_b32 s65, s64, 3
    v_and_b32 v20, 15, v1
    v_lshrrev_b32 v21, 4, v1
    v_bfe_u32 v22, v1, 1, 3
    v_xor_b32 v22, v22, v21
    v_lshlrev_b32 v22, 4, v22
    v_lshl_add_u32 v22, v20, 7, v22
    s_lshl_b32 s76, s65, 12
    v_add_u32 v180, s76, v22
    v_xor_b32 v181, 64, v180
    v_bfe_u32 v20, v1, 2, 2
    v_and_b32 v22, 3, v1
    v_lshlrev_b32 v22, 3, v22
    v_bfe_u32 v23, v1, 4, 1
    v_lshl_add_u32 v22, v23, 5, v22
    v_bfe_u32 v23, v1, 3, 1
    v_lshl_add_u32 v22, v23, 6, v22
    v_lshl_add_u32 v22, v20, 7, v22
    v_lshl_add_u32 v23, v21, 10, v22
    v_xor_b32 v182, 0x10000, v23
    v_add_u32 v183, 49152, v182
    v_xor_b32 v184, 32, v182
    v_xor_b32 v185, 32, v183
    v_lshrrev_b32 v21, 5, v1
    v_lshl_add_u32 v5, v21, 9, v22
    v_lshlrev_b32 v2, 4, v1
    v_mov_b32 v33, 0
    s_mov_b32 s38, 0x900080
    s_mov_b32 s39, 0x20000
    s_mov_b32 s26, 0x100
    s_mov_b32 s27, 0x20000
    s_lshl_b32 s80, s66, 2
    s_add_u32 s80, s80, s65
    s_lshl_b32 s79, s80, 11
    v_and_b32 v20, 15, v1
    v_lshrrev_b32 v22, 4, v1
    v_lshlrev_b32 v22, 9, v22
    v_lshl_add_u32 v22, v20, 4, v22
    v_add_u32 v28, s79, v22
    s_lshl_b32 s86, s3, 11
    s_add_u32 s86, s86, 2097152
    s_lshl_b32 s69, s92, 2
LIFa_0:
    s_cmp_eq_u32 s63, 1
    s_cbranch_scc1 LIFa_ret
    s_and_b32 s79, s93, 3
    s_add_u32 s69, s69, s79
    s_lshr_b32 s70, s93, 2
    s_lshl_b32 s79, s70, 7
    v_add_u32 v4, s79, v4
    s_mov_b32 s30, 0x158000
    s_mov_b32 s31, 0x20000
    s_mov_b32 s42, 0x80000
    s_mov_b32 s43, 0x20000
    s_or_b32 s77, s2, s64
    s_cbranch_scc1 Lnopub_3
    s_waitcnt lgkmcnt(0)
    s_or_b32 s94, s94, 1
    s_add_u32 s94, s94, 2
    v_mov_b32 v18, s94
    s_mov_b32 s77, 0x900000
    buffer_store_dword v18, v33, s[24:27], 0 offen sc1
    buffer_store_dword v18, v33, s[36:39], s77 offen sc1
Lnopub_3:
    s_waitcnt lgkmcnt(0)
    s_waitcnt vmcnt(11)
    s_barrier
    ds_read_b128 v[72:75], v180 offset:0
    ds_read_b64_tr_b16 v[36:37], v182 offset:0
    ds_read_b64_tr_b16 v[38:39], v182 offset:512
    ds_read_b64_tr_b16 v[40:41], v182 offset:8192
    ds_read_b64_tr_b16 v[42:43], v182 offset:8704
    ds_read_b64_tr_b16 v[44:45], v182 offset:16384
    ds_read_b64_tr_b16 v[46:47], v182 offset:16896
    ds_read_b128 v[76:79], v180 offset:2048
    ds_read_b64_tr_b16 v[48:49], v184 offset:0
    ds_read_b64_tr_b16 v[50:51], v184 offset:512
    ds_read_b64_tr_b16 v[52:53], v184 offset:8192
    ds_read_b64_tr_b16 v[54:55], v184 offset:8704
    ds_read_b64_tr_b16 v[56:57], v184 offset:16384
    ds_read_b64_tr_b16 v[58:59], v184 offset:16896
    s_waitcnt vmcnt(10)
    v_lshlrev_b32 v148, 16, v150
    v_and_b32 v149, 0xffff0000, v150
    v_lshlrev_b32 v150, 16, v151
    v_and_b32 v151, 0xffff0000, v151
    s_waitcnt vmcnt(9)
    v_lshlrev_b32 v152, 16, v154
    v_and_b32 v153, 0xffff0000, v154
    v_lshlrev_b32 v154, 16, v155
    v_and_b32 v155, 0xffff0000, v155
    s_waitcnt vmcnt(8)
    v_lshlrev_b32 v156, 16, v158
    v_and_b32 v157, 0xffff0000, v158
    v_lshlrev_b32 v158, 16, v159
    v_and_b32 v159, 0xffff0000, v159
    s_waitcnt vmcnt(7)
    v_lshlrev_b32 v160, 16, v162
    v_and_b32 v161, 0xffff0000, v162
    v_lshlrev_b32 v162, 16, v163
    v_and_b32 v163, 0xffff0000, v163
    s_waitcnt vmcnt(6)
    v_lshlrev_b32 v164, 16, v166
    v_and_b32 v165, 0xffff0000, v166
    v_lshlrev_b32 v166, 16, v167
    v_and_b32 v167, 0xffff0000, v167
    s_waitcnt vmcnt(5)
    v_lshlrev_b32 v168, 16, v170
    v_and_b32 v169, 0xffff0000, v170
    v_lshlrev_b32 v170, 16, v171
    v_and_b32 v171, 0xffff0000, v171
    s_waitcnt lgkmcnt(11)
    v_mfma_f32_16x16x32_bf16 v[100:103], v[36:39], v[72:75], v[148:151]
    ds_read_b128 v[80:83], v181 offset:0
    ds_read_b64_tr_b16 v[60:61], v182 offset:4096
    s_waitcnt lgkmcnt(8)
    v_mfma_f32_16x16x32_bf16 v[108:111], v[36:39], v[76:79], v[148:151]
    ds_read_b64_tr_b16 v[62:63], v182 offset:4608
    s_add_u32 m0, s72, 32768
    s_xor_b32 s74, s62, 256
    buffer_load_dwordx4 v96, s[4:7], s74 offen offset:0 lds
    s_mul_i32 s79, s64, 5
    s_min_u32 s80, s64, 3
    s_add_u32 s79, s79, s80
    s_lshl_b32 s87, s79, 15
    s_add_u32 s79, s79, 16
    s_lshl_b32 s89, s79, 17
    v_mfma_f32_16x16x32_bf16 v[116:119], v[40:43], v[72:75], v[156:159]
    ds_read_b64_tr_b16 v[64:65], v182 offset:12288
    ds_read_b64_tr_b16 v[66:67], v182 offset:12800
    v_mfma_f32_16x16x32_bf16 v[124:127], v[40:43], v[76:79], v[156:159]
    s_cmp_lt_u32 s64, 3
    s_cselect_b32 s91, 0, 0x40000000
    v_mfma_f32_16x16x32_bf16 v[132:135], v[44:47], v[72:75], v[164:167]
    ds_read_b64_tr_b16 v[68:69], v182 offset:20480
    ds_read_b64_tr_b16 v[70:71], v182 offset:20992
    v_mfma_f32_16x16x32_bf16 v[140:143], v[44:47], v[76:79], v[164:167]
    s_lshl_b32 s88, s64, 16
    s_lshl_b32 s90, s64, 18
    s_waitcnt lgkmcnt(11)
    v_mfma_f32_16x16x32_bf16 v[104:107], v[48:51], v[72:75], v[152:155]
    ds_read_b128 v[84:87], v181 offset:2048
    ds_read_b64_tr_b16 v[36:37], v184 offset:4096
    v_mfma_f32_16x16x32_bf16 v[112:115], v[48:51], v[76:79], v[152:155]
    ds_read_b64_tr_b16 v[38:39], v184 offset:4608
    buffer_load_dwordx4 v97, s[4:7], s74 offen offset:1024 lds
    s_mov_b32 s82, 0xbdd2d3e8
    s_mov_b32 s83, 0xbdd2d3e8
    s_waitcnt lgkmcnt(12)
    v_mfma_f32_16x16x32_bf16 v[120:123], v[52:55], v[72:75], v[160:163]
    ds_read_b64_tr_b16 v[40:41], v184 offset:12288
    ds_read_b64_tr_b16 v[42:43], v184 offset:12800
    v_mfma_f32_16x16x32_bf16 v[128:131], v[52:55], v[76:79], v[160:163]
    s_add_u32 m0, s73, 49152
    s_xor_b32 s75, s62, 256
    s_mul_i32 s75, s75, 1376
    buffer_load_dwordx4 v98, s[20:23], s75 offen offset:0 lds
    s_mov_b32 s84, 1.0
    s_mov_b32 s85, 1.0
    s_waitcnt lgkmcnt(12)
    v_mfma_f32_16x16x32_bf16 v[136:139], v[56:59], v[72:75], v[168:171]
    ds_read_b64_tr_b16 v[44:45], v184 offset:20480
    ds_read_b64_tr_b16 v[46:47], v184 offset:20992
    v_mfma_f32_16x16x32_bf16 v[144:147], v[56:59], v[76:79], v[168:171]
    v_mov_b32 v186, 0xc0135761
    v_mov_b32 v187, 0xc0135761
    s_waitcnt vmcnt(3) lgkmcnt(0)
    s_barrier
    v_mfma_f32_16x16x32_bf16 v[100:103], v[60:63], v[80:83], v[100:103]
    ds_read_b128 v[72:75], v180 offset:16384
    ds_read_b64_tr_b16 v[48:49], v182 offset:24576
    v_mfma_f32_16x16x32_bf16 v[108:111], v[60:63], v[84:87], v[108:111]
    ds_read_b64_tr_b16 v[50:51], v182 offset:25088
    s_add_u32 m0, s73, 57216
    s_nop 0
    buffer_load_dwordx4 v98, s[20:23], s75 offen offset:128 lds
    s_lshl_b32 s81, s66, 15
    s_lshr_b32 s79, s65, 1
    s_lshl_b32 s79, s79, 10
    s_add_u32 s81, s81, s79
    s_and_b32 s79, s65, 1
    s_lshl_b32 s79, s79, 2
    s_add_u32 s81, s81, s79
    s_add_u32 s81, s81, 0x800000
    v_mfma_f32_16x16x32_bf16 v[116:119], v[64:67], v[80:83], v[116:119]
    ds_read_b64_tr_b16 v[52:53], v182 offset:32768
    ds_read_b64_tr_b16 v[54:55], v182 offset:33280
    v_mfma_f32_16x16x32_bf16 v[124:127], v[64:67], v[84:87], v[124:127]
    s_lshl_b32 s79, s67, 11
    s_add_u32 s79, s79, s81
    v_mov_b32 v13, s79
    v_mfma_f32_16x16x32_bf16 v[132:135], v[68:71], v[80:83], v[132:135]
    ds_read_b64_tr_b16 v[56:57], v182 offset:40960
    ds_read_b64_tr_b16 v[58:59], v182 offset:41472
    v_mfma_f32_16x16x32_bf16 v[140:143], v[68:71], v[84:87], v[140:143]
    s_and_b32 s79, s64, 1
    s_lshl_b32 s79, s79, 6
    s_add_u32 s79, s79, s71
    v_xor_b32 v5, s79, v5
    v_xor_b32 v6, 64, v5
    v_mfma_f32_16x16x32_bf16 v[104:107], v[36:39], v[80:83], v[104:107]
    ds_read_b128 v[76:79], v180 offset:18432
    ds_read_b64_tr_b16 v[60:61], v184 offset:24576
    v_mfma_f32_16x16x32_bf16 v[112:115], v[36:39], v[84:87], v[112:115]
    ds_read_b64_tr_b16 v[62:63], v184 offset:25088
    s_add_u32 m0, s73, 65280
    s_nop 0
LIFa_1:
    s_cmp_eq_u32 s63, 1
    s_cbranch_scc1 LIFa_ret
    buffer_load_dwordx4 v99, s[20:23], s75 offen offset:256 lds
    v_add_u32 v7, 0x10000, v5
    v_add_u32 v8, 0x10000, v6
    v_mfma_f32_16x16x32_bf16 v[120:123], v[40:43], v[80:83], v[120:123]
    ds_read_b64_tr_b16 v[64:65], v184 offset:32768
    ds_read_b64_tr_b16 v[66:67], v184 offset:33280
    v_mfma_f32_16x16x32_bf16 v[128:131], v[40:43], v[84:87], v[128:131]
    s_add_u32 m0, s72, 49152
    s_xor_b32 s74, s62, 384
    buffer_load_dwordx4 v96, s[4:7], s74 offen offset:0 lds
    v_add_u32 v9, 0x10000, v7
    v_add_u32 v10, 0x10000, v8
    v_mfma_f32_16x16x32_bf16 v[136:139], v[44:47], v[80:83], v[136:139]
    ds_read_b64_tr_b16 v[68:69], v184 offset:40960
    ds_read_b64_tr_b16 v[70:71], v184 offset:41472
    v_mfma_f32_16x16x32_bf16 v[144:147], v[44:47], v[84:87], v[144:147]
    s_mov_b32 s34, 0x200000
    s_mov_b32 s35, 0x20000
    s_waitcnt lgkmcnt(11)
    v_mfma_f32_16x16x32_bf16 v[100:103], v[48:51], v[72:75], v[100:103]
    ds_read_b128 v[80:83], v181 offset:16384
    ds_read_b64_tr_b16 v[36:37], v182 offset:28672
    s_waitcnt lgkmcnt(8)
    v_mfma_f32_16x16x32_bf16 v[108:111], v[48:51], v[76:79], v[108:111]
    ds_read_b64_tr_b16 v[38:39], v182 offset:29184
    buffer_load_dwordx4 v97, s[4:7], s74 offen offset:1024 lds
    s_lshl_b32 s79, s69, 1
    s_lshr_b32 s80, s65, 1
    s_add_u32 s79, s79, s80
    s_lshl_b32 s80, s79, 11
    v_add_u32 v11, s80, v2
    v_xor_b32 v12, 2048, v11
    s_lshl_b32 s79, s79, 7
    s_lshr_b32 s80, s64, 1
    s_lshl_b32 s80, s80, 13
    s_add_u32 s79, s79, s80
    s_add_u32 s79, s79, 0x798000
    v_and_b32 v20, 31, v1
    v_lshl_add_u32 v29, v20, 2, s79
    v_mfma_f32_16x16x32_bf16 v[116:119], v[52:55], v[72:75], v[116:119]
    ds_read_b64_tr_b16 v[40:41], v182 offset:36864
    ds_read_b64_tr_b16 v[42:43], v182 offset:37376
    v_mfma_f32_16x16x32_bf16 v[124:127], v[52:55], v[76:79], v[124:127]
    s_lshr_b32 s79, s69, 1
    s_lshl_b32 s79, s79, 15
    s_and_b32 s80, s69, 1
    s_lshl_b32 s80, s80, 10
    s_add_u32 s79, s79, s80
    s_add_u32 s79, s79, 0x800000
    s_add_u32 s96, s79, s72
    v_mfma_f32_16x16x32_bf16 v[132:135], v[56:59], v[72:75], v[132:135]
    ds_read_b64_tr_b16 v[44:45], v182 offset:45056
    ds_read_b64_tr_b16 v[46:47], v182 offset:45568
    v_mfma_f32_16x16x32_bf16 v[140:143], v[56:59], v[76:79], v[140:143]
    v_lshlrev_b32 v206, 7, v1
    v_mov_b32 v207, 0x40000000
    v_cmp_gt_u32 vcc, 8, v1
    s_lshl_b32 s76, s2, 3
    s_add_u32 s76, s76, s64
    v_cndmask_b32 v206, v207, v206, vcc
    s_lshl_b32 s76, s76, 10
    s_sub_u32 s77, s76, 1409024
    s_cbranch_scc0 Ltu_4
    buffer_load_dword v207, v206, s[28:31], s76 offen
    s_branch Ltv_5
Ltu_4:
    buffer_load_dword v207, v206, s[40:43], s77 offen
Ltv_5:
    s_mov_b32 s18, 0x400
    s_mov_b32 s19, 0x20000
    s_lshl_b32 s79, s70, 7
    s_and_b32 s80, s65, 1
    s_lshl_b32 s80, s80, 6
    s_add_u32 s79, s79, s80
    v_lshlrev_b32 v22, 3, v21
    buffer_load_dwordx2 v[24:25], v22, s[16:19], s79 offen offset:0
    buffer_load_dwordx2 v[26:27], v22, s[16:19], s79 offen offset:16
    s_waitcnt lgkmcnt(11)
    v_mfma_f32_16x16x32_bf16 v[104:107], v[60:63], v[72:75], v[104:107]
    ds_read_b128 v[84:87], v181 offset:18432
    ds_read_b64_tr_b16 v[48:49], v184 offset:28672
    v_mfma_f32_16x16x32_bf16 v[112:115], v[60:63], v[76:79], v[112:115]
    ds_read_b64_tr_b16 v[50:51], v184 offset:29184
    s_add_u32 m0, s73, 73728
    s_xor_b32 s75, s62, 384
    s_mul_i32 s75, s75, 1376
    buffer_load_dwordx4 v98, s[20:23], s75 offen offset:0 lds
    s_waitcnt lgkmcnt(12)
    v_mfma_f32_16x16x32_bf16 v[120:123], v[64:67], v[72:75], v[120:123]
    ds_read_b64_tr_b16 v[52:53], v184 offset:36864
    ds_read_b64_tr_b16 v[54:55], v184 offset:37376
    v_mfma_f32_16x16x32_bf16 v[128:131], v[64:67], v[76:79], v[128:131]
    s_add_u32 m0, s73, 81792
    s_nop 0
    buffer_load_dwordx4 v98, s[20:23], s75 offen offset:128 lds
    s_waitcnt lgkmcnt(12)
    v_mfma_f32_16x16x32_bf16 v[136:139], v[68:71], v[72:75], v[136:139]
    ds_read_b64_tr_b16 v[56:57], v184 offset:45056
    ds_read_b64_tr_b16 v[58:59], v184 offset:45568
    v_mfma_f32_16x16x32_bf16 v[144:147], v[68:71], v[76:79], v[144:147]
    s_waitcnt vmcnt(7) lgkmcnt(0)
    s_barrier
    v_mfma_f32_16x16x32_bf16 v[100:103], v[36:39], v[80:83], v[100:103]
    ds_read_b128 v[72:75], v180 offset:32768
    ds_read_b64_tr_b16 v[60:61], v183 offset:0
    v_mfma_f32_16x16x32_bf16 v[108:111], v[36:39], v[84:87], v[108:111]
    ds_read_b64_tr_b16 v[62:63], v183 offset:512
    s_add_u32 m0, s73, 89856
    s_nop 0
    buffer_load_dwordx4 v99, s[20:23], s75 offen offset:256 lds
    v_mfma_f32_16x16x32_bf16 v[116:119], v[40:43], v[80:83], v[116:119]
    ds_read_b64_tr_b16 v[64:65], v183 offset:8192
    ds_read_b64_tr_b16 v[66:67], v183 offset:8704
    v_mfma_f32_16x16x32_bf16 v[124:127], v[40:43], v[84:87], v[124:127]
    v_mfma_f32_16x16x32_bf16 v[132:135], v[44:47], v[80:83], v[132:135]
    ds_read_b64_tr_b16 v[68:69], v183 offset:16384
    ds_read_b64_tr_b16 v[70:71], v183 offset:16896
    v_mfma_f32_16x16x32_bf16 v[140:143], v[44:47], v[84:87], v[140:143]
    v_mfma_f32_16x16x32_bf16 v[104:107], v[48:51], v[80:83], v[104:107]
    ds_read_b128 v[76:79], v180 offset:34816
    ds_read_b64_tr_b16 v[36:37], v185 offset:0
    v_mfma_f32_16x16x32_bf16 v[112:115], v[48:51], v[84:87], v[112:115]
    ds_read_b64_tr_b16 v[38:39], v185 offset:512
    s_add_u32 m0, s72, 0
    s_xor_b32 s74, s62, 512
    buffer_load_dwordx4 v96, s[4:7], s74 offen offset:0 lds
    v_mfma_f32_16x16x32_bf16 v[120:123], v[52:55], v[80:83], v[120:123]
    ds_read_b64_tr_b16 v[40:41], v185 offset:8192
    ds_read_b64_tr_b16 v[42:43], v185 offset:8704
    v_mfma_f32_16x16x32_bf16 v[128:131], v[52:55], v[84:87], v[128:131]
    buffer_load_dwordx4 v97, s[4:7], s74 offen offset:1024 lds
    v_mfma_f32_16x16x32_bf16 v[136:139], v[56:59], v[80:83], v[136:139]
    ds_read_b64_tr_b16 v[44:45], v185 offset:16384
    ds_read_b64_tr_b16 v[46:47], v185 offset:16896
    v_mfma_f32_16x16x32_bf16 v[144:147], v[56:59], v[84:87], v[144:147]
    s_waitcnt lgkmcnt(11)
    v_mfma_f32_16x16x32_bf16 v[100:103], v[60:63], v[72:75], v[100:103]
    ds_read_b128 v[80:83], v181 offset:32768
    ds_read_b64_tr_b16 v[48:49], v183 offset:4096
    s_waitcnt lgkmcnt(8)
    v_mfma_f32_16x16x32_bf16 v[108:111], v[60:63], v[76:79], v[108:111]
    ds_read_b64_tr_b16 v[50:51], v183 offset:4608
    s_add_u32 m0, s73, 0
    s_xor_b32 s75, s62, 512
    s_mul_i32 s75, s75, 1376
    buffer_load_dwordx4 v98, s[20:23], s75 offen offset:0 lds
    v_mfma_f32_16x16x32_bf16 v[116:119], v[64:67], v[72:75], v[116:119]
    ds_read_b64_tr_b16 v[52:53], v183 offset:12288
    ds_read_b64_tr_b16 v[54:55], v183 offset:12800
    v_mfma_f32_16x16x32_bf16 v[124:127], v[64:67], v[76:79], v[124:127]
    v_mfma_f32_16x16x32_bf16 v[132:135], v[68:71], v[72:75], v[132:135]
LIFa_2:
    s_cmp_eq_u32 s63, 1
    s_cbranch_scc1 LIFa_ret
    ds_read_b64_tr_b16 v[56:57], v183 offset:20480
    ds_read_b64_tr_b16 v[58:59], v183 offset:20992
    v_mfma_f32_16x16x32_bf16 v[140:143], v[68:71], v[76:79], v[140:143]
    s_waitcnt lgkmcnt(11)
    v_mfma_f32_16x16x32_bf16 v[104:107], v[36:39], v[72:75], v[104:107]
    ds_read_b128 v[84:87], v181 offset:34816
    ds_read_b64_tr_b16 v[60:61], v185 offset:4096
    v_mfma_f32_16x16x32_bf16 v[112:115], v[36:39], v[76:79], v[112:115]
    ds_read_b64_tr_b16 v[62:63], v185 offset:4608
    s_add_u32 m0, s73, 8064
    s_nop 0
    buffer_load_dwordx4 v98, s[20:23], s75 offen offset:128 lds
    s_waitcnt lgkmcnt(12)
    v_mfma_f32_16x16x32_bf16 v[120:123], v[40:43], v[72:75], v[120:123]
    ds_read_b64_tr_b16 v[64:65], v185 offset:12288
    ds_read_b64_tr_b16 v[66:67], v185 offset:12800
    v_mfma_f32_16x16x32_bf16 v[128:131], v[40:43], v[76:79], v[128:131]
    s_add_u32 m0, s73, 16128
    s_nop 0
    buffer_load_dwordx4 v99, s[20:23], s75 offen offset:256 lds
    s_waitcnt lgkmcnt(12)
    v_mfma_f32_16x16x32_bf16 v[136:139], v[44:47], v[72:75], v[136:139]
    ds_read_b64_tr_b16 v[68:69], v185 offset:20480
    ds_read_b64_tr_b16 v[70:71], v185 offset:20992
    v_mfma_f32_16x16x32_bf16 v[144:147], v[44:47], v[76:79], v[144:147]
    s_waitcnt vmcnt(5) lgkmcnt(0)
    s_barrier
    v_mfma_f32_16x16x32_bf16 v[100:103], v[48:51], v[80:83], v[100:103]
    ds_read_b128 v[72:75], v180 offset:49152
    ds_read_b64_tr_b16 v[36:37], v183 offset:24576
    v_mfma_f32_16x16x32_bf16 v[108:111], v[48:51], v[84:87], v[108:111]
    ds_read_b64_tr_b16 v[38:39], v183 offset:25088
    s_add_u32 m0, s72, 16384
    s_xor_b32 s74, s62, 640
    buffer_load_dwordx4 v96, s[4:7], s74 offen offset:0 lds
    v_mfma_f32_16x16x32_bf16 v[116:119], v[52:55], v[80:83], v[116:119]
    ds_read_b64_tr_b16 v[40:41], v183 offset:32768
    ds_read_b64_tr_b16 v[42:43], v183 offset:33280
    v_mfma_f32_16x16x32_bf16 v[124:127], v[52:55], v[84:87], v[124:127]
    v_mfma_f32_16x16x32_bf16 v[132:135], v[56:59], v[80:83], v[132:135]
    ds_read_b64_tr_b16 v[44:45], v183 offset:40960
    ds_read_b64_tr_b16 v[46:47], v183 offset:41472
    v_mfma_f32_16x16x32_bf16 v[140:143], v[56:59], v[84:87], v[140:143]
    v_mfma_f32_16x16x32_bf16 v[104:107], v[60:63], v[80:83], v[104:107]
    ds_read_b128 v[76:79], v180 offset:51200
    ds_read_b64_tr_b16 v[48:49], v185 offset:24576
    v_mfma_f32_16x16x32_bf16 v[112:115], v[60:63], v[84:87], v[112:115]
    ds_read_b64_tr_b16 v[50:51], v185 offset:25088
    buffer_load_dwordx4 v97, s[4:7], s74 offen offset:1024 lds
    v_mfma_f32_16x16x32_bf16 v[120:123], v[64:67], v[80:83], v[120:123]
    ds_read_b64_tr_b16 v[52:53], v185 offset:32768
    ds_read_b64_tr_b16 v[54:55], v185 offset:33280
    v_mfma_f32_16x16x32_bf16 v[128:131], v[64:67], v[84:87], v[128:131]
    s_add_u32 m0, s73, 24576
    s_xor_b32 s75, s62, 640
    s_mul_i32 s75, s75, 1376
    buffer_load_dwordx4 v98, s[20:23], s75 offen offset:0 lds
    v_mfma_f32_16x16x32_bf16 v[136:139], v[68:71], v[80:83], v[136:139]
    ds_read_b64_tr_b16 v[56:57], v185 offset:40960
    ds_read_b64_tr_b16 v[58:59], v185 offset:41472
    v_mfma_f32_16x16x32_bf16 v[144:147], v[68:71], v[84:87], v[144:147]
    s_waitcnt lgkmcnt(11)
    v_mfma_f32_16x16x32_bf16 v[100:103], v[36:39], v[72:75], v[100:103]
    ds_read_b128 v[80:83], v181 offset:49152
    ds_read_b64_tr_b16 v[60:61], v183 offset:28672
    s_waitcnt lgkmcnt(8)
    v_mfma_f32_16x16x32_bf16 v[108:111], v[36:39], v[76:79], v[108:111]
    ds_read_b64_tr_b16 v[62:63], v183 offset:29184
    s_add_u32 m0, s73, 32640
    s_nop 0
    buffer_load_dwordx4 v98, s[20:23], s75 offen offset:128 lds
    v_mfma_f32_16x16x32_bf16 v[116:119], v[40:43], v[72:75], v[116:119]
    ds_read_b64_tr_b16 v[64:65], v183 offset:36864
    ds_read_b64_tr_b16 v[66:67], v183 offset:37376
    v_mfma_f32_16x16x32_bf16 v[124:127], v[40:43], v[76:79], v[124:127]
    v_mfma_f32_16x16x32_bf16 v[132:135], v[44:47], v[72:75], v[132:135]
    ds_read_b64_tr_b16 v[68:69], v183 offset:45056
    ds_read_b64_tr_b16 v[70:71], v183 offset:45568
    v_mfma_f32_16x16x32_bf16 v[140:143], v[44:47], v[76:79], v[140:143]
    s_waitcnt lgkmcnt(11)
    v_mfma_f32_16x16x32_bf16 v[104:107], v[48:51], v[72:75], v[104:107]
    ds_read_b128 v[84:87], v181 offset:51200
    ds_read_b64_tr_b16 v[36:37], v185 offset:28672
    v_mfma_f32_16x16x32_bf16 v[112:115], v[48:51], v[76:79], v[112:115]
    ds_read_b64_tr_b16 v[38:39], v185 offset:29184
    s_add_u32 m0, s73, 40704
    s_nop 0
    buffer_load_dwordx4 v99, s[20:23], s75 offen offset:256 lds
    s_waitcnt lgkmcnt(12)
    v_mfma_f32_16x16x32_bf16 v[120:123], v[52:55], v[72:75], v[120:123]
    ds_read_b64_tr_b16 v[40:41], v185 offset:36864
    ds_read_b64_tr_b16 v[42:43], v185 offset:37376
    v_mfma_f32_16x16x32_bf16 v[128:131], v[52:55], v[76:79], v[128:131]
    s_add_u32 m0, s72, 32768
    s_xor_b32 s74, s62, 768
    buffer_load_dwordx4 v96, s[4:7], s74 offen offset:0 lds
    s_waitcnt lgkmcnt(12)
    v_mfma_f32_16x16x32_bf16 v[136:139], v[56:59], v[72:75], v[136:139]
    ds_read_b64_tr_b16 v[44:45], v185 offset:45056
    ds_read_b64_tr_b16 v[46:47], v185 offset:45568
    v_mfma_f32_16x16x32_bf16 v[144:147], v[56:59], v[76:79], v[144:147]
    s_waitcnt vmcnt(6) lgkmcnt(0)
    s_barrier
    v_mfma_f32_16x16x32_bf16 v[100:103], v[60:63], v[80:83], v[100:103]
    ds_read_b128 v[72:75], v180 offset:0
    ds_read_b64_tr_b16 v[48:49], v182 offset:0
    v_mfma_f32_16x16x32_bf16 v[108:111], v[60:63], v[84:87], v[108:111]
    ds_read_b64_tr_b16 v[50:51], v182 offset:512
    buffer_load_dwordx4 v97, s[4:7], s74 offen offset:1024 lds
    v_mfma_f32_16x16x32_bf16 v[116:119], v[64:67], v[80:83], v[116:119]
    ds_read_b64_tr_b16 v[52:53], v182 offset:8192
    ds_read_b64_tr_b16 v[54:55], v182 offset:8704
    v_mfma_f32_16x16x32_bf16 v[124:127], v[64:67], v[84:87], v[124:127]
    v_mfma_f32_16x16x32_bf16 v[132:135], v[68:71], v[80:83], v[132:135]
    ds_read_b64_tr_b16 v[56:57], v182 offset:16384
    ds_read_b64_tr_b16 v[58:59], v182 offset:16896
    v_mfma_f32_16x16x32_bf16 v[140:143], v[68:71], v[84:87], v[140:143]
    v_mfma_f32_16x16x32_bf16 v[104:107], v[36:39], v[80:83], v[104:107]
    ds_read_b128 v[76:79], v180 offset:2048
LIFa_3:
    s_cmp_eq_u32 s63, 1
    s_cbranch_scc1 LIFa_ret
    ds_read_b64_tr_b16 v[60:61], v184 offset:0
    v_mfma_f32_16x16x32_bf16 v[112:115], v[36:39], v[84:87], v[112:115]
    ds_read_b64_tr_b16 v[62:63], v184 offset:512
    s_add_u32 m0, s73, 49152
    s_xor_b32 s75, s62, 768
    s_mul_i32 s75, s75, 1376
    buffer_load_dwordx4 v98, s[20:23], s75 offen offset:0 lds
    v_mfma_f32_16x16x32_bf16 v[120:123], v[40:43], v[80:83], v[120:123]
    ds_read_b64_tr_b16 v[64:65], v184 offset:8192
    ds_read_b64_tr_b16 v[66:67], v184 offset:8704
    v_mfma_f32_16x16x32_bf16 v[128:131], v[40:43], v[84:87], v[128:131]
    s_add_u32 m0, s73, 57216
    s_nop 0
    buffer_load_dwordx4 v98, s[20:23], s75 offen offset:128 lds
    v_mfma_f32_16x16x32_bf16 v[136:139], v[44:47], v[80:83], v[136:139]
    ds_read_b64_tr_b16 v[68:69], v184 offset:16384
    ds_read_b64_tr_b16 v[70:71], v184 offset:16896
    v_mfma_f32_16x16x32_bf16 v[144:147], v[44:47], v[84:87], v[144:147]
    s_waitcnt lgkmcnt(11)
    v_mfma_f32_16x16x32_bf16 v[100:103], v[48:51], v[72:75], v[100:103]
    ds_read_b128 v[80:83], v181 offset:0
    ds_read_b64_tr_b16 v[36:37], v182 offset:4096
    s_waitcnt lgkmcnt(8)
    v_mfma_f32_16x16x32_bf16 v[108:111], v[48:51], v[76:79], v[108:111]
    ds_read_b64_tr_b16 v[38:39], v182 offset:4608
    s_add_u32 m0, s73, 65280
    s_nop 0
    buffer_load_dwordx4 v99, s[20:23], s75 offen offset:256 lds
    v_mfma_f32_16x16x32_bf16 v[116:119], v[52:55], v[72:75], v[116:119]
    ds_read_b64_tr_b16 v[40:41], v182 offset:12288
    ds_read_b64_tr_b16 v[42:43], v182 offset:12800
    v_mfma_f32_16x16x32_bf16 v[124:127], v[52:55], v[76:79], v[124:127]
    v_mfma_f32_16x16x32_bf16 v[132:135], v[56:59], v[72:75], v[132:135]
    ds_read_b64_tr_b16 v[44:45], v182 offset:20480
    ds_read_b64_tr_b16 v[46:47], v182 offset:20992
    v_mfma_f32_16x16x32_bf16 v[140:143], v[56:59], v[76:79], v[140:143]
    s_and_b32 s76, s93, 15
    s_lshl_b32 s76, s76, 3
    s_add_u32 s76, s76, s64
    v_mov_b32 v30, 0x40000000
    v_lshlrev_b32 v31, 10, v1
    v_cmp_gt_u32 vcc, 11, v1
    s_mul_i32 s77, s76, 11264
    s_nop 0
    v_cndmask_b32 v19, v30, v31, vcc
    v_cmp_gt_u32 vcc, 4, v1
    s_lshl_b32 s76, s76, 12
    s_nop 0
    v_cndmask_b32 v31, v30, v31, vcc
    buffer_load_dword v30, v19, s[28:31], s77 offen offset:384
    buffer_load_dword v31, v31, s[40:43], s76 offen offset:384
    s_waitcnt lgkmcnt(11)
    v_mfma_f32_16x16x32_bf16 v[104:107], v[60:63], v[72:75], v[104:107]
    ds_read_b128 v[84:87], v181 offset:2048
    ds_read_b64_tr_b16 v[48:49], v184 offset:4096
    v_mfma_f32_16x16x32_bf16 v[112:115], v[60:63], v[76:79], v[112:115]
    ds_read_b64_tr_b16 v[50:51], v184 offset:4608
    s_add_u32 m0, s72, 49152
    s_xor_b32 s74, s62, 896
    buffer_load_dwordx4 v96, s[4:7], s74 offen offset:0 lds
    s_waitcnt lgkmcnt(12)
    v_mfma_f32_16x16x32_bf16 v[120:123], v[64:67], v[72:75], v[120:123]
    ds_read_b64_tr_b16 v[52:53], v184 offset:12288
    ds_read_b64_tr_b16 v[54:55], v184 offset:12800
    v_mfma_f32_16x16x32_bf16 v[128:131], v[64:67], v[76:79], v[128:131]
    buffer_load_dwordx4 v97, s[4:7], s74 offen offset:1024 lds
    s_waitcnt lgkmcnt(12)
    v_mfma_f32_16x16x32_bf16 v[136:139], v[68:71], v[72:75], v[136:139]
    ds_read_b64_tr_b16 v[56:57], v184 offset:20480
    ds_read_b64_tr_b16 v[58:59], v184 offset:20992
    v_mfma_f32_16x16x32_bf16 v[144:147], v[68:71], v[76:79], v[144:147]
    s_waitcnt vmcnt(9) lgkmcnt(0)
    s_barrier
    v_mfma_f32_16x16x32_bf16 v[100:103], v[36:39], v[80:83], v[100:103]
    ds_read_b128 v[72:75], v180 offset:16384
    ds_read_b64_tr_b16 v[60:61], v182 offset:24576
    v_mfma_f32_16x16x32_bf16 v[108:111], v[36:39], v[84:87], v[108:111]
    ds_read_b64_tr_b16 v[62:63], v182 offset:25088
    s_add_u32 m0, s73, 73728
    s_xor_b32 s75, s62, 896
    s_mul_i32 s75, s75, 1376
    buffer_load_dwordx4 v98, s[20:23], s75 offen offset:0 lds
    v_mfma_f32_16x16x32_bf16 v[116:119], v[40:43], v[80:83], v[116:119]
    ds_read_b64_tr_b16 v[64:65], v182 offset:32768
    ds_read_b64_tr_b16 v[66:67], v182 offset:33280
    v_mfma_f32_16x16x32_bf16 v[124:127], v[40:43], v[84:87], v[124:127]
    v_mfma_f32_16x16x32_bf16 v[132:135], v[44:47], v[80:83], v[132:135]
    ds_read_b64_tr_b16 v[68:69], v182 offset:40960
    ds_read_b64_tr_b16 v[70:71], v182 offset:41472
    v_mfma_f32_16x16x32_bf16 v[140:143], v[44:47], v[84:87], v[140:143]
    v_mfma_f32_16x16x32_bf16 v[104:107], v[48:51], v[80:83], v[104:107]
    ds_read_b128 v[76:79], v180 offset:18432
    ds_read_b64_tr_b16 v[36:37], v184 offset:24576
    v_mfma_f32_16x16x32_bf16 v[112:115], v[48:51], v[84:87], v[112:115]
    ds_read_b64_tr_b16 v[38:39], v184 offset:25088
    s_add_u32 m0, s73, 81792
    s_nop 0
    buffer_load_dwordx4 v98, s[20:23], s75 offen offset:128 lds
    v_mfma_f32_16x16x32_bf16 v[120:123], v[52:55], v[80:83], v[120:123]
    ds_read_b64_tr_b16 v[40:41], v184 offset:32768
    ds_read_b64_tr_b16 v[42:43], v184 offset:33280
    v_mfma_f32_16x16x32_bf16 v[128:131], v[52:55], v[84:87], v[128:131]
    s_add_u32 m0, s73, 89856
    s_nop 0
    buffer_load_dwordx4 v99, s[20:23], s75 offen offset:256 lds
    v_mfma_f32_16x16x32_bf16 v[136:139], v[56:59], v[80:83], v[136:139]
    ds_read_b64_tr_b16 v[44:45], v184 offset:40960
    ds_read_b64_tr_b16 v[46:47], v184 offset:41472
    v_mfma_f32_16x16x32_bf16 v[144:147], v[56:59], v[84:87], v[144:147]
    s_waitcnt lgkmcnt(11)
    v_mfma_f32_16x16x32_bf16 v[100:103], v[60:63], v[72:75], v[100:103]
    ds_read_b128 v[80:83], v181 offset:16384
    ds_read_b64_tr_b16 v[48:49], v182 offset:28672
    s_waitcnt lgkmcnt(8)
    v_mfma_f32_16x16x32_bf16 v[108:111], v[60:63], v[76:79], v[108:111]
    ds_read_b64_tr_b16 v[50:51], v182 offset:29184
    s_add_u32 m0, s71, 65536
    s_add_u32 s77, s87, 0
    buffer_load_dwordx4 v4, s[28:31], s77 offen lds
    v_mfma_f32_16x16x32_bf16 v[116:119], v[64:67], v[72:75], v[116:119]
    ds_read_b64_tr_b16 v[52:53], v182 offset:36864
    ds_read_b64_tr_b16 v[54:55], v182 offset:37376
    v_mfma_f32_16x16x32_bf16 v[124:127], v[64:67], v[76:79], v[124:127]
    v_mfma_f32_16x16x32_bf16 v[132:135], v[68:71], v[72:75], v[132:135]
    ds_read_b64_tr_b16 v[56:57], v182 offset:45056
    ds_read_b64_tr_b16 v[58:59], v182 offset:45568
    v_mfma_f32_16x16x32_bf16 v[140:143], v[68:71], v[76:79], v[140:143]
    s_waitcnt lgkmcnt(11)
    v_mfma_f32_16x16x32_bf16 v[104:107], v[36:39], v[72:75], v[104:107]
    ds_read_b128 v[84:87], v181 offset:18432
    ds_read_b64_tr_b16 v[60:61], v184 offset:28672
    v_mfma_f32_16x16x32_bf16 v[112:115], v[36:39], v[76:79], v[112:115]
    ds_read_b64_tr_b16 v[62:63], v184 offset:29184
    s_add_u32 m0, s71, 73728
    s_add_u32 s77, s87, 16384
    buffer_load_dwordx4 v4, s[28:31], s77 offen lds
    s_waitcnt lgkmcnt(12)
    v_mfma_f32_16x16x32_bf16 v[120:123], v[40:43], v[72:75], v[120:123]
    ds_read_b64_tr_b16 v[64:65], v184 offset:36864
    ds_read_b64_tr_b16 v[66:67], v184 offset:37376
    v_mfma_f32_16x16x32_bf16 v[128:131], v[40:43], v[76:79], v[128:131]
LIFa_4:
    s_cmp_eq_u32 s63, 1
    s_cbranch_scc1 LIFa_ret
    s_waitcnt lgkmcnt(12)
    v_mfma_f32_16x16x32_bf16 v[136:139], v[44:47], v[72:75], v[136:139]
    ds_read_b64_tr_b16 v[68:69], v184 offset:45056
    ds_read_b64_tr_b16 v[70:71], v184 offset:45568
    v_mfma_f32_16x16x32_bf16 v[144:147], v[44:47], v[76:79], v[144:147]
    s_waitcnt vmcnt(9) lgkmcnt(0)
    s_barrier
    v_mfma_f32_16x16x32_bf16 v[100:103], v[48:51], v[80:83], v[100:103]
    ds_read_b128 v[72:75], v180 offset:32768
    ds_read_b64_tr_b16 v[36:37], v183 offset:0
    v_mfma_f32_16x16x32_bf16 v[108:111], v[48:51], v[84:87], v[108:111]
    ds_read_b64_tr_b16 v[38:39], v183 offset:512
    s_add_u32 m0, s71, 0
    s_add_u32 s77, s87, 8192
    buffer_load_dwordx4 v4, s[28:31], s77 offen lds
    v_mfma_f32_16x16x32_bf16 v[116:119], v[52:55], v[80:83], v[116:119]
    ds_read_b64_tr_b16 v[40:41], v183 offset:8192
    ds_read_b64_tr_b16 v[42:43], v183 offset:8704
    v_mfma_f32_16x16x32_bf16 v[124:127], v[52:55], v[84:87], v[124:127]
    v_mfma_f32_16x16x32_bf16 v[132:135], v[56:59], v[80:83], v[132:135]
    ds_read_b64_tr_b16 v[44:45], v183 offset:16384
    ds_read_b64_tr_b16 v[46:47], v183 offset:16896
    v_mfma_f32_16x16x32_bf16 v[140:143], v[56:59], v[84:87], v[140:143]
    s_buffer_load_dword s94, s[24:27], 0
    v_mfma_f32_16x16x32_bf16 v[104:107], v[60:63], v[80:83], v[104:107]
    ds_read_b128 v[76:79], v180 offset:34816
    ds_read_b64_tr_b16 v[48:49], v185 offset:0
    v_mfma_f32_16x16x32_bf16 v[112:115], v[60:63], v[84:87], v[112:115]
    ds_read_b64_tr_b16 v[50:51], v185 offset:512
    s_add_u32 m0, s71, 8192
    s_add_u32 s77, s87, 24576
    buffer_load_dwordx4 v4, s[28:31], s77 offen lds
    v_mfma_f32_16x16x32_bf16 v[120:123], v[64:67], v[80:83], v[120:123]
    ds_read_b64_tr_b16 v[52:53], v185 offset:8192
    ds_read_b64_tr_b16 v[54:55], v185 offset:8704
    v_mfma_f32_16x16x32_bf16 v[128:131], v[64:67], v[84:87], v[128:131]
    s_add_u32 m0, s71, 81920
    s_add_u32 s77, s87, 65536
    buffer_load_dwordx4 v4, s[28:31], s77 offen lds
    v_mfma_f32_16x16x32_bf16 v[136:139], v[68:71], v[80:83], v[136:139]
    ds_read_b64_tr_b16 v[56:57], v185 offset:16384
    ds_read_b64_tr_b16 v[58:59], v185 offset:16896
    v_mfma_f32_16x16x32_bf16 v[144:147], v[68:71], v[84:87], v[144:147]
    s_waitcnt lgkmcnt(11)
    v_mfma_f32_16x16x32_bf16 v[100:103], v[36:39], v[72:75], v[100:103]
    ds_read_b128 v[80:83], v181 offset:32768
    ds_read_b64_tr_b16 v[60:61], v183 offset:4096
    s_waitcnt lgkmcnt(8)
    v_mfma_f32_16x16x32_bf16 v[108:111], v[36:39], v[76:79], v[108:111]
    ds_read_b64_tr_b16 v[62:63], v183 offset:4608
    s_add_u32 m0, s71, 90112
    s_add_u32 s77, s87, 81920
    buffer_load_dwordx4 v4, s[28:31], s77 offen lds
    v_mfma_f32_16x16x32_bf16 v[116:119], v[40:43], v[72:75], v[116:119]
    ds_read_b64_tr_b16 v[64:65], v183 offset:12288
    ds_read_b64_tr_b16 v[66:67], v183 offset:12800
    v_mfma_f32_16x16x32_bf16 v[124:127], v[40:43], v[76:79], v[124:127]
    v_mfma_f32_16x16x32_bf16 v[132:135], v[44:47], v[72:75], v[132:135]
    ds_read_b64_tr_b16 v[68:69], v183 offset:20480
    ds_read_b64_tr_b16 v[70:71], v183 offset:20992
    v_mfma_f32_16x16x32_bf16 v[140:143], v[44:47], v[76:79], v[140:143]
    s_waitcnt lgkmcnt(11)
    v_mfma_f32_16x16x32_bf16 v[104:107], v[48:51], v[72:75], v[104:107]
    ds_read_b128 v[84:87], v181 offset:34816
    ds_read_b64_tr_b16 v[36:37], v185 offset:4096
    v_mfma_f32_16x16x32_bf16 v[112:115], v[48:51], v[76:79], v[112:115]
    ds_read_b64_tr_b16 v[38:39], v185 offset:4608
    s_add_u32 m0, s71, 98304
    s_add_u32 s77, s87, 73728
    buffer_load_dwordx4 v4, s[28:31], s77 offen lds
    s_waitcnt lgkmcnt(12)
    v_mfma_f32_16x16x32_bf16 v[120:123], v[52:55], v[72:75], v[120:123]
    ds_read_b64_tr_b16 v[40:41], v185 offset:12288
    ds_read_b64_tr_b16 v[42:43], v185 offset:12800
    v_mfma_f32_16x16x32_bf16 v[128:131], v[52:55], v[76:79], v[128:131]
    s_waitcnt lgkmcnt(12)
    v_mfma_f32_16x16x32_bf16 v[136:139], v[56:59], v[72:75], v[136:139]
    ds_read_b64_tr_b16 v[44:45], v185 offset:20480
    ds_read_b64_tr_b16 v[46:47], v185 offset:20992
    v_mfma_f32_16x16x32_bf16 v[144:147], v[56:59], v[76:79], v[144:147]
    s_waitcnt lgkmcnt(0)
    s_cmp_lg_u32 s94, 0
    s_cbranch_scc0 Lretry_7i
Lok_6:
    s_mov_b32 s95, s94
    v_mov_b32 v17, s94
    s_waitcnt vmcnt(7)
    s_barrier
    v_mfma_f32_16x16x32_bf16 v[100:103], v[60:63], v[80:83], v[100:103]
    ds_read_b128 v[72:75], v180 offset:49152
    ds_read_b64_tr_b16 v[48:49], v183 offset:24576
    v_mfma_f32_16x16x32_bf16 v[108:111], v[60:63], v[84:87], v[108:111]
    ds_read_b64_tr_b16 v[50:51], v183 offset:25088
    s_add_u32 m0, s71, 16384
    s_add_u32 s77, s87, 90112
    buffer_load_dwordx4 v4, s[28:31], s77 offen lds
    v_mfma_f32_16x16x32_bf16 v[116:119], v[64:67], v[80:83], v[116:119]
    ds_read_b64_tr_b16 v[52:53], v183 offset:32768
    ds_read_b64_tr_b16 v[54:55], v183 offset:33280
    v_mfma_f32_16x16x32_bf16 v[124:127], v[64:67], v[84:87], v[124:127]
    v_mfma_f32_16x16x32_bf16 v[132:135], v[68:71], v[80:83], v[132:135]
    ds_read_b64_tr_b16 v[56:57], v183 offset:40960
    ds_read_b64_tr_b16 v[58:59], v183 offset:41472
    v_mfma_f32_16x16x32_bf16 v[140:143], v[68:71], v[84:87], v[140:143]
    v_mfma_f32_16x16x32_bf16 v[104:107], v[36:39], v[80:83], v[104:107]
    ds_read_b128 v[76:79], v180 offset:51200
    ds_read_b64_tr_b16 v[60:61], v185 offset:24576
    v_mfma_f32_16x16x32_bf16 v[112:115], v[36:39], v[84:87], v[112:115]
    ds_read_b64_tr_b16 v[62:63], v185 offset:25088
    s_add_u32 m0, s71, 24576
    s_add_u32 s77, s87, 131072
    buffer_load_dwordx4 v4, s[28:31], s77 offen lds
    v_mfma_f32_16x16x32_bf16 v[120:123], v[40:43], v[80:83], v[120:123]
    ds_read_b64_tr_b16 v[64:65], v185 offset:32768
    ds_read_b64_tr_b16 v[66:67], v185 offset:33280
    v_mfma_f32_16x16x32_bf16 v[128:131], v[40:43], v[84:87], v[128:131]
    s_add_u32 m0, s71, 106496
    s_add_u32 s77, s87, 147456
    buffer_load_dwordx4 v4, s[28:31], s77 offen lds
    v_mfma_f32_16x16x32_bf16 v[136:139], v[44:47], v[80:83], v[136:139]
    ds_read_b64_tr_b16 v[68:69], v185 offset:40960
    ds_read_b64_tr_b16 v[70:71], v185 offset:41472
    v_mfma_f32_16x16x32_bf16 v[144:147], v[44:47], v[84:87], v[144:147]
    s_waitcnt lgkmcnt(11)
    v_mfma_f32_16x16x32_bf16 v[100:103], v[48:51], v[72:75], v[100:103]
    ds_read_b128 v[80:83], v181 offset:49152
    ds_read_b64_tr_b16 v[36:37], v183 offset:28672
    s_waitcnt lgkmcnt(8)
    v_mfma_f32_16x16x32_bf16 v[108:111], v[48:51], v[76:79], v[108:111]
    ds_read_b64_tr_b16 v[38:39], v183 offset:29184
    s_add_u32 m0, s71, 114688
    s_add_u32 s77, s87, 139264
    buffer_load_dwordx4 v4, s[28:31], s77 offen lds
    v_mfma_f32_16x16x32_bf16 v[116:119], v[52:55], v[72:75], v[116:119]
    ds_read_b64_tr_b16 v[40:41], v183 offset:36864
    ds_read_b64_tr_b16 v[42:43], v183 offset:37376
    v_mfma_f32_16x16x32_bf16 v[124:127], v[52:55], v[76:79], v[124:127]
LIFa_5:
    s_cmp_eq_u32 s63, 1
    s_cbranch_scc1 LIFa_ret
    v_mfma_f32_16x16x32_bf16 v[132:135], v[56:59], v[72:75], v[132:135]
    ds_read_b64_tr_b16 v[44:45], v183 offset:45056
    ds_read_b64_tr_b16 v[46:47], v183 offset:45568
    v_mfma_f32_16x16x32_bf16 v[140:143], v[56:59], v[76:79], v[140:143]
    s_waitcnt lgkmcnt(11)
    v_mfma_f32_16x16x32_bf16 v[104:107], v[60:63], v[72:75], v[104:107]
    ds_read_b128 v[84:87], v181 offset:51200
    ds_read_b64_tr_b16 v[48:49], v185 offset:28672
    v_mfma_f32_16x16x32_bf16 v[112:115], v[60:63], v[76:79], v[112:115]
    ds_read_b64_tr_b16 v[50:51], v185 offset:29184
    s_add_u32 m0, s71, 122880
    s_add_u32 s77, s87, 155648
    buffer_load_dwordx4 v4, s[28:31], s77 offen lds
    s_waitcnt lgkmcnt(12)
    v_mfma_f32_16x16x32_bf16 v[120:123], v[64:67], v[72:75], v[120:123]
    ds_read_b64_tr_b16 v[52:53], v185 offset:36864
    ds_read_b64_tr_b16 v[54:55], v185 offset:37376
    v_mfma_f32_16x16x32_bf16 v[128:131], v[64:67], v[76:79], v[128:131]
    s_waitcnt lgkmcnt(12)
    v_mfma_f32_16x16x32_bf16 v[136:139], v[68:71], v[72:75], v[136:139]
    ds_read_b64_tr_b16 v[56:57], v185 offset:45056
    ds_read_b64_tr_b16 v[58:59], v185 offset:45568
    v_mfma_f32_16x16x32_bf16 v[144:147], v[68:71], v[76:79], v[144:147]
    s_waitcnt lgkmcnt(11)
    v_mfma_f32_16x16x32_bf16 v[100:103], v[36:39], v[80:83], v[100:103]
    s_waitcnt lgkmcnt(6)
    v_mfma_f32_16x16x32_bf16 v[108:111], v[36:39], v[84:87], v[108:111]
    s_add_u32 m0, s71, 32768
    s_add_u32 s77, s87, 32768
    buffer_load_dwordx4 v4, s[28:31], s77 offen lds
    v_mfma_f32_16x16x32_bf16 v[116:119], v[40:43], v[80:83], v[116:119]
    v_mfma_f32_16x16x32_bf16 v[124:127], v[40:43], v[84:87], v[124:127]
    v_mfma_f32_16x16x32_bf16 v[132:135], v[44:47], v[80:83], v[132:135]
    v_mfma_f32_16x16x32_bf16 v[140:143], v[44:47], v[84:87], v[140:143]
    s_waitcnt lgkmcnt(4)
    v_mfma_f32_16x16x32_bf16 v[104:107], v[48:51], v[80:83], v[104:107]
    v_mfma_f32_16x16x32_bf16 v[112:115], v[48:51], v[84:87], v[112:115]
    s_add_u32 m0, s71, 40960
    s_add_u32 s77, s87, 49152
    buffer_load_dwordx4 v4, s[28:31], s77 offen lds
    s_waitcnt lgkmcnt(2)
    v_mfma_f32_16x16x32_bf16 v[120:123], v[52:55], v[80:83], v[120:123]
    v_mfma_f32_16x16x32_bf16 v[128:131], v[52:55], v[84:87], v[128:131]
    s_add_u32 m0, s71, 131072
    s_add_u32 s77, s87, 40960
    buffer_load_dwordx4 v4, s[28:31], s77 offen lds
    s_waitcnt lgkmcnt(0)
    v_mfma_f32_16x16x32_bf16 v[136:139], v[56:59], v[80:83], v[136:139]
    v_mfma_f32_16x16x32_bf16 v[144:147], v[56:59], v[84:87], v[144:147]
LDFa:
    s_setprio 3
    v_pk_mul_f32 v[148:149], v[100:101], v[100:101]
    v_pk_mul_f32 v[150:151], v[102:103], v[102:103]
    v_pk_mul_f32 v[152:153], v[104:105], v[104:105]
    v_pk_mul_f32 v[154:155], v[106:107], v[106:107]
    v_pk_fma_f32 v[148:149], v[148:149], s[82:83], v[186:187]
    v_pk_fma_f32 v[150:151], v[150:151], s[82:83], v[186:187]
    v_pk_fma_f32 v[152:153], v[152:153], s[82:83], v[186:187]
    v_pk_fma_f32 v[154:155], v[154:155], s[82:83], v[186:187]
    v_pk_mul_f32 v[148:149], v[148:149], v[100:101]
    v_pk_mul_f32 v[150:151], v[150:151], v[102:103]
    v_pk_mul_f32 v[152:153], v[152:153], v[104:105]
    v_pk_mul_f32 v[154:155], v[154:155], v[106:107]
    v_exp_f32 v148, v148
    v_exp_f32 v149, v149
    v_exp_f32 v150, v150
    v_exp_f32 v151, v151
    v_exp_f32 v152, v152
    v_exp_f32 v153, v153
    v_exp_f32 v154, v154
    v_exp_f32 v155, v155
    v_pk_add_f32 v[148:149], v[148:149], s[84:85]
    v_pk_add_f32 v[150:151], v[150:151], s[84:85]
    v_pk_add_f32 v[152:153], v[152:153], s[84:85]
    v_pk_add_f32 v[154:155], v[154:155], s[84:85]
    v_rcp_f32 v148, v148
    v_rcp_f32 v149, v149
    v_rcp_f32 v150, v150
    v_rcp_f32 v151, v151
    v_rcp_f32 v152, v152
    v_rcp_f32 v153, v153
    v_rcp_f32 v154, v154
    v_rcp_f32 v155, v155
    v_pk_mul_f32 v[148:149], v[148:149], v[100:101]
    v_pk_mul_f32 v[150:151], v[150:151], v[102:103]
    v_pk_mul_f32 v[152:153], v[152:153], v[104:105]
    v_pk_mul_f32 v[154:155], v[154:155], v[106:107]
    s_waitcnt vmcnt(13)
    ds_read_b64_tr_b16 v[196:197], v7 offset:0
    ds_read_b64_tr_b16 v[198:199], v7 offset:8192
    ds_read_b64_tr_b16 v[200:201], v8 offset:0
    ds_read_b64_tr_b16 v[202:203], v8 offset:8192
    v_cvt_pk_bf16_f32 v156, v148, v149
    v_cvt_pk_bf16_f32 v157, v150, v151
    v_cvt_pk_bf16_f32 v158, v152, v153
    v_cvt_pk_bf16_f32 v159, v154, v155
    v_pk_mul_f32 v[164:165], v[108:109], v[108:109]
    v_pk_mul_f32 v[166:167], v[110:111], v[110:111]
    s_add_u32 s76, s86, 0
    buffer_store_dwordx4 v[156:159], v28, s[36:39], s76 offen offset:0 sc1
    v_pk_mul_f32 v[168:169], v[112:113], v[112:113]
    v_pk_mul_f32 v[170:171], v[114:115], v[114:115]
    v_pk_fma_f32 v[164:165], v[164:165], s[82:83], v[186:187]
    v_pk_fma_f32 v[166:167], v[166:167], s[82:83], v[186:187]
    v_pk_fma_f32 v[168:169], v[168:169], s[82:83], v[186:187]
    v_pk_fma_f32 v[170:171], v[170:171], s[82:83], v[186:187]
    v_pk_mul_f32 v[164:165], v[164:165], v[108:109]
    v_pk_mul_f32 v[166:167], v[166:167], v[110:111]
    v_pk_mul_f32 v[168:169], v[168:169], v[112:113]
    v_pk_mul_f32 v[170:171], v[170:171], v[114:115]
    v_exp_f32 v164, v164
    v_exp_f32 v165, v165
    v_exp_f32 v166, v166
    v_exp_f32 v167, v167
    v_exp_f32 v168, v168
    v_exp_f32 v169, v169
    v_exp_f32 v170, v170
    v_exp_f32 v171, v171
    v_pk_add_f32 v[164:165], v[164:165], s[84:85]
    v_pk_add_f32 v[166:167], v[166:167], s[84:85]
    v_pk_add_f32 v[168:169], v[168:169], s[84:85]
    v_pk_add_f32 v[170:171], v[170:171], s[84:85]
    v_rcp_f32 v164, v164
    v_rcp_f32 v165, v165
    v_rcp_f32 v166, v166
    v_rcp_f32 v167, v167
    v_rcp_f32 v168, v168
    v_rcp_f32 v169, v169
    v_rcp_f32 v170, v170
    s_waitcnt lgkmcnt(0)
    s_add_u32 m0, s71, 65536
    s_add_u32 s77, s87, 57344
    buffer_load_dwordx4 v4, s[28:31], s77 offen lds
    s_waitcnt vmcnt(13)
    ds_read_b64_tr_b16 v[204:205], v5 offset:0
    ds_read_b64_tr_b16 v[206:207], v5 offset:8192
    ds_read_b64_tr_b16 v[208:209], v6 offset:0
    ds_read_b64_tr_b16 v[210:211], v6 offset:8192
    v_rcp_f32 v171, v171
    v_pk_mul_f32 v[164:165], v[164:165], v[108:109]
    v_pk_mul_f32 v[166:167], v[166:167], v[110:111]
    v_pk_mul_f32 v[168:169], v[168:169], v[112:113]
    v_pk_mul_f32 v[170:171], v[170:171], v[114:115]
    v_cvt_pk_bf16_f32 v160, v164, v165
    v_cvt_pk_bf16_f32 v161, v166, v167
    v_cvt_pk_bf16_f32 v162, v168, v169
    v_cvt_pk_bf16_f32 v163, v170, v171
    s_add_u32 s76, s86, 0
    buffer_store_dwordx4 v[160:163], v28, s[36:39], s76 offen offset:256 sc1
    v_pk_mul_f32 v[148:149], v[116:117], v[116:117]
    v_pk_mul_f32 v[150:151], v[118:119], v[118:119]
LIFa_6:
    s_cmp_eq_u32 s63, 1
    s_cbranch_scc1 LIFa_ret
    v_pk_mul_f32 v[152:153], v[120:121], v[120:121]
    v_pk_mul_f32 v[154:155], v[122:123], v[122:123]
    v_pk_fma_f32 v[148:149], v[148:149], s[82:83], v[186:187]
    v_pk_fma_f32 v[150:151], v[150:151], s[82:83], v[186:187]
    v_pk_fma_f32 v[152:153], v[152:153], s[82:83], v[186:187]
    v_pk_fma_f32 v[154:155], v[154:155], s[82:83], v[186:187]
    v_pk_mul_f32 v[148:149], v[148:149], v[116:117]
    v_pk_mul_f32 v[150:151], v[150:151], v[118:119]
    v_pk_mul_f32 v[152:153], v[152:153], v[120:121]
    v_pk_mul_f32 v[154:155], v[154:155], v[122:123]
    v_exp_f32 v148, v148
    v_exp_f32 v149, v149
    v_exp_f32 v150, v150
    v_exp_f32 v151, v151
    v_exp_f32 v152, v152
    v_exp_f32 v153, v153
    v_exp_f32 v154, v154
    v_exp_f32 v155, v155
    v_pk_add_f32 v[148:149], v[148:149], s[84:85]
    v_pk_add_f32 v[150:151], v[150:151], s[84:85]
    v_pk_add_f32 v[152:153], v[152:153], s[84:85]
    v_pk_add_f32 v[154:155], v[154:155], s[84:85]
    s_add_u32 m0, s71, 73728
    s_add_u32 s77, s87, 98304
    buffer_load_dwordx4 v4, s[28:31], s77 offen lds
    v_rcp_f32 v148, v148
    v_rcp_f32 v149, v149
    v_rcp_f32 v150, v150
    v_rcp_f32 v151, v151
    v_rcp_f32 v152, v152
    v_rcp_f32 v153, v153
    v_rcp_f32 v154, v154
    v_rcp_f32 v155, v155
    v_pk_mul_f32 v[148:149], v[148:149], v[116:117]
    v_pk_mul_f32 v[150:151], v[150:151], v[118:119]
    v_pk_mul_f32 v[152:153], v[152:153], v[120:121]
    v_pk_mul_f32 v[154:155], v[154:155], v[122:123]
    v_cvt_pk_bf16_f32 v172, v148, v149
    v_cvt_pk_bf16_f32 v173, v150, v151
    v_cvt_pk_bf16_f32 v174, v152, v153
    v_cvt_pk_bf16_f32 v175, v154, v155
    v_pk_mul_f32 v[164:165], v[124:125], v[124:125]
    v_pk_mul_f32 v[166:167], v[126:127], v[126:127]
    s_add_u32 s76, s86, 262144
    buffer_store_dwordx4 v[172:175], v28, s[36:39], s76 offen offset:0 sc1
    v_pk_mul_f32 v[168:169], v[128:129], v[128:129]
    v_pk_mul_f32 v[170:171], v[130:131], v[130:131]
    v_pk_fma_f32 v[164:165], v[164:165], s[82:83], v[186:187]
    v_pk_fma_f32 v[166:167], v[166:167], s[82:83], v[186:187]
    v_pk_fma_f32 v[168:169], v[168:169], s[82:83], v[186:187]
    v_pk_fma_f32 v[170:171], v[170:171], s[82:83], v[186:187]
    v_pk_mul_f32 v[164:165], v[164:165], v[124:125]
    v_pk_mul_f32 v[166:167], v[166:167], v[126:127]
    v_pk_mul_f32 v[168:169], v[168:169], v[128:129]
    v_pk_mul_f32 v[170:171], v[170:171], v[130:131]
    v_exp_f32 v164, v164
    v_exp_f32 v165, v165
    v_exp_f32 v166, v166
    v_exp_f32 v167, v167
    v_exp_f32 v168, v168
    v_exp_f32 v169, v169
    v_exp_f32 v170, v170
    s_waitcnt lgkmcnt(0)
    s_add_u32 m0, s71, 0
    s_add_u32 s77, s87, 114688
    buffer_load_dwordx4 v4, s[28:31], s77 offen lds
    s_waitcnt vmcnt(15)
    ds_read_b64_tr_b16 v[212:213], v7 offset:16384
    ds_read_b64_tr_b16 v[214:215], v7 offset:24576
    ds_read_b64_tr_b16 v[216:217], v8 offset:16384
    ds_read_b64_tr_b16 v[218:219], v8 offset:24576
    v_exp_f32 v171, v171
    v_pk_add_f32 v[164:165], v[164:165], s[84:85]
    v_pk_add_f32 v[166:167], v[166:167], s[84:85]
    v_pk_add_f32 v[168:169], v[168:169], s[84:85]
    v_pk_add_f32 v[170:171], v[170:171], s[84:85]
    v_rcp_f32 v164, v164
    v_rcp_f32 v165, v165
    v_rcp_f32 v166, v166
    v_rcp_f32 v167, v167
    v_rcp_f32 v168, v168
    v_rcp_f32 v169, v169
    v_rcp_f32 v170, v170
    v_rcp_f32 v171, v171
    v_pk_mul_f32 v[164:165], v[164:165], v[124:125]
    v_pk_mul_f32 v[166:167], v[166:167], v[126:127]
    v_pk_mul_f32 v[168:169], v[168:169], v[128:129]
    v_pk_mul_f32 v[170:171], v[170:171], v[130:131]
    v_cvt_pk_bf16_f32 v176, v164, v165
    v_cvt_pk_bf16_f32 v177, v166, v167
    v_cvt_pk_bf16_f32 v178, v168, v169
    v_cvt_pk_bf16_f32 v179, v170, v171
    s_add_u32 s76, s86, 262144
    buffer_store_dwordx4 v[176:179], v28, s[36:39], s76 offen offset:256 sc1
    s_waitcnt vmcnt(4)
    buffer_store_dword v17, v13, s[36:39], 0 offen offset:0 sc1
    v_pk_mul_f32 v[148:149], v[132:133], v[132:133]
    v_pk_mul_f32 v[150:151], v[134:135], v[134:135]
    v_pk_mul_f32 v[152:153], v[136:137], v[136:137]
    v_pk_mul_f32 v[154:155], v[138:139], v[138:139]
    v_pk_fma_f32 v[148:149], v[148:149], s[82:83], v[186:187]
    v_pk_fma_f32 v[150:151], v[150:151], s[82:83], v[186:187]
    v_pk_fma_f32 v[152:153], v[152:153], s[82:83], v[186:187]
    v_pk_fma_f32 v[154:155], v[154:155], s[82:83], v[186:187]
    v_pk_mul_f32 v[148:149], v[148:149], v[132:133]
    v_pk_mul_f32 v[150:151], v[150:151], v[134:135]
    v_pk_mul_f32 v[152:153], v[152:153], v[136:137]
    v_pk_mul_f32 v[154:155], v[154:155], v[138:139]
    v_exp_f32 v148, v148
    v_exp_f32 v149, v149
    v_exp_f32 v150, v150
    v_exp_f32 v151, v151
    v_exp_f32 v152, v152
    v_exp_f32 v153, v153
    v_exp_f32 v154, v154
    v_exp_f32 v155, v155
    v_pk_add_f32 v[148:149], v[148:149], s[84:85]
    v_pk_add_f32 v[150:151], v[150:151], s[84:85]
    v_pk_add_f32 v[152:153], v[152:153], s[84:85]
    v_pk_add_f32 v[154:155], v[154:155], s[84:85]
    v_rcp_f32 v148, v148
    v_rcp_f32 v149, v149
    v_rcp_f32 v150, v150
    v_rcp_f32 v151, v151
    v_rcp_f32 v152, v152
    v_rcp_f32 v153, v153
    v_rcp_f32 v154, v154
    v_rcp_f32 v155, v155
    v_pk_mul_f32 v[148:149], v[148:149], v[132:133]
    v_pk_mul_f32 v[150:151], v[150:151], v[134:135]
    v_pk_mul_f32 v[152:153], v[152:153], v[136:137]
    s_add_u32 m0, s71, 8192
    s_add_u32 s77, s87, 106496
    buffer_load_dwordx4 v4, s[28:31], s77 offen lds
    v_pk_mul_f32 v[154:155], v[154:155], v[138:139]
    v_cvt_pk_bf16_f32 v156, v148, v149
    v_cvt_pk_bf16_f32 v157, v150, v151
    v_cvt_pk_bf16_f32 v158, v152, v153
    v_cvt_pk_bf16_f32 v159, v154, v155
    v_pk_mul_f32 v[164:165], v[140:141], v[140:141]
    v_pk_mul_f32 v[166:167], v[142:143], v[142:143]
    s_add_u32 s76, s86, 524288
    buffer_store_dwordx4 v[156:159], v28, s[36:39], s76 offen offset:0 sc1
    v_pk_mul_f32 v[168:169], v[144:145], v[144:145]
    v_pk_mul_f32 v[170:171], v[146:147], v[146:147]
    v_pk_fma_f32 v[164:165], v[164:165], s[82:83], v[186:187]
    v_pk_fma_f32 v[166:167], v[166:167], s[82:83], v[186:187]
    v_pk_fma_f32 v[168:169], v[168:169], s[82:83], v[186:187]
    v_pk_fma_f32 v[170:171], v[170:171], s[82:83], v[186:187]
    v_pk_mul_f32 v[164:165], v[164:165], v[140:141]
    v_pk_mul_f32 v[166:167], v[166:167], v[142:143]
    v_pk_mul_f32 v[168:169], v[168:169], v[144:145]
    v_pk_mul_f32 v[170:171], v[170:171], v[146:147]
LIFa_7:
    s_cmp_eq_u32 s63, 1
    s_cbranch_scc1 LIFa_ret
    v_exp_f32 v164, v164
    v_exp_f32 v165, v165
    v_exp_f32 v166, v166
    v_exp_f32 v167, v167
    v_exp_f32 v168, v168
    v_exp_f32 v169, v169
    v_exp_f32 v170, v170
    v_exp_f32 v171, v171
    v_pk_add_f32 v[164:165], v[164:165], s[84:85]
    v_pk_add_f32 v[166:167], v[166:167], s[84:85]
    v_pk_add_f32 v[168:169], v[168:169], s[84:85]
    v_pk_add_f32 v[170:171], v[170:171], s[84:85]
    v_rcp_f32 v164, v164
    v_rcp_f32 v165, v165
    v_rcp_f32 v166, v166
    v_rcp_f32 v167, v167
    v_rcp_f32 v168, v168
    v_rcp_f32 v169, v169
    s_waitcnt lgkmcnt(0)
    s_add_u32 m0, s71, 81920
    s_add_u32 s77, s87, 122880
    buffer_load_dwordx4 v4, s[28:31], s77 offen lds
    ds_read_b64_tr_b16 v[220:221], v7 offset:32768
    ds_read_b64_tr_b16 v[222:223], v5 offset:16384
    ds_read_b64_tr_b16 v[224:225], v8 offset:32768
    ds_read_b64_tr_b16 v[226:227], v6 offset:16384
    v_rcp_f32 v170, v170
    v_rcp_f32 v171, v171
    v_pk_mul_f32 v[164:165], v[164:165], v[140:141]
    v_pk_mul_f32 v[166:167], v[166:167], v[142:143]
    v_pk_mul_f32 v[168:169], v[168:169], v[144:145]
    v_pk_mul_f32 v[170:171], v[170:171], v[146:147]
    v_cvt_pk_bf16_f32 v160, v164, v165
    v_cvt_pk_bf16_f32 v161, v166, v167
    v_cvt_pk_bf16_f32 v162, v168, v169
    v_cvt_pk_bf16_f32 v163, v170, v171
    s_add_u32 s76, s86, 524288
    buffer_store_dwordx4 v[160:163], v28, s[36:39], s76 offen offset:256 sc1
    s_waitcnt vmcnt(5)
    buffer_store_dword v17, v13, s[36:39], 0 offen offset:16 sc1
    s_setprio 0
    s_mov_b32 s63, 2
    s_cmp_eq_u32 s64, 0
    s_cbranch_scc1 LJFa_0
    s_cmp_eq_u32 s64, 1
    s_cbranch_scc1 LJFa_1
    s_cmp_eq_u32 s64, 2
    s_cbranch_scc1 LJFa_2
    s_cmp_eq_u32 s64, 3
    s_cbranch_scc1 LJFa_3
LJFa_3:
LJFa_4:
LJFa_5:
LJFa_6:
LJFa_ret:
    s_mov_b32 s63, 0
    s_buffer_load_dwordx16 s[4:19], s[36:39], s96 offset:16384 glc
    s_waitcnt vmcnt(1)
    buffer_store_dword v17, v13, s[36:39], 0 offen offset:32 sc1
    s_barrier
    s_waitcnt lgkmcnt(0)
    s_cmp_eq_u64 s[4:5], s[94:95]
    s_cbranch_scc0 Lretry_9i
Lok_8:
    buffer_load_dwordx4 v[100:103], v11, s[36:39], s89 offen offset:0 sc1
    buffer_load_dwordx4 v[104:107], v12, s[36:39], s89 offen offset:0 sc1
    buffer_load_dwordx4 v[108:111], v11, s[36:39], s89 offen offset:1024 sc1
    buffer_load_dwordx4 v[112:115], v12, s[36:39], s89 offen offset:1024 sc1
    s_cmp_eq_u64 s[8:9], s[94:95]
    s_cbranch_scc0 Lretry_11i
Lok_10:
    s_add_u32 s75, s89, 262144
    buffer_load_dwordx4 v[116:119], v11, s[36:39], s75 offen offset:0 sc1
    buffer_load_dwordx4 v[120:123], v12, s[36:39], s75 offen offset:0 sc1
    buffer_load_dwordx4 v[124:127], v11, s[36:39], s75 offen offset:1024 sc1
    buffer_load_dwordx4 v[128:131], v12, s[36:39], s75 offen offset:1024 sc1
    s_cmp_eq_u64 s[12:13], s[94:95]
    s_cselect_b32 s79, 0, 0x40000000
    s_add_u32 s75, s89, 524288
    s_or_b32 s75, s75, s79
    buffer_load_dwordx4 v[132:135], v11, s[36:39], s75 offen offset:0 sc1
    buffer_load_dwordx4 v[136:139], v12, s[36:39], s75 offen offset:0 sc1
    buffer_load_dwordx4 v[140:143], v11, s[36:39], s75 offen offset:1024 sc1
    buffer_load_dwordx4 v[144:147], v12, s[36:39], s75 offen offset:1024 sc1
    s_buffer_load_dwordx16 s[4:19], s[36:39], s96 offset:16384 glc
    s_add_u32 m0, s71, 90112
    s_add_u32 s77, s87, 163840
    s_add_u32 s77, s77, s91
    buffer_load_dwordx4 v4, s[28:31], s77 offen lds
    s_add_u32 m0, s71, 98304
    s_add_u32 s77, s87, 180224
    s_add_u32 s77, s77, s91
    buffer_load_dwordx4 v4, s[28:31], s77 offen lds
    s_add_u32 m0, s71, 16384
    s_add_u32 s77, s87, 172032
    s_add_u32 s77, s77, s91
    buffer_load_dwordx4 v4, s[28:31], s77 offen lds
    s_add_u32 m0, s71, 139264
    s_add_u32 s77, s87, 188416
    s_add_u32 s77, s77, s91
    buffer_load_dwordx4 v4, s[28:31], s77 offen lds
    s_add_u32 m0, s71, 147456
    s_add_u32 s77, s88, 0
    buffer_load_dwordx4 v4, s[40:43], s77 offen lds
    s_add_u32 m0, s71, 49152
    s_add_u32 s77, s88, 16384
    buffer_load_dwordx4 v4, s[40:43], s77 offen lds
    s_add_u32 m0, s71, 57344
    s_add_u32 s77, s88, 8192
    buffer_load_dwordx4 v4, s[40:43], s77 offen lds
    s_add_u32 m0, s71, 155648
    s_add_u32 s77, s88, 24576
    buffer_load_dwordx4 v4, s[40:43], s77 offen lds
    s_waitcnt vmcnt(19)
    v_mfma_f32_32x32x16_bf16 v[36:51], v[196:199], v[100:103], 0
    v_mfma_f32_32x32x16_bf16 v[52:67], v[200:203], v[100:103], 0
    s_waitcnt vmcnt(18)
    v_mfma_f32_32x32x16_bf16 v[68:83], v[196:199], v[104:107], 0
    v_mfma_f32_32x32x16_bf16 v[84:99], v[200:203], v[104:107], 0
    s_waitcnt vmcnt(17)
    v_mfma_f32_32x32x16_bf16 v[36:51], v[204:207], v[108:111], v[36:51]
    v_mfma_f32_32x32x16_bf16 v[52:67], v[208:211], v[108:111], v[52:67]
    s_waitcnt vmcnt(16)
    v_mfma_f32_32x32x16_bf16 v[68:83], v[204:207], v[112:115], v[68:83]
    v_mfma_f32_32x32x16_bf16 v[84:99], v[208:211], v[112:115], v[84:99]
    s_cmp_eq_u32 s79, 0
    s_cbranch_scc0 Lcfix_13i
Lcok_12:
    s_cmp_eq_u64 s[6:7], s[94:95]
    s_cselect_b32 s80, 0, 0x40000000
    s_add_u32 s75, s89, 131072
    s_or_b32 s75, s75, s80
    buffer_load_dwordx4 v[148:151], v11, s[36:39], s75 offen offset:0 sc1
    buffer_load_dwordx4 v[152:155], v12, s[36:39], s75 offen offset:0 sc1
    buffer_load_dwordx4 v[156:159], v11, s[36:39], s75 offen offset:1024 sc1
    buffer_load_dwordx4 v[160:163], v12, s[36:39], s75 offen offset:1024 sc1
    s_buffer_load_dwordx16 s[4:19], s[36:39], s96 offset:16384 glc
    ds_read_b64_tr_b16 v[228:229], v5 offset:24576
    ds_read_b64_tr_b16 v[230:231], v7 offset:40960
    ds_read_b64_tr_b16 v[232:233], v6 offset:24576
    ds_read_b64_tr_b16 v[234:235], v8 offset:40960
    s_waitcnt vmcnt(19)
    v_mfma_f32_32x32x16_bf16 v[36:51], v[212:215], v[116:119], v[36:51]
    v_mfma_f32_32x32x16_bf16 v[52:67], v[216:219], v[116:119], v[52:67]
    s_waitcnt vmcnt(18)
    v_mfma_f32_32x32x16_bf16 v[68:83], v[212:215], v[120:123], v[68:83]
    v_mfma_f32_32x32x16_bf16 v[84:99], v[216:219], v[120:123], v[84:99]
    ds_read_b64_tr_b16 v[236:237], v7 offset:49152
    ds_read_b64_tr_b16 v[238:239], v7 offset:57344
    ds_read_b64_tr_b16 v[240:241], v8 offset:49152
    ds_read_b64_tr_b16 v[242:243], v8 offset:57344
    s_waitcnt vmcnt(17)
    v_mfma_f32_32x32x16_bf16 v[36:51], v[220:223], v[124:127], v[36:51]
    v_mfma_f32_32x32x16_bf16 v[52:67], v[224:227], v[124:127], v[52:67]
    s_waitcnt vmcnt(16)
    v_mfma_f32_32x32x16_bf16 v[68:83], v[220:223], v[128:131], v[68:83]
    v_mfma_f32_32x32x16_bf16 v[84:99], v[224:227], v[128:131], v[84:99]
    s_cmp_eq_u32 s80, 0
    s_cbranch_scc0 Lcfix_15i
Lcok_14:
    s_cmp_eq_u64 s[10:11], s[94:95]
    s_cselect_b32 s81, 0, 0x40000000
    s_add_u32 s75, s89, 393216
    s_or_b32 s75, s75, s81
    buffer_load_dwordx4 v[164:167], v11, s[36:39], s75 offen offset:0 sc1
    buffer_load_dwordx4 v[168:171], v12, s[36:39], s75 offen offset:0 sc1
    buffer_load_dwordx4 v[172:175], v11, s[36:39], s75 offen offset:1024 sc1
LIFa_8:
    s_cmp_eq_u32 s63, 1
    s_cbranch_scc1 LIFa_ret
LJFa_0:
    s_cmp_eq_u32 s63, 2
    s_cbranch_scc1 LJFa_4
    buffer_load_dwordx4 v[176:179], v12, s[36:39], s75 offen offset:1024 sc1
    s_buffer_load_dwordx16 s[4:19], s[36:39], s96 offset:16384 glc
    ds_read_b64_tr_b16 v[244:245], v5 offset:32768
    ds_read_b64_tr_b16 v[246:247], v5 offset:40960
    ds_read_b64_tr_b16 v[248:249], v6 offset:32768
    ds_read_b64_tr_b16 v[250:251], v6 offset:40960
    s_waitcnt vmcnt(8) lgkmcnt(10)
    v_mfma_f32_32x32x16_bf16 v[36:51], v[228:231], v[132:135], v[36:51]
    s_waitcnt lgkmcnt(8)
    v_mfma_f32_32x32x16_bf16 v[52:67], v[232:235], v[132:135], v[52:67]
    s_add_u32 m0, s71, 24576
    s_add_u32 s77, s88, 32768
    buffer_load_dwordx4 v4, s[40:43], s77 offen lds
    v_mfma_f32_32x32x16_bf16 v[68:83], v[228:231], v[136:139], v[68:83]
    s_add_u32 m0, s71, 106496
    s_add_u32 s77, s88, 49152
    buffer_load_dwordx4 v4, s[40:43], s77 offen lds
    v_mfma_f32_32x32x16_bf16 v[84:99], v[232:235], v[136:139], v[84:99]
    ds_read_b64_tr_b16 v[196:197], v9 offset:0
    ds_read_b64_tr_b16 v[198:199], v7 offset:0
    ds_read_b64_tr_b16 v[200:201], v10 offset:0
    ds_read_b64_tr_b16 v[202:203], v8 offset:0
    s_waitcnt lgkmcnt(10)
    v_mfma_f32_32x32x16_bf16 v[36:51], v[236:239], v[140:143], v[36:51]
    s_waitcnt lgkmcnt(8)
    v_mfma_f32_32x32x16_bf16 v[52:67], v[240:243], v[140:143], v[52:67]
    s_add_u32 m0, s71, 114688
    s_add_u32 s77, s88, 40960
    buffer_load_dwordx4 v4, s[40:43], s77 offen lds
    v_mfma_f32_32x32x16_bf16 v[68:83], v[236:239], v[144:147], v[68:83]
    s_add_u32 m0, s71, 122880
    s_add_u32 s77, s88, 57344
    buffer_load_dwordx4 v4, s[40:43], s77 offen lds
    v_mfma_f32_32x32x16_bf16 v[84:99], v[240:243], v[144:147], v[84:99]
    s_cmp_eq_u32 s81, 0
    s_cbranch_scc0 Lcfix_17i
Lcok_16:
    s_cmp_eq_u64 s[14:15], s[94:95]
    s_cselect_b32 s73, 0, 0x40000000
    s_add_u32 s75, s89, 655360
    s_add_u32 s75, s75, s91
    s_or_b32 s75, s75, s73
    buffer_load_dwordx4 v[180:183], v11, s[36:39], s75 offen offset:0 sc1
    buffer_load_dwordx4 v[184:187], v12, s[36:39], s75 offen offset:0 sc1
    buffer_load_dwordx4 v[188:191], v11, s[36:39], s75 offen offset:1024 sc1
    buffer_load_dwordx4 v[192:195], v12, s[36:39], s75 offen offset:1024 sc1
    ds_read_b64_tr_b16 v[204:205], v7 offset:8192
    ds_read_b64_tr_b16 v[206:207], v5 offset:0
    ds_read_b64_tr_b16 v[208:209], v8 offset:8192
    ds_read_b64_tr_b16 v[210:211], v6 offset:0
    s_waitcnt vmcnt(12) lgkmcnt(10)
    v_mfma_f32_32x32x16_bf16 v[36:51], v[244:247], v[148:151], v[36:51]
    s_waitcnt lgkmcnt(8)
    v_mfma_f32_32x32x16_bf16 v[52:67], v[248:251], v[148:151], v[52:67]
    v_mfma_f32_32x32x16_bf16 v[68:83], v[244:247], v[152:155], v[68:83]
    v_mfma_f32_32x32x16_bf16 v[84:99], v[248:251], v[152:155], v[84:99]
    ds_read_b64_tr_b16 v[212:213], v5 offset:8192
    ds_read_b64_tr_b16 v[214:215], v7 offset:16384
    ds_read_b64_tr_b16 v[216:217], v6 offset:8192
    ds_read_b64_tr_b16 v[218:219], v8 offset:16384
    s_waitcnt lgkmcnt(10)
    v_mfma_f32_32x32x16_bf16 v[36:51], v[196:199], v[156:159], v[36:51]
    s_waitcnt lgkmcnt(8)
    v_mfma_f32_32x32x16_bf16 v[52:67], v[200:203], v[156:159], v[52:67]
    v_mfma_f32_32x32x16_bf16 v[68:83], v[196:199], v[160:163], v[68:83]
    v_mfma_f32_32x32x16_bf16 v[84:99], v[200:203], v[160:163], v[84:99]
    s_cmp_eq_u32 s73, 0
    s_cbranch_scc0 Lcfix_19i
Lcok_18:
    s_buffer_load_dwordx4 s[20:23], s[36:39], s96 glc
    ds_read_b64_tr_b16 v[220:221], v7 offset:24576
    ds_read_b64_tr_b16 v[222:223], v7 offset:32768
    ds_read_b64_tr_b16 v[224:225], v8 offset:24576
    ds_read_b64_tr_b16 v[226:227], v8 offset:32768
    s_waitcnt vmcnt(4) lgkmcnt(10)
    v_mfma_f32_32x32x16_bf16 v[36:51], v[204:207], v[164:167], v[36:51]
    s_waitcnt lgkmcnt(8)
    v_mfma_f32_32x32x16_bf16 v[52:67], v[208:211], v[164:167], v[52:67]
    v_mfma_f32_32x32x16_bf16 v[68:83], v[204:207], v[168:171], v[68:83]
    v_mfma_f32_32x32x16_bf16 v[84:99], v[208:211], v[168:171], v[84:99]
    ds_read_b64_tr_b16 v[228:229], v5 offset:16384
    ds_read_b64_tr_b16 v[230:231], v9 offset:8192
    ds_read_b64_tr_b16 v[232:233], v6 offset:16384
    ds_read_b64_tr_b16 v[234:235], v10 offset:8192
    s_waitcnt lgkmcnt(10)
    v_mfma_f32_32x32x16_bf16 v[36:51], v[212:215], v[172:175], v[36:51]
    s_waitcnt lgkmcnt(8)
    v_mfma_f32_32x32x16_bf16 v[52:67], v[216:219], v[172:175], v[52:67]
    v_mfma_f32_32x32x16_bf16 v[68:83], v[212:215], v[176:179], v[68:83]
    v_mfma_f32_32x32x16_bf16 v[84:99], v[216:219], v[176:179], v[84:99]
    s_waitcnt lgkmcnt(0)
    s_cmp_eq_u64 s[20:21], s[94:95]
    s_cbranch_scc0 Lretry_21i
Lok_20:
    buffer_load_dwordx4 v[100:103], v11, s[36:39], s90 offen offset:0 sc1
    buffer_load_dwordx4 v[104:107], v12, s[36:39], s90 offen offset:0 sc1
    buffer_load_dwordx4 v[108:111], v11, s[36:39], s90 offen offset:1024 sc1
    buffer_load_dwordx4 v[112:115], v12, s[36:39], s90 offen offset:1024 sc1
    s_cmp_eq_u64 s[22:23], s[94:95]
    s_cbranch_scc0 Lretry_23i
Lok_22:
    s_add_u32 s75, s90, 131072
    buffer_load_dwordx4 v[116:119], v11, s[36:39], s75 offen offset:0 sc1
    buffer_load_dwordx4 v[120:123], v12, s[36:39], s75 offen offset:0 sc1
    buffer_load_dwordx4 v[124:127], v11, s[36:39], s75 offen offset:1024 sc1
    buffer_load_dwordx4 v[128:131], v12, s[36:39], s75 offen offset:1024 sc1
    buffer_load_dword v18, v29, s[36:39], 0 offen sc1
    ds_read_b64_tr_b16 v[236:237], v9 offset:16384
    ds_read_b64_tr_b16 v[238:239], v5 offset:49152
    ds_read_b64_tr_b16 v[240:241], v10 offset:16384
    ds_read_b64_tr_b16 v[242:243], v6 offset:49152
    s_waitcnt vmcnt(9)
    v_mfma_f32_32x32x16_bf16 v[36:51], v[220:223], v[180:183], v[36:51]
    v_mfma_f32_32x32x16_bf16 v[52:67], v[224:227], v[180:183], v[52:67]
    v_mfma_f32_32x32x16_bf16 v[68:83], v[220:223], v[184:187], v[68:83]
    v_mfma_f32_32x32x16_bf16 v[84:99], v[224:227], v[184:187], v[84:99]
    ds_read_b64_tr_b16 v[244:245], v5 offset:57344
    ds_read_b64_tr_b16 v[246:247], v9 offset:24576
    ds_read_b64_tr_b16 v[248:249], v6 offset:57344
    ds_read_b64_tr_b16 v[250:251], v10 offset:24576
    v_mfma_f32_32x32x16_bf16 v[36:51], v[228:231], v[188:191], v[36:51]
    v_mfma_f32_32x32x16_bf16 v[52:67], v[232:235], v[188:191], v[52:67]
    v_mfma_f32_32x32x16_bf16 v[68:83], v[228:231], v[192:195], v[68:83]
    v_mfma_f32_32x32x16_bf16 v[84:99], v[232:235], v[192:195], v[84:99]
    ds_read_b64_tr_b16 v[196:197], v5 offset:24576
    ds_read_b64_tr_b16 v[198:199], v7 offset:40960
    ds_read_b64_tr_b16 v[200:201], v6 offset:24576
    ds_read_b64_tr_b16 v[202:203], v8 offset:40960
    s_waitcnt vmcnt(8) lgkmcnt(10)
    v_mfma_f32_32x32x16_bf16 v[36:51], v[236:239], v[100:103], v[36:51]
    s_waitcnt lgkmcnt(8)
    v_mfma_f32_32x32x16_bf16 v[52:67], v[240:243], v[100:103], v[52:67]
    s_waitcnt vmcnt(7)
    v_mfma_f32_32x32x16_bf16 v[68:83], v[236:239], v[104:107], v[68:83]
    v_mfma_f32_32x32x16_bf16 v[84:99], v[240:243], v[104:107], v[84:99]
    ds_read_b64_tr_b16 v[204:205], v7 offset:49152
    ds_read_b64_tr_b16 v[206:207], v7 offset:57344
    ds_read_b64_tr_b16 v[208:209], v8 offset:49152
    ds_read_b64_tr_b16 v[210:211], v8 offset:57344
    s_waitcnt vmcnt(6) lgkmcnt(10)
    v_mfma_f32_32x32x16_bf16 v[36:51], v[244:247], v[108:111], v[36:51]
    s_waitcnt lgkmcnt(8)
    v_mfma_f32_32x32x16_bf16 v[52:67], v[248:251], v[108:111], v[52:67]
    s_waitcnt vmcnt(5)
    v_mfma_f32_32x32x16_bf16 v[68:83], v[244:247], v[112:115], v[68:83]
    v_mfma_f32_32x32x16_bf16 v[84:99], v[248:251], v[112:115], v[84:99]
LIFa_9:
    s_cmp_eq_u32 s63, 1
    s_cbranch_scc1 LIFa_ret
LJFa_1:
    s_cmp_eq_u32 s63, 2
    s_cbranch_scc1 LJFa_5
    s_waitcnt vmcnt(4) lgkmcnt(4)
    v_mfma_f32_32x32x16_bf16 v[52:67], v[200:203], v[116:119], v[52:67]
    s_waitcnt vmcnt(2) lgkmcnt(0)
    v_mfma_f32_32x32x16_bf16 v[52:67], v[208:211], v[124:127], v[52:67]
    v_add_u32 v22, s71, v2
    v_add_u32 v23, 0x10000, v22
    s_lshl_b32 s74, s65, 10
    v_add_u32 v20, s74, v2
    v_xor_b32 v5, 0x0, v20
    v_mfma_f32_32x32x16_bf16 v[68:83], v[196:199], v[120:123], v[68:83]
    v_xor_b32 v6, 0x4400, v20
    v_xor_b32 v7, 0xc800, v20
    v_xor_b32 v8, 0x14c00, v20
    s_lshl_b32 s74, s69, 1
    s_lshr_b32 s75, s65, 1
    s_waitcnt vmcnt(1)
    v_mfma_f32_32x32x16_bf16 v[68:83], v[204:207], v[128:131], v[68:83]
    ds_write_b128 v22, v[52:55] offset:16384
    ds_write_b128 v22, v[56:59] offset:24576
    ds_write_b128 v22, v[60:63] offset:32768
    ds_write_b128 v22, v[64:67] offset:40960
    v_mfma_f32_32x32x16_bf16 v[84:99], v[200:203], v[120:123], v[84:99]
    s_add_u32 s74, s74, s75
    s_lshl_b32 s74, s74, 15
    s_lshl_b32 s75, s70, 7
    s_add_u32 s74, s74, s75
    s_and_b32 s75, s65, 1
    s_lshl_b32 s75, s75, 6
    v_mfma_f32_32x32x16_bf16 v[84:99], v[208:211], v[128:131], v[84:99]
    ds_write_b128 v22, v[68:71] offset:49152
    ds_write_b128 v22, v[72:75] offset:57344
    ds_write_b128 v23, v[76:79] offset:0
    ds_write_b128 v23, v[80:83] offset:8192
    v_mfma_f32_32x32x16_bf16 v[36:51], v[196:199], v[116:119], v[36:51]
    s_add_u32 s74, s74, s75
    v_lshrrev_b32 v11, 5, v1
    v_lshlrev_b32 v11, 4, v11
    v_and_b32 v21, 31, v1
    v_lshl_add_u32 v11, v21, 10, v11
    v_lshlrev_b32 v100, 16, v24
    v_mfma_f32_32x32x16_bf16 v[36:51], v[204:207], v[124:127], v[36:51]
    ds_write_b128 v23, v[84:87] offset:16384
    ds_write_b128 v23, v[88:91] offset:24576
    ds_write_b128 v23, v[92:95] offset:32768
    ds_write_b128 v23, v[96:99] offset:40960
    v_and_b32 v101, 0xffff0000, v24
    v_lshlrev_b32 v102, 16, v25
    v_and_b32 v103, 0xffff0000, v25
    v_lshlrev_b32 v104, 16, v26
    v_and_b32 v105, 0xffff0000, v26
    v_lshlrev_b32 v106, 16, v27
    v_and_b32 v107, 0xffff0000, v27
    s_nop 0
    ds_write_b128 v22, v[44:47] offset:0
    s_waitcnt lgkmcnt(12)
    ds_write_b128 v22, v[48:51] offset:8192
    v_pk_add_f32 v[36:37], v[36:37], v[100:101]
    v_pk_add_f32 v[38:39], v[38:39], v[102:103]
    v_pk_add_f32 v[40:41], v[40:41], v[104:105]
    v_pk_add_f32 v[42:43], v[42:43], v[106:107]
    s_waitcnt lgkmcnt(0)
    s_barrier
    ds_read_b128 v[100:103], v6 offset:0
    ds_read_b128 v[108:111], v7 offset:0
    ds_read_b128 v[116:119], v8 offset:0
    ds_read_b128 v[124:127], v5 offset:4096
    ds_read_b128 v[132:135], v6 offset:4096
    ds_read_b128 v[140:143], v7 offset:4096
    ds_read_b128 v[148:151], v8 offset:4096
    ds_read_b128 v[104:107], v6 offset:8192
    ds_read_b128 v[112:115], v7 offset:8192
    ds_read_b128 v[120:123], v8 offset:8192
    ds_read_b128 v[128:131], v5 offset:12288
    ds_read_b128 v[136:139], v6 offset:12288
    ds_read_b128 v[144:147], v7 offset:12288
    s_waitcnt lgkmcnt(12)
    ds_read_b128 v[152:155], v8 offset:12288
    s_waitcnt vmcnt(0)
    v_add_f32 v18, 1.0, v18
    v_rcp_f32 v18, v18
    s_nop 0
    v_mov_b32 v19, v18
    v_pk_add_f32 v[36:37], v[36:37], v[100:101]
    v_pk_add_f32 v[38:39], v[38:39], v[102:103]
    s_waitcnt lgkmcnt(12)
    v_pk_add_f32 v[36:37], v[36:37], v[108:109]
    v_pk_add_f32 v[38:39], v[38:39], v[110:111]
    s_waitcnt lgkmcnt(11)
    v_pk_add_f32 v[36:37], v[36:37], v[116:117]
    v_pk_add_f32 v[38:39], v[38:39], v[118:119]
    s_waitcnt lgkmcnt(10)
    v_pk_add_f32 v[36:37], v[36:37], v[124:125]
    v_pk_add_f32 v[38:39], v[38:39], v[126:127]
    s_waitcnt lgkmcnt(9)
    v_pk_add_f32 v[36:37], v[36:37], v[132:133]
    v_pk_add_f32 v[38:39], v[38:39], v[134:135]
    s_waitcnt lgkmcnt(8)
    v_pk_add_f32 v[36:37], v[36:37], v[140:141]
    v_pk_add_f32 v[38:39], v[38:39], v[142:143]
    s_waitcnt lgkmcnt(7)
    v_pk_add_f32 v[36:37], v[36:37], v[148:149]
    v_pk_add_f32 v[38:39], v[38:39], v[150:151]
    v_pk_mul_f32 v[36:37], v[36:37], v[18:19]
    v_pk_mul_f32 v[38:39], v[38:39], v[18:19]
    v_cvt_pk_bf16_f32 v164, v36, v37
    v_cvt_pk_bf16_f32 v165, v38, v39
    s_waitcnt lgkmcnt(6)
    v_pk_add_f32 v[40:41], v[40:41], v[104:105]
    v_pk_add_f32 v[42:43], v[42:43], v[106:107]
    s_waitcnt lgkmcnt(5)
    v_pk_add_f32 v[40:41], v[40:41], v[112:113]
    v_pk_add_f32 v[42:43], v[42:43], v[114:115]
    s_waitcnt lgkmcnt(4)
    v_pk_add_f32 v[40:41], v[40:41], v[120:121]
    v_pk_add_f32 v[42:43], v[42:43], v[122:123]
    s_waitcnt lgkmcnt(3)
    v_pk_add_f32 v[40:41], v[40:41], v[128:129]
    v_pk_add_f32 v[42:43], v[42:43], v[130:131]
    s_waitcnt lgkmcnt(2)
    v_pk_add_f32 v[40:41], v[40:41], v[136:137]
    v_pk_add_f32 v[42:43], v[42:43], v[138:139]
    s_waitcnt lgkmcnt(1)
    v_pk_add_f32 v[40:41], v[40:41], v[144:145]
    v_pk_add_f32 v[42:43], v[42:43], v[146:147]
    s_waitcnt lgkmcnt(0)
    v_pk_add_f32 v[40:41], v[40:41], v[152:153]
    v_pk_add_f32 v[42:43], v[42:43], v[154:155]
    v_pk_mul_f32 v[40:41], v[40:41], v[18:19]
    v_pk_mul_f32 v[42:43], v[42:43], v[18:19]
    v_cvt_pk_bf16_f32 v166, v40, v41
    v_cvt_pk_bf16_f32 v167, v42, v43
    s_nop 0
    v_permlane32_swap_b32 v164, v166
    v_permlane32_swap_b32 v165, v167
    buffer_store_dwordx4 v[164:167], v11, s[32:35], s74 offen offset:0
    s_endpgm
Lretry_7i:
    s_mov_b32 s0, 20000
Lretry_7:
    s_sub_u32 s0, s0, 1
    s_cbranch_scc1 Lok_6
    s_sleep 1
    s_buffer_load_dword s94, s[24:27], 0 glc
Lretry_7w:
    s_waitcnt lgkmcnt(0)
    s_cmp_lg_u32 s94, 0
    s_cbranch_scc0 Lretry_7
    s_branch Lok_6
Lretry_9i:
    s_mov_b32 s0, 20000
Lretry_9:
    s_sub_u32 s0, s0, 1
    s_cbranch_scc1 Lok_8
    s_sleep 1
    s_buffer_load_dwordx16 s[4:19], s[36:39], s96 offset:16384 glc
Lretry_9w:
    s_waitcnt lgkmcnt(0)
    s_cmp_eq_u64 s[4:5], s[94:95]
    s_cbranch_scc0 Lretry_9
    s_branch Lok_8
Lretry_11i:
    s_mov_b32 s0, 20000
    s_branch Lretry_11w
Lretry_11:
    s_sub_u32 s0, s0, 1
    s_cbranch_scc1 Lok_10
    s_sleep 1
    s_buffer_load_dwordx16 s[4:19], s[36:39], s96 offset:16384 glc
Lretry_11w:
LIFa_10:
    s_cmp_eq_u32 s63, 1
    s_cbranch_scc1 LIFa_ret
LJFa_2:
    s_cmp_eq_u32 s63, 2
    s_cbranch_scc1 LJFa_6
    s_waitcnt lgkmcnt(0)
    s_cmp_eq_u64 s[8:9], s[94:95]
    s_cbranch_scc0 Lretry_11
    s_branch Lok_10
Lcfix_13i:
    s_mov_b32 s0, 20000
    s_branch Lcfix_13w
Lcfix_13:
    s_sub_u32 s0, s0, 1
    s_cbranch_scc1 Lcfix_13g
    s_sleep 1
    s_buffer_load_dwordx16 s[4:19], s[36:39], s96 offset:16384 glc
Lcfix_13w:
    s_waitcnt lgkmcnt(0)
    s_cmp_eq_u64 s[12:13], s[94:95]
    s_cbranch_scc0 Lcfix_13
Lcfix_13g:
    s_add_u32 s75, s89, 524288
    buffer_load_dwordx4 v[132:135], v11, s[36:39], s75 offen offset:0 sc1
    buffer_load_dwordx4 v[136:139], v12, s[36:39], s75 offen offset:0 sc1
    buffer_load_dwordx4 v[140:143], v11, s[36:39], s75 offen offset:1024 sc1
    buffer_load_dwordx4 v[144:147], v12, s[36:39], s75 offen offset:1024 sc1
    s_branch Lcok_12
Lcfix_15i:
    s_mov_b32 s0, 20000
    s_branch Lcfix_15w
Lcfix_15:
    s_sub_u32 s0, s0, 1
    s_cbranch_scc1 Lcfix_15g
    s_sleep 1
    s_buffer_load_dwordx16 s[4:19], s[36:39], s96 offset:16384 glc
Lcfix_15w:
    s_waitcnt lgkmcnt(0)
    s_cmp_eq_u64 s[6:7], s[94:95]
    s_cbranch_scc0 Lcfix_15
Lcfix_15g:
    s_add_u32 s75, s89, 131072
    buffer_load_dwordx4 v[148:151], v11, s[36:39], s75 offen offset:0 sc1
    buffer_load_dwordx4 v[152:155], v12, s[36:39], s75 offen offset:0 sc1
    buffer_load_dwordx4 v[156:159], v11, s[36:39], s75 offen offset:1024 sc1
    buffer_load_dwordx4 v[160:163], v12, s[36:39], s75 offen offset:1024 sc1
    s_branch Lcok_14
Lcfix_17i:
    s_mov_b32 s0, 20000
    s_branch Lcfix_17w
Lcfix_17:
    s_sub_u32 s0, s0, 1
    s_cbranch_scc1 Lcfix_17g
    s_sleep 1
    s_buffer_load_dwordx16 s[4:19], s[36:39], s96 offset:16384 glc
Lcfix_17w:
    s_waitcnt lgkmcnt(0)
    s_cmp_eq_u64 s[10:11], s[94:95]
    s_cbranch_scc0 Lcfix_17
Lcfix_17g:
    s_add_u32 s75, s89, 393216
    buffer_load_dwordx4 v[164:167], v11, s[36:39], s75 offen offset:0 sc1
    buffer_load_dwordx4 v[168:171], v12, s[36:39], s75 offen offset:0 sc1
    buffer_load_dwordx4 v[172:175], v11, s[36:39], s75 offen offset:1024 sc1
    buffer_load_dwordx4 v[176:179], v12, s[36:39], s75 offen offset:1024 sc1
    s_branch Lcok_16
Lcfix_19i:
    s_mov_b32 s0, 20000
    s_branch Lcfix_19w
Lcfix_19:
    s_sub_u32 s0, s0, 1
    s_cbranch_scc1 Lcfix_19g
    s_sleep 1
    s_buffer_load_dwordx16 s[4:19], s[36:39], s96 offset:16384 glc
Lcfix_19w:
    s_waitcnt lgkmcnt(0)
    s_cmp_eq_u64 s[14:15], s[94:95]
    s_cbranch_scc0 Lcfix_19
Lcfix_19g:
    s_add_u32 s75, s89, 655360
    s_add_u32 s75, s75, s91
    buffer_load_dwordx4 v[180:183], v11, s[36:39], s75 offen offset:0 sc1
    buffer_load_dwordx4 v[184:187], v12, s[36:39], s75 offen offset:0 sc1
    buffer_load_dwordx4 v[188:191], v11, s[36:39], s75 offen offset:1024 sc1
    buffer_load_dwordx4 v[192:195], v12, s[36:39], s75 offen offset:1024 sc1
    s_branch Lcok_18
Lretry_21i:
    s_mov_b32 s0, 20000
Lretry_21:
    s_sub_u32 s0, s0, 1
    s_cbranch_scc1 Lok_20
    s_sleep 1
    s_buffer_load_dwordx4 s[20:23], s[36:39], s96 glc
Lretry_21w:
    s_waitcnt lgkmcnt(0)
    s_cmp_eq_u64 s[20:21], s[94:95]
    s_cbranch_scc0 Lretry_21
    s_branch Lok_20
Lretry_23i:
    s_mov_b32 s0, 20000
    s_branch Lretry_23w
Lretry_23:
    s_sub_u32 s0, s0, 1
    s_cbranch_scc1 Lok_22
    s_sleep 1
    s_buffer_load_dwordx4 s[20:23], s[36:39], s96 glc
Lretry_23w:
    s_waitcnt lgkmcnt(0)
    s_cmp_eq_u64 s[22:23], s[94:95]
    s_cbranch_scc0 Lretry_23
    s_branch Lok_22
.p2align 12
L_pathAa:
    s_load_dwordx2 s[12:13], s[0:1], 40
    s_load_dwordx2 s[24:25], s[0:1], 80
    s_load_dwordx2 s[28:29], s[0:1], 48
    s_load_dwordx2 s[40:41], s[0:1], 16
    s_load_dwordx2 s[32:33], s[0:1], 72
    s_load_dwordx2 s[16:17], s[0:1], 56
    v_lshrrev_b32 v20, 3, v1
    v_and_b32 v21, 7, v1
    v_lshrrev_b32 v22, 4, v1
    v_xor_b32 v23, v21, v22
    v_lshlrev_b32 v23, 4, v23
    v_lshl_add_u32 v23, v20, 10, v23
    s_lshl_b32 s76, s66, 3
    s_add_u32 s76, s76, s64
    s_lshl_b32 s77, s76, 14
    v_add_u32 v96, s77, v23
    v_xor_b32 v97, 64, v96
    v_add_u32 v97, 7168, v97
    v_and_b32 v22, 1, v22
    v_lshlrev_b32 v22, 2, v22
    v_xor_b32 v21, v21, v22
    v_lshlrev_b32 v21, 4, v21
    s_and_b32 s62, s92, 7
    s_and_b32 s75, s93, 6
    s_xor_b32 s62, s62, s75
    s_lshl_b32 s62, s62, 7
    s_mul_i32 s75, s62, 1536
    s_lshl_b32 s72, s64, 11
    s_lshl_b32 s71, s64, 10
    s_add_u32 s73, s71, 65536
    s_mov_b32 m0, s72
    s_mov_b32 s6, 0x200000
    s_mov_b32 s7, 0x20000
    s_mov_b32 s10, 0x180000
    s_mov_b32 s11, 0x20000
    s_lshl_b32 s3, s68, 7
    s_mul_i32 s77, s64, 24576
    s_add_u32 s77, s77, s3
    v_mul_u32_u24 v98, 3072, v20
    v_lshl_add_u32 v4, v20, 10, v21
    s_and_b32 s76, s64, 1
    s_lshl_b32 s76, s76, 5
    v_xor_b32 v21, s76, v21
    v_add3_u32 v98, v98, v21, s77
    s_waitcnt lgkmcnt(0)
    buffer_load_dwordx4 v96, s[4:7], s62 offen offset:0 lds
    buffer_load_dwordx4 v97, s[4:7], s62 offen offset:1024 lds
    s_add_u32 m0, s73, -1024
    s_nop 0
    buffer_load_dwordx4 v98, s[8:11], s75 offen offset:1024 lds
    s_add_u32 m0, s73, 6144
    s_nop 0
    buffer_load_dwordx4 v98, s[8:11], s75 offen offset:2048 lds
    s_add_u32 m0, s73, 16384
    s_nop 0
    buffer_load_dwordx4 v98, s[8:11], s75 offen offset:0 lds
    s_lshl_b32 s76, s2, 3
    s_add_u32 s76, s76, s64
    s_lshl_b32 s77, s76, 10
    s_add_u32 s77, s77, 0x800000
    s_lshl_b32 s76, s76, 7
    s_add_u32 s76, s76, 0x77a000
    s_cmp_lt_u32 s2, 64
    s_cselect_b32 s76, s77, s76
    s_cmp_lt_u32 s2, 80
    s_cbranch_scc0 Lnop_24
    s_load_dword s95, s[36:37], s76 glc
Lnop_24:
    s_mov_b32 s63, 1
    s_and_b32 s76, s93, 3
    s_lshl_b32 s76, s76, 2
    s_add_u32 s76, s76, s64
    s_cmp_eq_u32 s76, 0
    s_cbranch_scc1 LIAa_0
    s_cmp_eq_u32 s76, 1
    s_cbranch_scc1 LIAa_1
    s_cmp_eq_u32 s76, 2
    s_cbranch_scc1 LIAa_2
    s_cmp_eq_u32 s76, 3
    s_cbranch_scc1 LIAa_3
    s_cmp_eq_u32 s76, 4
    s_cbranch_scc1 LIAa_4
    s_cmp_eq_u32 s76, 5
    s_cbranch_scc1 LIAa_5
    s_cmp_eq_u32 s76, 6
    s_cbranch_scc1 LIAa_6
    s_cmp_eq_u32 s76, 7
    s_cbranch_scc1 LIAa_7
    s_cmp_eq_u32 s76, 8
    s_cbranch_scc1 LIAa_8
    s_cmp_eq_u32 s76, 9
    s_cbranch_scc1 LIAa_9
    s_cmp_eq_u32 s76, 10
    s_cbranch_scc1 LIAa_10
    s_cmp_eq_u32 s76, 11
    s_cbranch_scc1 LIAa_11
    s_cmp_eq_u32 s76, 12
    s_cbranch_scc1 LIAa_12
LIAa_11:
LIAa_12:
LIAa_ret:
    s_mov_b32 s63, 0
    s_barrier
    s_add_u32 m0, s72, 16384
    s_xor_b32 s74, s62, 128
    buffer_load_dwordx4 v96, s[4:7], s74 offen offset:0 lds
    buffer_load_dwordx4 v97, s[4:7], s74 offen offset:1024 lds
    s_add_u32 m0, s73, 23552
    s_xor_b32 s75, s62, 128
    s_mul_i32 s75, s75, 1536
    buffer_load_dwordx4 v98, s[8:11], s75 offen offset:1024 lds
    s_add_u32 m0, s73, 30720
    s_nop 0
    buffer_load_dwordx4 v98, s[8:11], s75 offen offset:2048 lds
    s_add_u32 m0, s73, 40960
    s_nop 0
    buffer_load_dwordx4 v98, s[8:11], s75 offen offset:0 lds
    s_and_b32 s65, s64, 3
    v_and_b32 v20, 15, v1
    v_lshrrev_b32 v21, 4, v1
    v_bfe_u32 v22, v1, 1, 3
    v_xor_b32 v22, v22, v21
    v_lshlrev_b32 v22, 4, v22
    v_lshl_add_u32 v22, v20, 7, v22
    s_lshl_b32 s76, s65, 12
    v_add_u32 v180, s76, v22
    v_xor_b32 v181, 64, v180
    v_bfe_u32 v20, v1, 2, 2
    v_and_b32 v22, 3, v1
    v_lshlrev_b32 v22, 3, v22
    v_bfe_u32 v23, v1, 4, 1
    v_lshl_add_u32 v22, v23, 5, v22
    v_bfe_u32 v23, v1, 3, 1
    v_lshl_add_u32 v22, v23, 6, v22
    v_lshl_add_u32 v22, v20, 7, v22
    v_lshl_add_u32 v23, v21, 10, v22
    v_xor_b32 v182, 0x10000, v23
    v_add_u32 v183, 49152, v182
    v_xor_b32 v184, 32, v182
    v_xor_b32 v185, 32, v183
    v_lshrrev_b32 v21, 5, v1
    v_lshl_add_u32 v5, v21, 9, v22
    v_lshlrev_b32 v2, 4, v1
    v_mov_b32 v33, 0
    s_mov_b32 s38, 0x900080
    s_mov_b32 s39, 0x20000
    s_mov_b32 s26, 0x100
    s_mov_b32 s27, 0x20000
    s_lshl_b32 s80, s66, 2
    s_add_u32 s80, s80, s65
    s_lshl_b32 s79, s80, 11
    v_and_b32 v20, 15, v1
    v_lshrrev_b32 v22, 4, v1
    v_lshlrev_b32 v22, 9, v22
    v_lshl_add_u32 v22, v20, 4, v22
    v_add_u32 v28, s79, v22
    s_lshr_b32 s79, s68, 1
    s_lshl_b32 s79, s79, 13
    s_lshl_b32 s80, s80, 7
    s_add_u32 s79, s79, s80
    s_add_u32 s79, s79, 0x798000
    v_and_b32 v20, 15, v1
    v_lshl_add_u32 v35, v20, 2, s79
    s_lshl_b32 s86, s68, 18
    s_lshl_b32 s69, s92, 2
    s_and_b32 s79, s93, 3
    s_add_u32 s69, s69, s79
    s_lshr_b32 s70, s93, 2
    s_lshl_b32 s79, s70, 7
    v_add_u32 v4, s79, v4
    s_waitcnt lgkmcnt(0)
    s_waitcnt vmcnt(5)
    s_barrier
    ds_read_b128 v[72:75], v180 offset:0
    ds_read_b64_tr_b16 v[36:37], v182 offset:0
    ds_read_b64_tr_b16 v[38:39], v182 offset:512
    ds_read_b64_tr_b16 v[40:41], v182 offset:8192
    ds_read_b64_tr_b16 v[42:43], v182 offset:8704
    ds_read_b64_tr_b16 v[44:45], v182 offset:16384
    ds_read_b64_tr_b16 v[46:47], v182 offset:16896
    ds_read_b128 v[76:79], v180 offset:2048
    ds_read_b64_tr_b16 v[48:49], v184 offset:0
    ds_read_b64_tr_b16 v[50:51], v184 offset:512
    ds_read_b64_tr_b16 v[52:53], v184 offset:8192
    ds_read_b64_tr_b16 v[54:55], v184 offset:8704
    ds_read_b64_tr_b16 v[56:57], v184 offset:16384
LIAa_0:
    s_cmp_eq_u32 s63, 1
    s_cbranch_scc1 LIAa_ret
    ds_read_b64_tr_b16 v[58:59], v184 offset:16896
    s_waitcnt lgkmcnt(11)
    v_mfma_f32_16x16x32_bf16 v[100:103], v[72:75], v[36:39], 0
    ds_read_b128 v[80:83], v181 offset:0
    ds_read_b64_tr_b16 v[60:61], v182 offset:4096
    s_waitcnt lgkmcnt(8)
    v_mfma_f32_16x16x32_bf16 v[104:107], v[76:79], v[36:39], 0
    ds_read_b64_tr_b16 v[62:63], v182 offset:4608
    s_add_u32 m0, s72, 32768
    s_xor_b32 s74, s62, 256
    buffer_load_dwordx4 v96, s[4:7], s74 offen offset:0 lds
    s_mov_b32 s30, 0x158000
    s_mov_b32 s31, 0x20000
    v_mfma_f32_16x16x32_bf16 v[116:119], v[72:75], v[40:43], 0
    ds_read_b64_tr_b16 v[64:65], v182 offset:12288
    ds_read_b64_tr_b16 v[66:67], v182 offset:12800
    v_mfma_f32_16x16x32_bf16 v[120:123], v[76:79], v[40:43], 0
    s_mov_b32 s42, 0x80000
    s_mov_b32 s43, 0x20000
    v_mfma_f32_16x16x32_bf16 v[132:135], v[44:47], v[72:75], 0
    ds_read_b64_tr_b16 v[68:69], v182 offset:20480
    ds_read_b64_tr_b16 v[70:71], v182 offset:20992
    v_mfma_f32_16x16x32_bf16 v[140:143], v[44:47], v[76:79], 0
    s_mul_i32 s79, s64, 5
    s_min_u32 s80, s64, 3
    s_add_u32 s79, s79, s80
    s_lshl_b32 s87, s79, 15
    s_add_u32 s79, s79, 16
    s_lshl_b32 s89, s79, 17
    s_waitcnt lgkmcnt(11)
    v_mfma_f32_16x16x32_bf16 v[108:111], v[72:75], v[48:51], 0
    ds_read_b128 v[84:87], v181 offset:2048
    ds_read_b64_tr_b16 v[36:37], v184 offset:4096
    v_mfma_f32_16x16x32_bf16 v[112:115], v[76:79], v[48:51], 0
    ds_read_b64_tr_b16 v[38:39], v184 offset:4608
    buffer_load_dwordx4 v97, s[4:7], s74 offen offset:1024 lds
    s_cmp_lt_u32 s64, 3
    s_cselect_b32 s91, 0, 0x40000000
    s_waitcnt lgkmcnt(12)
    v_mfma_f32_16x16x32_bf16 v[124:127], v[72:75], v[52:55], 0
    ds_read_b64_tr_b16 v[40:41], v184 offset:12288
    ds_read_b64_tr_b16 v[42:43], v184 offset:12800
    v_mfma_f32_16x16x32_bf16 v[128:131], v[76:79], v[52:55], 0
    s_add_u32 m0, s73, 48128
    s_xor_b32 s75, s62, 256
    s_mul_i32 s75, s75, 1536
    buffer_load_dwordx4 v98, s[8:11], s75 offen offset:1024 lds
    s_lshl_b32 s88, s64, 16
    s_lshl_b32 s90, s64, 18
    s_waitcnt lgkmcnt(12)
    v_mfma_f32_16x16x32_bf16 v[136:139], v[56:59], v[72:75], 0
    ds_read_b64_tr_b16 v[44:45], v184 offset:20480
    ds_read_b64_tr_b16 v[46:47], v184 offset:20992
    v_mfma_f32_16x16x32_bf16 v[144:147], v[56:59], v[76:79], 0
    s_mov_b32 s82, 0x3fb8aa3b
    s_mov_b32 s83, 0x3fb8aa3b
    s_waitcnt vmcnt(3) lgkmcnt(0)
    s_barrier
    v_mfma_f32_16x16x32_bf16 v[100:103], v[80:83], v[60:63], v[100:103]
    ds_read_b128 v[72:75], v180 offset:16384
    ds_read_b64_tr_b16 v[48:49], v182 offset:24576
    v_mfma_f32_16x16x32_bf16 v[104:107], v[84:87], v[60:63], v[104:107]
    ds_read_b64_tr_b16 v[50:51], v182 offset:25088
    s_add_u32 m0, s73, 55296
    s_nop 0
    buffer_load_dwordx4 v98, s[8:11], s75 offen offset:2048 lds
    s_lshr_b32 s79, s65, 1
    s_add_u32 s79, s79, s65
    s_lshl_b32 s79, s79, 13
    s_add_u32 s79, s79, 114688
    v_add_u32 v34, s79, v2
    v_lshl_add_u32 v34, v21, 9, v34
    v_mfma_f32_16x16x32_bf16 v[116:119], v[80:83], v[64:67], v[116:119]
    ds_read_b64_tr_b16 v[52:53], v182 offset:32768
    ds_read_b64_tr_b16 v[54:55], v182 offset:33280
    v_mfma_f32_16x16x32_bf16 v[120:123], v[84:87], v[64:67], v[120:123]
    s_add_u32 s79, s71, 114688
    v_lshl_add_u32 v188, v1, 2, s79
    s_add_u32 s79, s79, 512
    v_bfe_u32 v189, v1, 2, 1
    v_and_b32 v190, 3, v1
    v_lshlrev_b32 v190, 2, v190
    v_lshl_add_u32 v189, v189, 8, v190
    v_add_u32 v189, s79, v189
    v_mfma_f32_16x16x32_bf16 v[132:135], v[68:71], v[80:83], v[132:135]
    ds_read_b64_tr_b16 v[56:57], v182 offset:40960
    ds_read_b64_tr_b16 v[58:59], v182 offset:41472
    v_mfma_f32_16x16x32_bf16 v[140:143], v[68:71], v[84:87], v[140:143]
    v_cmp_gt_u32 vcc, 8, v1
    v_lshlrev_b32 v190, 2, v1
    v_mov_b32 v191, 0x40000000
    v_cndmask_b32 v191, v191, v190, vcc
    v_mfma_f32_16x16x32_bf16 v[108:111], v[80:83], v[36:39], v[108:111]
    ds_read_b128 v[76:79], v180 offset:18432
    ds_read_b64_tr_b16 v[60:61], v184 offset:24576
    v_mfma_f32_16x16x32_bf16 v[112:115], v[84:87], v[36:39], v[112:115]
    ds_read_b64_tr_b16 v[62:63], v184 offset:25088
    s_add_u32 m0, s73, 65536
    s_nop 0
    buffer_load_dwordx4 v98, s[8:11], s75 offen offset:0 lds
    s_lshl_b32 s79, s68, 3
    s_add_u32 s79, s79, s64
    s_mul_i32 s78, s79, 576
    s_add_u32 s78, s78, 0x780000
    v_mfma_f32_16x16x32_bf16 v[124:127], v[80:83], v[40:43], v[124:127]
    ds_read_b64_tr_b16 v[64:65], v184 offset:32768
    ds_read_b64_tr_b16 v[66:67], v184 offset:33280
    v_mfma_f32_16x16x32_bf16 v[128:131], v[84:87], v[40:43], v[128:131]
    s_add_u32 m0, s72, 49152
    s_xor_b32 s74, s62, 384
    buffer_load_dwordx4 v96, s[4:7], s74 offen offset:0 lds
    s_mul_i32 s79, s68, 4608
    s_add_u32 s79, s79, 0x780000
    v_mul_u32_u24 v22, 576, v21
    v_add_u32 v22, s79, v22
    v_and_b32 v20, 31, v1
    v_lshl_add_u32 v32, v20, 4, v22
    v_and_b32 v20, 16, v1
    v_add_u32 v22, v20, v22
    v_and_b32 v20, 1, v1
    v_mul_u32_u24 v20, 1152, v20
    v_add_u32 v15, v20, v22
    v_mfma_f32_16x16x32_bf16 v[136:139], v[44:47], v[80:83], v[136:139]
    ds_read_b64_tr_b16 v[68:69], v184 offset:40960
    ds_read_b64_tr_b16 v[70:71], v184 offset:41472
    v_mfma_f32_16x16x32_bf16 v[144:147], v[44:47], v[84:87], v[144:147]
    s_lshl_b32 s81, s66, 15
    s_lshr_b32 s79, s65, 1
    s_lshl_b32 s79, s79, 10
    s_add_u32 s81, s81, s79
    s_and_b32 s79, s65, 1
    s_lshl_b32 s79, s79, 2
    s_add_u32 s81, s81, s79
    s_add_u32 s81, s81, 0x800000
    s_waitcnt lgkmcnt(11)
    v_mfma_f32_16x16x32_bf16 v[100:103], v[72:75], v[48:51], v[100:103]
    ds_read_b128 v[80:83], v181 offset:16384
    ds_read_b64_tr_b16 v[36:37], v182 offset:28672
    s_waitcnt lgkmcnt(8)
    v_mfma_f32_16x16x32_bf16 v[104:107], v[76:79], v[48:51], v[104:107]
    ds_read_b64_tr_b16 v[38:39], v182 offset:29184
    buffer_load_dwordx4 v97, s[4:7], s74 offen offset:1024 lds
    s_lshl_b32 s79, s67, 11
    s_add_u32 s79, s79, s81
    v_mov_b32 v13, s79
    v_mfma_f32_16x16x32_bf16 v[116:119], v[72:75], v[52:55], v[116:119]
    ds_read_b64_tr_b16 v[40:41], v182 offset:36864
    ds_read_b64_tr_b16 v[42:43], v182 offset:37376
    v_mfma_f32_16x16x32_bf16 v[120:123], v[76:79], v[52:55], v[120:123]
    s_lshl_b32 s79, s67, 11
    s_add_u32 s79, s79, s81
    s_andn2_b32 s85, s79, 7
    v_mfma_f32_16x16x32_bf16 v[132:135], v[56:59], v[72:75], v[132:135]
    ds_read_b64_tr_b16 v[44:45], v182 offset:45056
LIAa_1:
    s_cmp_eq_u32 s63, 1
    s_cbranch_scc1 LIAa_ret
    ds_read_b64_tr_b16 v[46:47], v182 offset:45568
    v_mfma_f32_16x16x32_bf16 v[140:143], v[56:59], v[76:79], v[140:143]
    s_and_b32 s79, s64, 1
    s_lshl_b32 s79, s79, 6
    s_add_u32 s79, s79, s71
    v_xor_b32 v5, s79, v5
    v_xor_b32 v6, 64, v5
    v_lshlrev_b32 v206, 7, v1
    v_mov_b32 v207, 0x40000000
    v_cmp_gt_u32 vcc, 8, v1
    s_lshl_b32 s76, s2, 3
    s_add_u32 s76, s76, s64
    v_cndmask_b32 v206, v207, v206, vcc
    s_lshl_b32 s76, s76, 10
    s_sub_u32 s77, s76, 1409024
    s_cbranch_scc0 Ltu_25
    buffer_load_dword v207, v206, s[28:31], s76 offen
    s_branch Ltv_26
Ltu_25:
    buffer_load_dword v207, v206, s[40:43], s77 offen
Ltv_26:
    s_mov_b32 s18, 0x400
    s_mov_b32 s19, 0x20000
    s_lshl_b32 s79, s70, 7
    s_and_b32 s80, s65, 1
    s_lshl_b32 s80, s80, 6
    s_add_u32 s79, s79, s80
    v_lshlrev_b32 v22, 3, v21
    buffer_load_dwordx2 v[24:25], v22, s[16:19], s79 offen offset:0
    buffer_load_dwordx2 v[26:27], v22, s[16:19], s79 offen offset:16
    s_waitcnt lgkmcnt(11)
    v_mfma_f32_16x16x32_bf16 v[108:111], v[72:75], v[60:63], v[108:111]
    ds_read_b128 v[84:87], v181 offset:18432
    ds_read_b64_tr_b16 v[48:49], v184 offset:28672
    v_mfma_f32_16x16x32_bf16 v[112:115], v[76:79], v[60:63], v[112:115]
    ds_read_b64_tr_b16 v[50:51], v184 offset:29184
    s_add_u32 m0, s73, 72704
    s_xor_b32 s75, s62, 384
    s_mul_i32 s75, s75, 1536
    buffer_load_dwordx4 v98, s[8:11], s75 offen offset:1024 lds
    v_add_u32 v7, 0x10000, v5
    v_add_u32 v8, 0x10000, v6
    s_waitcnt lgkmcnt(12)
    v_mfma_f32_16x16x32_bf16 v[124:127], v[72:75], v[64:67], v[124:127]
    ds_read_b64_tr_b16 v[52:53], v184 offset:36864
    ds_read_b64_tr_b16 v[54:55], v184 offset:37376
    v_mfma_f32_16x16x32_bf16 v[128:131], v[76:79], v[64:67], v[128:131]
    s_add_u32 m0, s73, 79872
    s_nop 0
    buffer_load_dwordx4 v98, s[8:11], s75 offen offset:2048 lds
    v_add_u32 v9, 0x10000, v7
    v_add_u32 v10, 0x10000, v8
    s_waitcnt lgkmcnt(12)
    v_mfma_f32_16x16x32_bf16 v[136:139], v[68:71], v[72:75], v[136:139]
    ds_read_b64_tr_b16 v[56:57], v184 offset:45056
    ds_read_b64_tr_b16 v[58:59], v184 offset:45568
    v_mfma_f32_16x16x32_bf16 v[144:147], v[68:71], v[76:79], v[144:147]
    s_mov_b32 s34, 0x200000
    s_mov_b32 s35, 0x20000
    s_waitcnt vmcnt(7) lgkmcnt(0)
    s_barrier
    v_mfma_f32_16x16x32_bf16 v[100:103], v[80:83], v[36:39], v[100:103]
    ds_read_b128 v[72:75], v180 offset:32768
    ds_read_b64_tr_b16 v[60:61], v183 offset:0
    v_mfma_f32_16x16x32_bf16 v[104:107], v[84:87], v[36:39], v[104:107]
    ds_read_b64_tr_b16 v[62:63], v183 offset:512
    s_add_u32 m0, s73, 90112
    s_nop 0
    buffer_load_dwordx4 v98, s[8:11], s75 offen offset:0 lds
    s_lshl_b32 s79, s69, 1
    s_lshr_b32 s80, s65, 1
    s_add_u32 s79, s79, s80
    s_lshl_b32 s80, s79, 11
    v_add_u32 v11, s80, v2
    v_xor_b32 v12, 2048, v11
    s_lshl_b32 s79, s79, 7
    s_lshr_b32 s80, s64, 1
    s_lshl_b32 s80, s80, 13
    s_add_u32 s79, s79, s80
    s_add_u32 s79, s79, 0x798000
    v_and_b32 v20, 31, v1
    v_lshl_add_u32 v29, v20, 2, s79
    v_mfma_f32_16x16x32_bf16 v[116:119], v[80:83], v[40:43], v[116:119]
    ds_read_b64_tr_b16 v[64:65], v183 offset:8192
    ds_read_b64_tr_b16 v[66:67], v183 offset:8704
    v_mfma_f32_16x16x32_bf16 v[120:123], v[84:87], v[40:43], v[120:123]
    s_lshr_b32 s79, s69, 1
    s_lshl_b32 s79, s79, 15
    s_and_b32 s80, s69, 1
    s_lshl_b32 s80, s80, 10
    s_add_u32 s79, s79, s80
    s_add_u32 s79, s79, 0x800000
    s_add_u32 s96, s79, s72
    v_mfma_f32_16x16x32_bf16 v[132:135], v[44:47], v[80:83], v[132:135]
    ds_read_b64_tr_b16 v[68:69], v183 offset:16384
    ds_read_b64_tr_b16 v[70:71], v183 offset:16896
    v_mfma_f32_16x16x32_bf16 v[140:143], v[44:47], v[84:87], v[140:143]
    v_mfma_f32_16x16x32_bf16 v[108:111], v[80:83], v[48:51], v[108:111]
    ds_read_b128 v[76:79], v180 offset:34816
    ds_read_b64_tr_b16 v[36:37], v185 offset:0
    v_mfma_f32_16x16x32_bf16 v[112:115], v[84:87], v[48:51], v[112:115]
    ds_read_b64_tr_b16 v[38:39], v185 offset:512
    s_add_u32 m0, s72, 0
    s_xor_b32 s74, s62, 512
    buffer_load_dwordx4 v96, s[4:7], s74 offen offset:0 lds
    v_mfma_f32_16x16x32_bf16 v[124:127], v[80:83], v[52:55], v[124:127]
    ds_read_b64_tr_b16 v[40:41], v185 offset:8192
    ds_read_b64_tr_b16 v[42:43], v185 offset:8704
    v_mfma_f32_16x16x32_bf16 v[128:131], v[84:87], v[52:55], v[128:131]
    buffer_load_dwordx4 v97, s[4:7], s74 offen offset:1024 lds
    v_mfma_f32_16x16x32_bf16 v[136:139], v[56:59], v[80:83], v[136:139]
    ds_read_b64_tr_b16 v[44:45], v185 offset:16384
    ds_read_b64_tr_b16 v[46:47], v185 offset:16896
    v_mfma_f32_16x16x32_bf16 v[144:147], v[56:59], v[84:87], v[144:147]
    s_waitcnt lgkmcnt(11)
    v_mfma_f32_16x16x32_bf16 v[100:103], v[72:75], v[60:63], v[100:103]
    ds_read_b128 v[80:83], v181 offset:32768
    ds_read_b64_tr_b16 v[48:49], v183 offset:4096
    s_waitcnt lgkmcnt(8)
    v_mfma_f32_16x16x32_bf16 v[104:107], v[76:79], v[60:63], v[104:107]
    ds_read_b64_tr_b16 v[50:51], v183 offset:4608
    s_add_u32 m0, s73, -1024
    s_xor_b32 s75, s62, 512
    s_mul_i32 s75, s75, 1536
    buffer_load_dwordx4 v98, s[8:11], s75 offen offset:1024 lds
    v_mfma_f32_16x16x32_bf16 v[116:119], v[72:75], v[64:67], v[116:119]
    ds_read_b64_tr_b16 v[52:53], v183 offset:12288
    ds_read_b64_tr_b16 v[54:55], v183 offset:12800
    v_mfma_f32_16x16x32_bf16 v[120:123], v[76:79], v[64:67], v[120:123]
    v_mfma_f32_16x16x32_bf16 v[132:135], v[68:71], v[72:75], v[132:135]
    ds_read_b64_tr_b16 v[56:57], v183 offset:20480
    ds_read_b64_tr_b16 v[58:59], v183 offset:20992
    v_mfma_f32_16x16x32_bf16 v[140:143], v[68:71], v[76:79], v[140:143]
    s_waitcnt lgkmcnt(11)
    v_mfma_f32_16x16x32_bf16 v[108:111], v[72:75], v[36:39], v[108:111]
    ds_read_b128 v[84:87], v181 offset:34816
    ds_read_b64_tr_b16 v[60:61], v185 offset:4096
    v_mfma_f32_16x16x32_bf16 v[112:115], v[76:79], v[36:39], v[112:115]
    ds_read_b64_tr_b16 v[62:63], v185 offset:4608
    s_add_u32 m0, s73, 6144
    s_nop 0
    buffer_load_dwordx4 v98, s[8:11], s75 offen offset:2048 lds
    s_waitcnt lgkmcnt(12)
    v_mfma_f32_16x16x32_bf16 v[124:127], v[72:75], v[40:43], v[124:127]
    ds_read_b64_tr_b16 v[64:65], v185 offset:12288
    ds_read_b64_tr_b16 v[66:67], v185 offset:12800
    v_mfma_f32_16x16x32_bf16 v[128:131], v[76:79], v[40:43], v[128:131]
    s_add_u32 m0, s72, 16384
    s_xor_b32 s74, s62, 640
    buffer_load_dwordx4 v96, s[4:7], s74 offen offset:0 lds
    s_waitcnt lgkmcnt(12)
    v_mfma_f32_16x16x32_bf16 v[136:139], v[44:47], v[72:75], v[136:139]
    ds_read_b64_tr_b16 v[68:69], v185 offset:20480
LIAa_2:
    s_cmp_eq_u32 s63, 1
    s_cbranch_scc1 LIAa_ret
    ds_read_b64_tr_b16 v[70:71], v185 offset:20992
    v_mfma_f32_16x16x32_bf16 v[144:147], v[44:47], v[76:79], v[144:147]
    s_waitcnt vmcnt(5) lgkmcnt(0)
    s_barrier
    v_mfma_f32_16x16x32_bf16 v[100:103], v[80:83], v[48:51], v[100:103]
    ds_read_b128 v[72:75], v180 offset:49152
    ds_read_b64_tr_b16 v[36:37], v183 offset:24576
    v_mfma_f32_16x16x32_bf16 v[104:107], v[84:87], v[48:51], v[104:107]
    ds_read_b64_tr_b16 v[38:39], v183 offset:25088
    buffer_load_dwordx4 v97, s[4:7], s74 offen offset:1024 lds
    v_mfma_f32_16x16x32_bf16 v[116:119], v[80:83], v[52:55], v[116:119]
    ds_read_b64_tr_b16 v[40:41], v183 offset:32768
    ds_read_b64_tr_b16 v[42:43], v183 offset:33280
    v_mfma_f32_16x16x32_bf16 v[120:123], v[84:87], v[52:55], v[120:123]
    v_mfma_f32_16x16x32_bf16 v[132:135], v[56:59], v[80:83], v[132:135]
    ds_read_b64_tr_b16 v[44:45], v183 offset:40960
    ds_read_b64_tr_b16 v[46:47], v183 offset:41472
    v_mfma_f32_16x16x32_bf16 v[140:143], v[56:59], v[84:87], v[140:143]
    v_mfma_f32_16x16x32_bf16 v[108:111], v[80:83], v[60:63], v[108:111]
    ds_read_b128 v[76:79], v180 offset:51200
    ds_read_b64_tr_b16 v[48:49], v185 offset:24576
    v_mfma_f32_16x16x32_bf16 v[112:115], v[84:87], v[60:63], v[112:115]
    ds_read_b64_tr_b16 v[50:51], v185 offset:25088
    s_add_u32 m0, s73, 23552
    s_xor_b32 s75, s62, 640
    s_mul_i32 s75, s75, 1536
    buffer_load_dwordx4 v98, s[8:11], s75 offen offset:1024 lds
    v_mfma_f32_16x16x32_bf16 v[124:127], v[80:83], v[64:67], v[124:127]
    ds_read_b64_tr_b16 v[52:53], v185 offset:32768
    ds_read_b64_tr_b16 v[54:55], v185 offset:33280
    v_mfma_f32_16x16x32_bf16 v[128:131], v[84:87], v[64:67], v[128:131]
    s_add_u32 m0, s73, 30720
    s_nop 0
    buffer_load_dwordx4 v98, s[8:11], s75 offen offset:2048 lds
    v_mfma_f32_16x16x32_bf16 v[136:139], v[68:71], v[80:83], v[136:139]
    ds_read_b64_tr_b16 v[56:57], v185 offset:40960
    ds_read_b64_tr_b16 v[58:59], v185 offset:41472
    v_mfma_f32_16x16x32_bf16 v[144:147], v[68:71], v[84:87], v[144:147]
    s_waitcnt lgkmcnt(11)
    v_mfma_f32_16x16x32_bf16 v[100:103], v[72:75], v[36:39], v[100:103]
    ds_read_b128 v[80:83], v181 offset:49152
    ds_read_b64_tr_b16 v[60:61], v183 offset:28672
    s_waitcnt lgkmcnt(8)
    v_mfma_f32_16x16x32_bf16 v[104:107], v[76:79], v[36:39], v[104:107]
    ds_read_b64_tr_b16 v[62:63], v183 offset:29184
    s_add_u32 m0, s72, 32768
    s_xor_b32 s74, s62, 768
    buffer_load_dwordx4 v96, s[4:7], s74 offen offset:0 lds
    v_mfma_f32_16x16x32_bf16 v[116:119], v[72:75], v[40:43], v[116:119]
    ds_read_b64_tr_b16 v[64:65], v183 offset:36864
    ds_read_b64_tr_b16 v[66:67], v183 offset:37376
    v_mfma_f32_16x16x32_bf16 v[120:123], v[76:79], v[40:43], v[120:123]
    v_mfma_f32_16x16x32_bf16 v[132:135], v[44:47], v[72:75], v[132:135]
    ds_read_b64_tr_b16 v[68:69], v183 offset:45056
    ds_read_b64_tr_b16 v[70:71], v183 offset:45568
    v_mfma_f32_16x16x32_bf16 v[140:143], v[44:47], v[76:79], v[140:143]
    s_waitcnt lgkmcnt(11)
    v_mfma_f32_16x16x32_bf16 v[108:111], v[72:75], v[48:51], v[108:111]
    ds_read_b128 v[84:87], v181 offset:51200
    ds_read_b64_tr_b16 v[36:37], v185 offset:28672
    v_mfma_f32_16x16x32_bf16 v[112:115], v[76:79], v[48:51], v[112:115]
    ds_read_b64_tr_b16 v[38:39], v185 offset:29184
    buffer_load_dwordx4 v97, s[4:7], s74 offen offset:1024 lds
    s_waitcnt lgkmcnt(12)
    v_mfma_f32_16x16x32_bf16 v[124:127], v[72:75], v[52:55], v[124:127]
    ds_read_b64_tr_b16 v[40:41], v185 offset:36864
    ds_read_b64_tr_b16 v[42:43], v185 offset:37376
    v_mfma_f32_16x16x32_bf16 v[128:131], v[76:79], v[52:55], v[128:131]
    s_add_u32 m0, s73, 48128
    s_xor_b32 s75, s62, 768
    s_mul_i32 s75, s75, 1536
    buffer_load_dwordx4 v98, s[8:11], s75 offen offset:1024 lds
    s_waitcnt lgkmcnt(12)
    v_mfma_f32_16x16x32_bf16 v[136:139], v[56:59], v[72:75], v[136:139]
    ds_read_b64_tr_b16 v[44:45], v185 offset:45056
    ds_read_b64_tr_b16 v[46:47], v185 offset:45568
    v_mfma_f32_16x16x32_bf16 v[144:147], v[56:59], v[76:79], v[144:147]
    s_waitcnt vmcnt(7) lgkmcnt(0)
    s_barrier
    v_mfma_f32_16x16x32_bf16 v[100:103], v[80:83], v[60:63], v[100:103]
    ds_read_b128 v[192:195], v180 offset:0
    ds_read_b64_tr_b16 v[48:49], v182 offset:0
    v_mfma_f32_16x16x32_bf16 v[104:107], v[84:87], v[60:63], v[104:107]
    ds_read_b64_tr_b16 v[50:51], v182 offset:512
    s_add_u32 m0, s73, 55296
    s_nop 0
    buffer_load_dwordx4 v98, s[8:11], s75 offen offset:2048 lds
    v_mfma_f32_16x16x32_bf16 v[116:119], v[80:83], v[64:67], v[116:119]
    ds_read_b64_tr_b16 v[52:53], v182 offset:8192
    ds_read_b64_tr_b16 v[54:55], v182 offset:8704
    v_mfma_f32_16x16x32_bf16 v[120:123], v[84:87], v[64:67], v[120:123]
    v_mfma_f32_16x16x32_bf16 v[132:135], v[68:71], v[80:83], v[132:135]
    v_mfma_f32_16x16x32_bf16 v[140:143], v[68:71], v[84:87], v[140:143]
    v_mfma_f32_16x16x32_bf16 v[108:111], v[80:83], v[36:39], v[108:111]
    ds_read_b128 v[196:199], v180 offset:2048
    ds_read_b64_tr_b16 v[60:61], v184 offset:0
    v_mfma_f32_16x16x32_bf16 v[112:115], v[84:87], v[36:39], v[112:115]
    ds_read_b64_tr_b16 v[62:63], v184 offset:512
    s_add_u32 m0, s72, 49152
    s_xor_b32 s74, s62, 896
    buffer_load_dwordx4 v96, s[4:7], s74 offen offset:0 lds
    v_mfma_f32_16x16x32_bf16 v[124:127], v[80:83], v[40:43], v[124:127]
    ds_read_b64_tr_b16 v[64:65], v184 offset:8192
    ds_read_b64_tr_b16 v[66:67], v184 offset:8704
    v_mfma_f32_16x16x32_bf16 v[128:131], v[84:87], v[40:43], v[128:131]
    buffer_load_dwordx4 v97, s[4:7], s74 offen offset:1024 lds
    v_mfma_f32_16x16x32_bf16 v[136:139], v[44:47], v[80:83], v[136:139]
    v_mfma_f32_16x16x32_bf16 v[144:147], v[44:47], v[84:87], v[144:147]
    s_waitcnt lgkmcnt(7)
    v_mfma_f32_16x16x32_bf16 v[100:103], v[192:195], v[48:51], v[100:103]
    ds_read_b128 v[200:203], v181 offset:0
    ds_read_b64_tr_b16 v[36:37], v182 offset:4096
    s_waitcnt lgkmcnt(6)
    v_mfma_f32_16x16x32_bf16 v[104:107], v[196:199], v[48:51], v[104:107]
    ds_read_b64_tr_b16 v[38:39], v182 offset:4608
    s_add_u32 m0, s73, 72704
    s_xor_b32 s75, s62, 896
    s_mul_i32 s75, s75, 1536
    buffer_load_dwordx4 v98, s[8:11], s75 offen offset:1024 lds
    v_mfma_f32_16x16x32_bf16 v[116:119], v[192:195], v[52:55], v[116:119]
    ds_read_b64_tr_b16 v[40:41], v182 offset:12288
    ds_read_b64_tr_b16 v[42:43], v182 offset:12800
    v_mfma_f32_16x16x32_bf16 v[120:123], v[196:199], v[52:55], v[120:123]
    s_waitcnt lgkmcnt(7)
    v_mfma_f32_16x16x32_bf16 v[108:111], v[192:195], v[60:63], v[108:111]
    ds_read_b128 v[204:207], v181 offset:2048
    ds_read_b64_tr_b16 v[48:49], v184 offset:4096
    v_mfma_f32_16x16x32_bf16 v[112:115], v[196:199], v[60:63], v[112:115]
    ds_read_b64_tr_b16 v[50:51], v184 offset:4608
    s_add_u32 m0, s73, 79872
    s_nop 0
    buffer_load_dwordx4 v98, s[8:11], s75 offen offset:2048 lds
    s_waitcnt lgkmcnt(8)
    v_mfma_f32_16x16x32_bf16 v[124:127], v[192:195], v[64:67], v[124:127]
    ds_read_b64_tr_b16 v[52:53], v184 offset:12288
LIAa_3:
    s_cmp_eq_u32 s63, 1
    s_cbranch_scc1 LIAa_ret
    ds_read_b64_tr_b16 v[54:55], v184 offset:12800
    v_mfma_f32_16x16x32_bf16 v[128:131], v[196:199], v[64:67], v[128:131]
    s_add_u32 m0, s73, 16384
    s_xor_b32 s75, s62, 512
    s_mul_i32 s75, s75, 1536
    buffer_load_dwordx4 v98, s[8:11], s75 offen offset:0 lds
    s_waitcnt vmcnt(9) lgkmcnt(0)
    s_barrier
    v_mfma_f32_16x16x32_bf16 v[100:103], v[200:203], v[36:39], v[100:103]
    ds_read_b128 v[208:211], v180 offset:16384
    ds_read_b64_tr_b16 v[60:61], v182 offset:24576
    v_mfma_f32_16x16x32_bf16 v[104:107], v[204:207], v[36:39], v[104:107]
    ds_read_b64_tr_b16 v[62:63], v182 offset:25088
    s_add_u32 m0, s73, 40960
    s_xor_b32 s75, s62, 640
    s_mul_i32 s75, s75, 1536
    buffer_load_dwordx4 v98, s[8:11], s75 offen offset:0 lds
    v_mfma_f32_16x16x32_bf16 v[116:119], v[200:203], v[40:43], v[116:119]
    ds_read_b64_tr_b16 v[64:65], v182 offset:32768
    ds_read_b64_tr_b16 v[66:67], v182 offset:33280
    v_mfma_f32_16x16x32_bf16 v[120:123], v[204:207], v[40:43], v[120:123]
    v_mfma_f32_16x16x32_bf16 v[108:111], v[200:203], v[48:51], v[108:111]
    ds_read_b128 v[212:215], v180 offset:18432
    ds_read_b64_tr_b16 v[36:37], v184 offset:24576
    v_mfma_f32_16x16x32_bf16 v[112:115], v[204:207], v[48:51], v[112:115]
    ds_read_b64_tr_b16 v[38:39], v184 offset:25088
    s_add_u32 m0, s73, 65536
    s_xor_b32 s75, s62, 768
    s_mul_i32 s75, s75, 1536
    buffer_load_dwordx4 v98, s[8:11], s75 offen offset:0 lds
    v_mfma_f32_16x16x32_bf16 v[124:127], v[200:203], v[52:55], v[124:127]
    ds_read_b64_tr_b16 v[40:41], v184 offset:32768
    ds_read_b64_tr_b16 v[42:43], v184 offset:33280
    v_mfma_f32_16x16x32_bf16 v[128:131], v[204:207], v[52:55], v[128:131]
    s_add_u32 m0, s73, 90112
    s_xor_b32 s75, s62, 896
    s_mul_i32 s75, s75, 1536
    buffer_load_dwordx4 v98, s[8:11], s75 offen offset:0 lds
    v_mov_b32 v80, 0x3f803f80
    v_mov_b32 v81, 0x3f803f80
    v_mov_b32 v82, 0x3f803f80
    v_mov_b32 v83, 0x3f803f80
    s_waitcnt lgkmcnt(7)
    v_mfma_f32_16x16x32_bf16 v[100:103], v[208:211], v[60:63], v[100:103]
    ds_read_b128 v[216:219], v181 offset:16384
    ds_read_b64_tr_b16 v[48:49], v182 offset:28672
    s_waitcnt lgkmcnt(6)
    v_mfma_f32_16x16x32_bf16 v[104:107], v[212:215], v[60:63], v[104:107]
    ds_read_b64_tr_b16 v[50:51], v182 offset:29184
    s_add_u32 m0, s71, 65536
    s_add_u32 s77, s87, 0
    buffer_load_dwordx4 v4, s[28:31], s77 offen lds
    v_mfma_f32_16x16x32_bf16 v[116:119], v[208:211], v[64:67], v[116:119]
    ds_read_b64_tr_b16 v[52:53], v182 offset:36864
    ds_read_b64_tr_b16 v[54:55], v182 offset:37376
    v_mfma_f32_16x16x32_bf16 v[120:123], v[212:215], v[64:67], v[120:123]
    s_waitcnt lgkmcnt(7)
    v_mfma_f32_16x16x32_bf16 v[108:111], v[208:211], v[36:39], v[108:111]
    ds_read_b128 v[220:223], v181 offset:18432
    ds_read_b64_tr_b16 v[60:61], v184 offset:28672
    v_mfma_f32_16x16x32_bf16 v[112:115], v[212:215], v[36:39], v[112:115]
    ds_read_b64_tr_b16 v[62:63], v184 offset:29184
    s_add_u32 m0, s71, 73728
    s_add_u32 s77, s87, 16384
    buffer_load_dwordx4 v4, s[28:31], s77 offen lds
    s_waitcnt lgkmcnt(8)
    v_mfma_f32_16x16x32_bf16 v[124:127], v[208:211], v[40:43], v[124:127]
    ds_read_b64_tr_b16 v[64:65], v184 offset:36864
    ds_read_b64_tr_b16 v[66:67], v184 offset:37376
    v_mfma_f32_16x16x32_bf16 v[128:131], v[212:215], v[40:43], v[128:131]
    s_waitcnt vmcnt(10) lgkmcnt(0)
    s_barrier
    v_mfma_f32_16x16x32_bf16 v[100:103], v[216:219], v[48:51], v[100:103]
    ds_read_b128 v[224:227], v180 offset:32768
    ds_read_b64_tr_b16 v[36:37], v183 offset:0
    v_mfma_f32_16x16x32_bf16 v[104:107], v[220:223], v[48:51], v[104:107]
    ds_read_b64_tr_b16 v[38:39], v183 offset:512
    s_add_u32 m0, s71, 0
    s_add_u32 s77, s87, 8192
    buffer_load_dwordx4 v4, s[28:31], s77 offen lds
    v_mfma_f32_16x16x32_bf16 v[116:119], v[216:219], v[52:55], v[116:119]
    ds_read_b64_tr_b16 v[40:41], v183 offset:8192
    ds_read_b64_tr_b16 v[42:43], v183 offset:8704
    v_mfma_f32_16x16x32_bf16 v[120:123], v[220:223], v[52:55], v[120:123]
    s_buffer_load_dword s94, s[24:27], 0
    v_mfma_f32_16x16x32_bf16 v[108:111], v[216:219], v[60:63], v[108:111]
    ds_read_b128 v[228:231], v180 offset:34816
    ds_read_b64_tr_b16 v[48:49], v185 offset:0
    v_mfma_f32_16x16x32_bf16 v[112:115], v[220:223], v[60:63], v[112:115]
    ds_read_b64_tr_b16 v[50:51], v185 offset:512
    s_add_u32 m0, s71, 8192
    s_add_u32 s77, s87, 24576
    buffer_load_dwordx4 v4, s[28:31], s77 offen lds
    v_mfma_f32_16x16x32_bf16 v[124:127], v[216:219], v[64:67], v[124:127]
    ds_read_b64_tr_b16 v[52:53], v185 offset:8192
    ds_read_b64_tr_b16 v[54:55], v185 offset:8704
    v_mfma_f32_16x16x32_bf16 v[128:131], v[220:223], v[64:67], v[128:131]
    s_add_u32 m0, s71, 90112
    s_add_u32 s77, s87, 65536
    buffer_load_dwordx4 v4, s[28:31], s77 offen lds
    s_waitcnt lgkmcnt(7)
    v_mfma_f32_16x16x32_bf16 v[100:103], v[224:227], v[36:39], v[100:103]
    ds_read_b128 v[232:235], v181 offset:32768
    ds_read_b64_tr_b16 v[60:61], v183 offset:4096
    s_waitcnt lgkmcnt(6)
    v_mfma_f32_16x16x32_bf16 v[104:107], v[228:231], v[36:39], v[104:107]
    ds_read_b64_tr_b16 v[62:63], v183 offset:4608
    s_add_u32 m0, s71, 98304
    s_add_u32 s77, s87, 81920
    buffer_load_dwordx4 v4, s[28:31], s77 offen lds
    v_mfma_f32_16x16x32_bf16 v[116:119], v[224:227], v[40:43], v[116:119]
    ds_read_b64_tr_b16 v[64:65], v183 offset:12288
    ds_read_b64_tr_b16 v[66:67], v183 offset:12800
    v_mfma_f32_16x16x32_bf16 v[120:123], v[228:231], v[40:43], v[120:123]
    s_waitcnt lgkmcnt(7)
    v_mfma_f32_16x16x32_bf16 v[108:111], v[224:227], v[48:51], v[108:111]
    ds_read_b128 v[236:239], v181 offset:34816
    ds_read_b64_tr_b16 v[36:37], v185 offset:4096
    v_mfma_f32_16x16x32_bf16 v[112:115], v[228:231], v[48:51], v[112:115]
    ds_read_b64_tr_b16 v[38:39], v185 offset:4608
    s_add_u32 m0, s71, 16384
    s_add_u32 s77, s87, 73728
    buffer_load_dwordx4 v4, s[28:31], s77 offen lds
    s_waitcnt lgkmcnt(8)
    v_mfma_f32_16x16x32_bf16 v[124:127], v[224:227], v[52:55], v[124:127]
    ds_read_b64_tr_b16 v[40:41], v185 offset:12288
    ds_read_b64_tr_b16 v[42:43], v185 offset:12800
    v_mfma_f32_16x16x32_bf16 v[128:131], v[228:231], v[52:55], v[128:131]
    s_waitcnt lgkmcnt(0)
    s_cmp_lg_u32 s94, 0
    s_cbranch_scc0 Lretry_28i
Lok_27:
    s_mov_b32 s95, s94
    v_mov_b32 v17, s94
    s_waitcnt vmcnt(11)
    s_barrier
    v_mfma_f32_16x16x32_bf16 v[100:103], v[232:235], v[60:63], v[100:103]
    ds_read_b128 v[240:243], v180 offset:49152
    ds_read_b64_tr_b16 v[48:49], v183 offset:24576
LIAa_4:
    s_cmp_eq_u32 s63, 1
    s_cbranch_scc1 LIAa_ret
    v_mfma_f32_16x16x32_bf16 v[104:107], v[236:239], v[60:63], v[104:107]
    ds_read_b64_tr_b16 v[50:51], v183 offset:25088
    s_add_u32 m0, s71, 24576
    s_add_u32 s77, s87, 90112
    buffer_load_dwordx4 v4, s[28:31], s77 offen lds
    v_mfma_f32_16x16x32_bf16 v[116:119], v[232:235], v[64:67], v[116:119]
    ds_read_b64_tr_b16 v[52:53], v183 offset:32768
    ds_read_b64_tr_b16 v[54:55], v183 offset:33280
    v_mfma_f32_16x16x32_bf16 v[120:123], v[236:239], v[64:67], v[120:123]
    v_mfma_f32_16x16x32_bf16 v[108:111], v[232:235], v[36:39], v[108:111]
    ds_read_b128 v[244:247], v180 offset:51200
    ds_read_b64_tr_b16 v[60:61], v185 offset:24576
    v_mfma_f32_16x16x32_bf16 v[112:115], v[236:239], v[36:39], v[112:115]
    ds_read_b64_tr_b16 v[62:63], v185 offset:25088
    s_add_u32 m0, s71, 32768
    s_add_u32 s77, s87, 131072
    buffer_load_dwordx4 v4, s[28:31], s77 offen lds
    s_waitcnt vmcnt(7)
    ds_read_b64_tr_b16 v[148:149], v7 offset:0
    ds_read_b64_tr_b16 v[150:151], v7 offset:8192
    ds_read_b64_tr_b16 v[152:153], v8 offset:0
    ds_read_b64_tr_b16 v[154:155], v8 offset:8192
    v_mfma_f32_16x16x32_bf16 v[124:127], v[232:235], v[40:43], v[124:127]
    ds_read_b64_tr_b16 v[64:65], v185 offset:32768
    ds_read_b64_tr_b16 v[66:67], v185 offset:33280
    v_mfma_f32_16x16x32_bf16 v[128:131], v[236:239], v[40:43], v[128:131]
    s_add_u32 m0, s71, 40960
    s_add_u32 s77, s87, 147456
    buffer_load_dwordx4 v4, s[28:31], s77 offen lds
    s_waitcnt lgkmcnt(11)
    v_mfma_f32_16x16x32_bf16 v[100:103], v[240:243], v[48:51], v[100:103]
    ds_read_b128 v[248:251], v181 offset:49152
    ds_read_b64_tr_b16 v[36:37], v183 offset:28672
    s_waitcnt lgkmcnt(10)
    v_mfma_f32_16x16x32_bf16 v[104:107], v[244:247], v[48:51], v[104:107]
    ds_read_b64_tr_b16 v[38:39], v183 offset:29184
    v_mfma_f32_16x16x32_bf16 v[116:119], v[240:243], v[52:55], v[116:119]
    ds_read_b64_tr_b16 v[40:41], v183 offset:36864
    ds_read_b64_tr_b16 v[42:43], v183 offset:37376
    v_mfma_f32_16x16x32_bf16 v[120:123], v[244:247], v[52:55], v[120:123]
    s_waitcnt lgkmcnt(11)
    v_mfma_f32_16x16x32_bf16 v[108:111], v[240:243], v[60:63], v[108:111]
    ds_read_b128 v[252:255], v181 offset:51200
    ds_read_b64_tr_b16 v[48:49], v185 offset:28672
    v_mfma_f32_16x16x32_bf16 v[112:115], v[244:247], v[60:63], v[112:115]
    ds_read_b64_tr_b16 v[50:51], v185 offset:29184
    s_waitcnt vmcnt(6)
    ds_read_b64_tr_b16 v[156:157], v5 offset:0
    s_waitcnt lgkmcnt(14)
    ds_read_b64_tr_b16 v[158:159], v5 offset:8192
    s_waitcnt lgkmcnt(14)
    ds_read_b64_tr_b16 v[160:161], v6 offset:0
    s_waitcnt lgkmcnt(14)
    ds_read_b64_tr_b16 v[162:163], v6 offset:8192
    s_waitcnt lgkmcnt(12)
    v_mfma_f32_16x16x32_bf16 v[124:127], v[240:243], v[64:67], v[124:127]
    ds_read_b64_tr_b16 v[52:53], v185 offset:36864
    ds_read_b64_tr_b16 v[54:55], v185 offset:37376
    v_mfma_f32_16x16x32_bf16 v[128:131], v[244:247], v[64:67], v[128:131]
    s_add_u32 m0, s71, 65536
    s_add_u32 s77, s87, 139264
    buffer_load_dwordx4 v4, s[28:31], s77 offen lds
    s_add_u32 m0, s71, 73728
    s_add_u32 s77, s87, 155648
    buffer_load_dwordx4 v4, s[28:31], s77 offen lds
    s_waitcnt lgkmcnt(11)
    v_mfma_f32_16x16x32_bf16 v[100:103], v[248:251], v[36:39], v[100:103]
    s_waitcnt lgkmcnt(8)
    v_mfma_f32_16x16x32_bf16 v[104:107], v[252:255], v[36:39], v[104:107]
    v_mfma_f32_16x16x32_bf16 v[116:119], v[248:251], v[40:43], v[116:119]
    v_mfma_f32_16x16x32_bf16 v[120:123], v[252:255], v[40:43], v[120:123]
    s_lshl_b32 s76, s68, 2
    s_buffer_load_dword s1, s[24:27], s76 offset:128
    s_waitcnt lgkmcnt(6)
    v_mfma_f32_16x16x32_bf16 v[108:111], v[248:251], v[48:51], v[108:111]
    v_mfma_f32_16x16x32_bf16 v[112:115], v[252:255], v[48:51], v[112:115]
    s_waitcnt lgkmcnt(0)
    v_mfma_f32_16x16x32_bf16 v[124:127], v[248:251], v[52:55], v[124:127]
    v_mfma_f32_16x16x32_bf16 v[128:131], v[252:255], v[52:55], v[128:131]
    s_add_u32 m0, s71, 0
    s_add_u32 s77, s87, 32768
    buffer_load_dwordx4 v4, s[28:31], s77 offen lds
    s_add_u32 m0, s71, 8192
    s_add_u32 s77, s87, 49152
    buffer_load_dwordx4 v4, s[28:31], s77 offen lds
LDAa:
    v_pk_mul_f32 v[84:85], v[100:101], s[82:83]
    v_pk_mul_f32 v[86:87], v[102:103], s[82:83]
    v_pk_mul_f32 v[88:89], v[104:105], s[82:83]
    v_pk_mul_f32 v[90:91], v[106:107], s[82:83]
    v_cvt_pk_bf16_f32 v72, v116, v117
    v_cvt_pk_bf16_f32 v73, v118, v119
    v_cvt_pk_bf16_f32 v74, v120, v121
    v_cvt_pk_bf16_f32 v75, v122, v123
    v_cvt_pk_bf16_f32 v76, v124, v125
    v_cvt_pk_bf16_f32 v77, v126, v127
    v_cvt_pk_bf16_f32 v78, v128, v129
    v_cvt_pk_bf16_f32 v79, v130, v131
    v_exp_f32 v84, v84 clamp
    v_exp_f32 v85, v85 clamp
    v_exp_f32 v86, v86 clamp
    v_exp_f32 v87, v87 clamp
    v_exp_f32 v88, v88 clamp
    v_exp_f32 v89, v89 clamp
    v_exp_f32 v90, v90 clamp
    v_exp_f32 v91, v91 clamp
    v_max_f32 v100, 0x358637bd, v100
    v_max_f32 v101, 0x358637bd, v101
    v_max_f32 v102, 0x358637bd, v102
    v_max_f32 v103, 0x358637bd, v103
    v_max_f32 v104, 0x358637bd, v104
    v_max_f32 v105, 0x358637bd, v105
    v_max_f32 v106, 0x358637bd, v106
    s_barrier
    v_max_f32 v107, 0x358637bd, v107
    v_pk_add_f32 v[84:85], v[84:85], v[100:101]
    v_pk_add_f32 v[86:87], v[86:87], v[102:103]
    v_pk_add_f32 v[88:89], v[88:89], v[104:105]
    v_pk_add_f32 v[90:91], v[90:91], v[106:107]
    v_cvt_pk_bf16_f32 v92, v84, v85
    v_cvt_pk_bf16_f32 v93, v86, v87
    v_cvt_pk_bf16_f32 v94, v88, v89
    v_cvt_pk_bf16_f32 v95, v90, v91
    v_pk_mul_f32 v[84:85], v[108:109], s[82:83]
    v_pk_mul_f32 v[86:87], v[110:111], s[82:83]
    v_pk_mul_f32 v[88:89], v[112:113], s[82:83]
    s_add_u32 m0, s71, 49152
    s_add_u32 s77, s87, 40960
    buffer_load_dwordx4 v4, s[28:31], s77 offen lds
    v_pk_mul_f32 v[90:91], v[114:115], s[82:83]
    v_exp_f32 v84, v84 clamp
    v_exp_f32 v85, v85 clamp
    v_exp_f32 v86, v86 clamp
    v_exp_f32 v87, v87 clamp
    v_exp_f32 v88, v88 clamp
    v_exp_f32 v89, v89 clamp
LIAa_5:
    s_cmp_eq_u32 s63, 1
    s_cbranch_scc1 LIAa_ret
    v_exp_f32 v90, v90 clamp
    v_exp_f32 v91, v91 clamp
    v_max_f32 v108, 0x358637bd, v108
    v_max_f32 v109, 0x358637bd, v109
    v_max_f32 v110, 0x358637bd, v110
    s_add_u32 m0, s71, 57344
    s_add_u32 s77, s87, 57344
    buffer_load_dwordx4 v4, s[28:31], s77 offen lds
    v_max_f32 v111, 0x358637bd, v111
    v_max_f32 v112, 0x358637bd, v112
    v_max_f32 v113, 0x358637bd, v113
    v_max_f32 v114, 0x358637bd, v114
    v_max_f32 v115, 0x358637bd, v115
    v_pk_add_f32 v[84:85], v[84:85], v[108:109]
    v_pk_add_f32 v[86:87], v[86:87], v[110:111]
    v_pk_add_f32 v[88:89], v[88:89], v[112:113]
    v_pk_add_f32 v[90:91], v[90:91], v[114:115]
    v_cvt_pk_bf16_f32 v96, v84, v85
    v_cvt_pk_bf16_f32 v97, v86, v87
    v_cvt_pk_bf16_f32 v98, v88, v89
    v_cvt_pk_bf16_f32 v99, v90, v91
    v_mfma_f32_16x16x32_bf16 v[40:43], v[92:95], v[80:83], 0
    s_nop 0
    v_mfma_f32_16x16x32_bf16 v[48:51], v[96:99], v[80:83], 0
    v_mfma_f32_16x16x32_bf16 v[36:39], v[92:95], v[72:75], 0
    v_mfma_f32_16x16x32_bf16 v[44:47], v[96:99], v[76:79], 0
    s_nop 6
    ds_write_b128 v34, v[36:39] offset:0
    ds_write_b128 v34, v[40:43] offset:512
    ds_write_b128 v34, v[44:47] offset:2048
    ds_write_b128 v34, v[48:51] offset:2560
    s_waitcnt lgkmcnt(0)
    s_barrier
    ds_read2st64_b32 v[36:37], v188 offset0:0 offset1:1
    ds_read2st64_b32 v[38:39], v188 offset0:32 offset1:33
    ds_read2st64_b32 v[40:41], v188 offset0:96 offset1:97
    ds_read2st64_b32 v[42:43], v188 offset0:128 offset1:129
    ds_read2st64_b32 v[44:45], v189 offset0:0 offset1:32
    ds_read2st64_b32 v[46:47], v189 offset0:96 offset1:128
    s_waitcnt lgkmcnt(4)
    v_pk_add_f32 v[36:37], v[36:37], v[38:39]
    s_waitcnt lgkmcnt(2)
    v_pk_add_f32 v[40:41], v[40:41], v[42:43]
    s_waitcnt lgkmcnt(0)
    v_pk_add_f32 v[44:45], v[44:45], v[46:47]
    v_pk_add_f32 v[36:37], v[36:37], v[40:41]
    v_add_f32 v44, v44, v45
    s_waitcnt lgkmcnt(0)
    s_cmp_eq_u32 s1, 1
    s_cbranch_scc0 Lretry_30i
Lok_29:
    buffer_atomic_add_f32 v36, v190, s[36:39], s78 offen offset:0
    buffer_atomic_add_f32 v37, v190, s[36:39], s78 offen offset:256
    buffer_atomic_add_f32 v44, v191, s[36:39], s78 offen offset:512
    ds_read_b64_tr_b16 v[68:69], v182 offset:16384
    ds_read_b64_tr_b16 v[70:71], v182 offset:16896
    ds_read_b64_tr_b16 v[72:73], v184 offset:16384
    ds_read_b64_tr_b16 v[74:75], v184 offset:16896
    ds_read_b64_tr_b16 v[76:77], v182 offset:20480
    ds_read_b64_tr_b16 v[78:79], v182 offset:20992
    s_waitcnt lgkmcnt(4)
    v_mfma_f32_16x16x32_bf16 v[132:135], v[68:71], v[192:195], v[132:135]
    v_mfma_f32_16x16x32_bf16 v[140:143], v[68:71], v[196:199], v[140:143]
    s_add_u32 m0, s71, 114688
    s_add_u32 s77, s87, 98304
    buffer_load_dwordx4 v4, s[28:31], s77 offen lds
    s_waitcnt vmcnt(14)
    ds_read_b64_tr_b16 v[164:165], v7 offset:24576
    ds_read_b64_tr_b16 v[166:167], v7 offset:32768
    ds_read_b64_tr_b16 v[168:169], v8 offset:24576
    ds_read_b64_tr_b16 v[170:171], v8 offset:32768
    ds_read_b64_tr_b16 v[80:81], v184 offset:20480
    ds_read_b64_tr_b16 v[82:83], v184 offset:20992
    s_waitcnt lgkmcnt(8)
    v_mfma_f32_16x16x32_bf16 v[136:139], v[72:75], v[192:195], v[136:139]
    v_mfma_f32_16x16x32_bf16 v[144:147], v[72:75], v[196:199], v[144:147]
    s_add_u32 m0, s71, 122880
    s_add_u32 s77, s87, 114688
    buffer_load_dwordx4 v4, s[28:31], s77 offen lds
    s_waitcnt vmcnt(13)
    ds_read_b64_tr_b16 v[172:173], v5 offset:16384
    ds_read_b64_tr_b16 v[174:175], v5 offset:24576
    ds_read_b64_tr_b16 v[176:177], v6 offset:16384
    ds_read_b64_tr_b16 v[178:179], v6 offset:24576
    ds_read_b64_tr_b16 v[68:69], v182 offset:40960
    s_waitcnt lgkmcnt(12)
    ds_read_b64_tr_b16 v[70:71], v182 offset:41472
    s_waitcnt lgkmcnt(12)
    v_mfma_f32_16x16x32_bf16 v[132:135], v[76:79], v[200:203], v[132:135]
    v_mfma_f32_16x16x32_bf16 v[140:143], v[76:79], v[204:207], v[140:143]
    s_add_u32 m0, s71, 139264
    s_add_u32 s77, s87, 106496
    buffer_load_dwordx4 v4, s[28:31], s77 offen lds
    ds_read_b64_tr_b16 v[72:73], v184 offset:40960
    s_waitcnt lgkmcnt(12)
    ds_read_b64_tr_b16 v[74:75], v184 offset:41472
    s_waitcnt lgkmcnt(8)
    v_mfma_f32_16x16x32_bf16 v[136:139], v[80:83], v[200:203], v[136:139]
    v_mfma_f32_16x16x32_bf16 v[144:147], v[80:83], v[204:207], v[144:147]
    s_add_u32 m0, s71, 147456
    s_add_u32 s77, s87, 122880
    buffer_load_dwordx4 v4, s[28:31], s77 offen lds
    ds_read_b64_tr_b16 v[76:77], v182 offset:45056
    ds_read_b64_tr_b16 v[78:79], v182 offset:45568
    s_waitcnt lgkmcnt(4)
    v_mfma_f32_16x16x32_bf16 v[132:135], v[68:71], v[208:211], v[132:135]
    v_mfma_f32_16x16x32_bf16 v[140:143], v[68:71], v[212:215], v[140:143]
    s_add_u32 m0, s71, 90112
    s_add_u32 s77, s87, 163840
    s_add_u32 s77, s77, s91
    buffer_load_dwordx4 v4, s[28:31], s77 offen lds
    ds_read_b64_tr_b16 v[80:81], v184 offset:45056
    ds_read_b64_tr_b16 v[82:83], v184 offset:45568
    s_waitcnt lgkmcnt(4)
    v_mfma_f32_16x16x32_bf16 v[136:139], v[72:75], v[208:211], v[136:139]
    v_mfma_f32_16x16x32_bf16 v[144:147], v[72:75], v[212:215], v[144:147]
    s_add_u32 m0, s71, 98304
    s_add_u32 s77, s87, 180224
    s_add_u32 s77, s77, s91
    buffer_load_dwordx4 v4, s[28:31], s77 offen lds
    s_buffer_load_dwordx16 s[4:19], s[36:39], s96 offset:16384 glc
    s_mov_b32 s63, 2
    s_cmp_eq_u32 s64, 0
    s_cbranch_scc1 LJAa_0
    s_cmp_eq_u32 s64, 1
    s_cbranch_scc1 LJAa_1
    s_cmp_eq_u32 s64, 2
    s_cbranch_scc1 LJAa_2
    s_cmp_eq_u32 s64, 3
    s_cbranch_scc1 LJAa_3
LJAa_5:
LJAa_6:
LJAa_7:
LJAa_8:
LJAa_ret:
    s_mov_b32 s63, 0
    v_lshrrev_b32 v22, 1, v1
    v_and_b32 v23, 1, v1
    v_lshlrev_b32 v22, 15, v22
    s_lshl_b32 s76, s68, 11
    v_lshl_add_u32 v22, v23, 10, v22
    s_add_u32 s76, s76, 0x800000
    v_mov_b32 v23, 1
    s_waitcnt vmcnt(6)
    s_barrier
    s_cmp_lg_u32 s64, 0
    s_cbranch_scc1 Lnokc_31
    s_mov_b32 exec_hi, 0
    buffer_atomic_add v23, v22, s[36:39], s76 offen offset:16
    s_mov_b64 exec, -1
Lnokc_31:
    ds_read_b64_tr_b16 v[68:69], v183 offset:16384
    ds_read_b64_tr_b16 v[70:71], v183 offset:16896
    s_waitcnt lgkmcnt(4)
    v_mfma_f32_16x16x32_bf16 v[132:135], v[76:79], v[216:219], v[132:135]
    v_mfma_f32_16x16x32_bf16 v[140:143], v[76:79], v[220:223], v[140:143]
LIAa_6:
    s_cmp_eq_u32 s63, 1
    s_cbranch_scc1 LIAa_ret
LJAa_0:
    s_cmp_eq_u32 s63, 2
    s_cbranch_scc1 LJAa_4
    s_add_u32 m0, s71, 16384
    s_add_u32 s77, s87, 172032
    s_add_u32 s77, s77, s91
    buffer_load_dwordx4 v4, s[28:31], s77 offen lds
    ds_read_b64_tr_b16 v[72:73], v185 offset:16384
    ds_read_b64_tr_b16 v[74:75], v185 offset:16896
    s_waitcnt lgkmcnt(4)
    v_mfma_f32_16x16x32_bf16 v[136:139], v[80:83], v[216:219], v[136:139]
    v_mfma_f32_16x16x32_bf16 v[144:147], v[80:83], v[220:223], v[144:147]
    s_add_u32 m0, s71, 24576
    s_add_u32 s77, s87, 188416
    s_add_u32 s77, s77, s91
    buffer_load_dwordx4 v4, s[28:31], s77 offen lds
    ds_read_b64_tr_b16 v[76:77], v183 offset:20480
    ds_read_b64_tr_b16 v[78:79], v183 offset:20992
    s_waitcnt lgkmcnt(4)
    v_mfma_f32_16x16x32_bf16 v[132:135], v[68:71], v[224:227], v[132:135]
    v_mfma_f32_16x16x32_bf16 v[140:143], v[68:71], v[228:231], v[140:143]
    ds_read_b64_tr_b16 v[80:81], v185 offset:20480
    ds_read_b64_tr_b16 v[82:83], v185 offset:20992
    s_waitcnt lgkmcnt(4)
    v_mfma_f32_16x16x32_bf16 v[136:139], v[72:75], v[224:227], v[136:139]
    v_mfma_f32_16x16x32_bf16 v[144:147], v[72:75], v[228:231], v[144:147]
    ds_read_b64_tr_b16 v[68:69], v183 offset:40960
    ds_read_b64_tr_b16 v[70:71], v183 offset:41472
    s_waitcnt lgkmcnt(4)
    v_mfma_f32_16x16x32_bf16 v[132:135], v[76:79], v[232:235], v[132:135]
    v_mfma_f32_16x16x32_bf16 v[140:143], v[76:79], v[236:239], v[140:143]
    ds_read_b64_tr_b16 v[72:73], v185 offset:40960
    ds_read_b64_tr_b16 v[74:75], v185 offset:41472
    s_waitcnt lgkmcnt(4)
    v_mfma_f32_16x16x32_bf16 v[136:139], v[80:83], v[232:235], v[136:139]
    v_mfma_f32_16x16x32_bf16 v[144:147], v[80:83], v[236:239], v[144:147]
    ds_read_b64_tr_b16 v[76:77], v183 offset:45056
    ds_read_b64_tr_b16 v[78:79], v183 offset:45568
    s_waitcnt lgkmcnt(4)
    v_mfma_f32_16x16x32_bf16 v[132:135], v[68:71], v[240:243], v[132:135]
    v_mfma_f32_16x16x32_bf16 v[140:143], v[68:71], v[244:247], v[140:143]
    ds_read_b64_tr_b16 v[80:81], v185 offset:45056
    ds_read_b64_tr_b16 v[82:83], v185 offset:45568
    s_waitcnt lgkmcnt(4)
    v_mfma_f32_16x16x32_bf16 v[136:139], v[72:75], v[240:243], v[136:139]
    v_mfma_f32_16x16x32_bf16 v[144:147], v[72:75], v[244:247], v[144:147]
    s_waitcnt lgkmcnt(2)
    v_mfma_f32_16x16x32_bf16 v[132:135], v[76:79], v[248:251], v[132:135]
    v_mfma_f32_16x16x32_bf16 v[140:143], v[76:79], v[252:255], v[140:143]
    s_waitcnt lgkmcnt(0)
    v_mfma_f32_16x16x32_bf16 v[136:139], v[80:83], v[248:251], v[136:139]
    v_mfma_f32_16x16x32_bf16 v[144:147], v[80:83], v[252:255], v[144:147]
    s_barrier
    s_waitcnt lgkmcnt(0)
    s_nop 1
    v_pk_mul_f32 v[84:85], v[132:133], s[82:83]
    v_pk_mul_f32 v[86:87], v[134:135], s[82:83]
    s_nop 0
    v_pk_mul_f32 v[88:89], v[136:137], s[82:83]
    v_pk_mul_f32 v[90:91], v[138:139], s[82:83]
    v_exp_f32 v84, v84 clamp
    v_exp_f32 v85, v85 clamp
    v_exp_f32 v86, v86 clamp
    s_add_u32 m0, s71, 81920
    s_add_u32 s77, s88, 0
    buffer_load_dwordx4 v4, s[40:43], s77 offen lds
    v_exp_f32 v87, v87 clamp
    v_exp_f32 v88, v88 clamp
    v_exp_f32 v89, v89 clamp
    v_exp_f32 v90, v90 clamp
    v_exp_f32 v91, v91 clamp
    v_max_f32 v132, 0x358637bd, v132
    v_max_f32 v133, 0x358637bd, v133
    v_max_f32 v134, 0x358637bd, v134
    s_add_u32 m0, s71, 106496
    s_add_u32 s77, s88, 16384
    buffer_load_dwordx4 v4, s[40:43], s77 offen lds
    s_buffer_load_dwordx16 s[4:19], s[36:39], s96 offset:16384 glc
    s_buffer_load_dwordx4 s[44:47], s[36:39], s85 offset:16 glc
    v_max_f32 v135, 0x358637bd, v135
    v_max_f32 v136, 0x358637bd, v136
    v_max_f32 v137, 0x358637bd, v137
    v_max_f32 v138, 0x358637bd, v138
    v_max_f32 v139, 0x358637bd, v139
    v_pk_add_f32 v[84:85], v[84:85], v[132:133]
    v_pk_add_f32 v[86:87], v[86:87], v[134:135]
    v_pk_add_f32 v[88:89], v[88:89], v[136:137]
    s_add_u32 m0, s71, 131072
    s_add_u32 s77, s88, 8192
    buffer_load_dwordx4 v4, s[40:43], s77 offen lds
    v_pk_add_f32 v[90:91], v[90:91], v[138:139]
    v_cvt_pk_bf16_f32 v108, v84, v85
    v_cvt_pk_bf16_f32 v109, v86, v87
    v_cvt_pk_bf16_f32 v110, v88, v89
    v_cvt_pk_bf16_f32 v111, v90, v91
    v_pk_mul_f32 v[84:85], v[140:141], s[82:83]
    v_pk_mul_f32 v[86:87], v[142:143], s[82:83]
    v_pk_mul_f32 v[88:89], v[144:145], s[82:83]
    s_add_u32 m0, s71, 155648
    s_add_u32 s77, s88, 24576
    buffer_load_dwordx4 v4, s[40:43], s77 offen lds
    v_pk_mul_f32 v[90:91], v[146:147], s[82:83]
    v_exp_f32 v84, v84 clamp
    v_exp_f32 v85, v85 clamp
    v_exp_f32 v86, v86 clamp
    v_exp_f32 v87, v87 clamp
    v_exp_f32 v88, v88 clamp
    v_exp_f32 v89, v89 clamp
    v_exp_f32 v90, v90 clamp
    v_exp_f32 v91, v91 clamp
    v_max_f32 v140, 0x358637bd, v140
    v_max_f32 v141, 0x358637bd, v141
    v_max_f32 v142, 0x358637bd, v142
    v_max_f32 v143, 0x358637bd, v143
    v_max_f32 v144, 0x358637bd, v144
    v_max_f32 v145, 0x358637bd, v145
    v_max_f32 v146, 0x358637bd, v146
    v_max_f32 v147, 0x358637bd, v147
    v_pk_add_f32 v[84:85], v[84:85], v[140:141]
    v_pk_add_f32 v[86:87], v[86:87], v[142:143]
    v_pk_add_f32 v[88:89], v[88:89], v[144:145]
    v_pk_add_f32 v[90:91], v[90:91], v[146:147]
    v_cvt_pk_bf16_f32 v112, v84, v85
    v_cvt_pk_bf16_f32 v113, v86, v87
    v_cvt_pk_bf16_f32 v114, v88, v89
    v_cvt_pk_bf16_f32 v115, v90, v91
    s_cmp_eq_u64 s[4:5], s[94:95]
    s_cbranch_scc0 Lretry_33i
Lok_32:
    buffer_load_dwordx4 v[116:119], v11, s[36:39], s89 offen offset:0 sc1
    buffer_load_dwordx4 v[120:123], v12, s[36:39], s89 offen offset:0 sc1
    buffer_load_dwordx4 v[124:127], v11, s[36:39], s89 offen offset:1024 sc1
    buffer_load_dwordx4 v[128:131], v12, s[36:39], s89 offen offset:1024 sc1
    s_waitcnt lgkmcnt(0)
    s_cmp_lg_u32 s64, 0
    s_cbranch_scc1 Lnopoll_34
    s_cmp_eq_u32 s44, 16
    s_cbranch_scc0 Lretry_36i
Lok_35:
Lnopoll_34:
    s_barrier
    s_setprio 3
    s_cmp_eq_u64 s[46:47], s[94:95]
    s_cbranch_scc0 Lretry_38i
Lok_37:
    buffer_load_dwordx4 v[204:207], v15, s[36:39], 0 offen offset:512 sc1
    buffer_load_dwordx4 v[196:199], v32, s[36:39], 0 offen offset:0 sc1
LIAa_7:
    s_cmp_eq_u32 s63, 1
    s_cbranch_scc1 LIAa_ret
LJAa_1:
    s_cmp_eq_u32 s63, 2
    s_cbranch_scc1 LJAa_5
    buffer_load_dwordx4 v[200:203], v32, s[36:39], 0 offen offset:1152 sc1
    s_buffer_load_dwordx16 s[4:19], s[36:39], s96 offset:16384 glc
    buffer_load_dword v30, v35, s[36:39], 0 offen sc1
    buffer_load_dword v31, v35, s[36:39], 0 offen offset:64 sc1
    s_cmp_eq_u64 s[8:9], s[94:95]
    s_cbranch_scc0 Lretry_40i
Lok_39:
    s_add_u32 s75, s89, 262144
    buffer_load_dwordx4 v[212:215], v11, s[36:39], s75 offen offset:0 sc1
    buffer_load_dwordx4 v[216:219], v12, s[36:39], s75 offen offset:0 sc1
    buffer_load_dwordx4 v[220:223], v11, s[36:39], s75 offen offset:1024 sc1
    buffer_load_dwordx4 v[224:227], v12, s[36:39], s75 offen offset:1024 sc1
    s_waitcnt vmcnt(12)
    v_mfma_f32_32x32x16_bf16 v[36:51], v[148:151], v[116:119], 0
    v_mfma_f32_32x32x16_bf16 v[52:67], v[152:155], v[116:119], 0
    s_waitcnt vmcnt(11)
    v_mfma_f32_32x32x16_bf16 v[68:83], v[148:151], v[120:123], 0
    v_mfma_f32_32x32x16_bf16 v[84:99], v[152:155], v[120:123], 0
    s_waitcnt vmcnt(10)
    v_mfma_f32_32x32x16_bf16 v[36:51], v[156:159], v[124:127], v[36:51]
    v_mfma_f32_32x32x16_bf16 v[52:67], v[160:163], v[124:127], v[52:67]
    s_waitcnt vmcnt(9)
    v_mfma_f32_32x32x16_bf16 v[68:83], v[156:159], v[128:131], v[68:83]
    v_mfma_f32_32x32x16_bf16 v[84:99], v[160:163], v[128:131], v[84:99]
    s_waitcnt vmcnt(8)
    v_cvt_pk_bf16_f32 v204, v204, v205
    v_cvt_pk_bf16_f32 v205, v206, v207
    s_nop 1
    v_mfma_f32_16x16x16_bf16 v[140:143], v[204:205], v[108:109], 0
    v_mfma_f32_16x16x16_bf16 v[144:147], v[204:205], v[110:111], 0
    v_mfma_f32_16x16x16_bf16 v[188:191], v[204:205], v[112:113], 0
    v_mfma_f32_16x16x16_bf16 v[192:195], v[204:205], v[114:115], 0
    s_waitcnt vmcnt(7)
    v_cvt_pk_bf16_f32 v196, v196, v197
    v_cvt_pk_bf16_f32 v197, v198, v199
    s_nop 1
    v_mfma_f32_16x16x16_bf16 v[132:135], v[196:197], v[108:109], 0
    v_mfma_f32_16x16x16_bf16 v[180:183], v[196:197], v[112:113], 0
    s_waitcnt vmcnt(6)
    v_cvt_pk_bf16_f32 v200, v200, v201
    v_cvt_pk_bf16_f32 v201, v202, v203
    s_nop 1
    v_mfma_f32_16x16x16_bf16 v[136:139], v[200:201], v[110:111], 0
    v_mfma_f32_16x16x16_bf16 v[184:187], v[200:201], v[114:115], 0
    v_add_f32 v140, 0x358637bd, v140
    v_add_f32 v145, 0x358637bd, v145
    v_add_f32 v188, 0x358637bd, v188
    v_add_f32 v193, 0x358637bd, v193
    v_rcp_f32 v140, v140
    v_rcp_f32 v145, v145
    v_rcp_f32 v188, v188
    v_rcp_f32 v193, v193
    s_waitcnt vmcnt(5)
    v_mul_f32 v141, v140, v30
    v_mul_f32 v140, v140, v30
    v_mul_f32 v144, v145, v30
    v_mul_f32 v145, v145, v30
    s_waitcnt vmcnt(4)
    v_mul_f32 v189, v188, v31
    v_mul_f32 v188, v188, v31
    v_mul_f32 v192, v193, v31
    v_mul_f32 v193, v193, v31
    v_pk_mul_f32 v[132:133], v[132:133], v[140:141]
    v_pk_mul_f32 v[134:135], v[134:135], v[140:141]
    v_pk_mul_f32 v[136:137], v[136:137], v[144:145]
    v_pk_mul_f32 v[138:139], v[138:139], v[144:145]
    v_cvt_pk_bf16_f32 v100, v132, v133
    v_cvt_pk_bf16_f32 v101, v134, v135
    v_cvt_pk_bf16_f32 v102, v136, v137
    v_cvt_pk_bf16_f32 v103, v138, v139
    s_add_u32 s76, s86, 0
    buffer_store_dwordx4 v[100:103], v28, s[36:39], s76 offen offset:0 sc1
    v_pk_mul_f32 v[180:181], v[180:181], v[188:189]
    v_pk_mul_f32 v[182:183], v[182:183], v[188:189]
    v_pk_mul_f32 v[184:185], v[184:185], v[192:193]
    v_pk_mul_f32 v[186:187], v[186:187], v[192:193]
    v_cvt_pk_bf16_f32 v104, v180, v181
    v_cvt_pk_bf16_f32 v105, v182, v183
    v_cvt_pk_bf16_f32 v106, v184, v185
    v_cvt_pk_bf16_f32 v107, v186, v187
    s_add_u32 s76, s86, 0
    buffer_store_dwordx4 v[104:107], v28, s[36:39], s76 offen offset:256 sc1
    s_setprio 0
    s_cmp_eq_u64 s[12:13], s[94:95]
    s_cbranch_scc0 Lretry_42i
Lok_41:
    s_add_u32 s75, s89, 524288
    buffer_load_dwordx4 v[148:151], v11, s[36:39], s75 offen offset:0 sc1
    buffer_load_dwordx4 v[152:155], v12, s[36:39], s75 offen offset:0 sc1
    buffer_load_dwordx4 v[156:159], v11, s[36:39], s75 offen offset:1024 sc1
    buffer_load_dwordx4 v[160:163], v12, s[36:39], s75 offen offset:1024 sc1
    s_buffer_load_dwordx16 s[4:19], s[36:39], s96 offset:16384 glc
    ds_read_b64_tr_b16 v[228:229], v5 offset:32768
    ds_read_b64_tr_b16 v[230:231], v5 offset:40960
    ds_read_b64_tr_b16 v[232:233], v6 offset:32768
    ds_read_b64_tr_b16 v[234:235], v6 offset:40960
    s_waitcnt vmcnt(9)
    v_mfma_f32_32x32x16_bf16 v[36:51], v[164:167], v[212:215], v[36:51]
    v_mfma_f32_32x32x16_bf16 v[52:67], v[168:171], v[212:215], v[52:67]
    s_waitcnt vmcnt(8)
    v_mfma_f32_32x32x16_bf16 v[68:83], v[164:167], v[216:219], v[68:83]
    v_mfma_f32_32x32x16_bf16 v[84:99], v[168:171], v[216:219], v[84:99]
    ds_read_b64_tr_b16 v[236:237], v7 offset:0
    ds_read_b64_tr_b16 v[238:239], v7 offset:8192
    ds_read_b64_tr_b16 v[240:241], v8 offset:0
    ds_read_b64_tr_b16 v[242:243], v8 offset:8192
    s_waitcnt vmcnt(7)
    v_mfma_f32_32x32x16_bf16 v[36:51], v[172:175], v[220:223], v[36:51]
    v_mfma_f32_32x32x16_bf16 v[52:67], v[176:179], v[220:223], v[52:67]
    s_waitcnt vmcnt(6)
    v_mfma_f32_32x32x16_bf16 v[68:83], v[172:175], v[224:227], v[68:83]
    v_mfma_f32_32x32x16_bf16 v[84:99], v[176:179], v[224:227], v[84:99]
    s_waitcnt vmcnt(4)
    buffer_store_dword v17, v13, s[36:39], 0 offen offset:0 sc1
    s_cmp_eq_u64 s[6:7], s[94:95]
    s_cbranch_scc0 Lretry_44i
Lok_43:
    s_add_u32 s75, s89, 131072
    buffer_load_dwordx4 v[116:119], v11, s[36:39], s75 offen offset:0 sc1
    buffer_load_dwordx4 v[120:123], v12, s[36:39], s75 offen offset:0 sc1
    buffer_load_dwordx4 v[124:127], v11, s[36:39], s75 offen offset:1024 sc1
    buffer_load_dwordx4 v[128:131], v12, s[36:39], s75 offen offset:1024 sc1
    s_cmp_eq_u64 s[10:11], s[94:95]
    s_cbranch_scc0 Lretry_46i
Lok_45:
    s_add_u32 s75, s89, 393216
    buffer_load_dwordx4 v[132:135], v11, s[36:39], s75 offen offset:0 sc1
    buffer_load_dwordx4 v[136:139], v12, s[36:39], s75 offen offset:0 sc1
    buffer_load_dwordx4 v[140:143], v11, s[36:39], s75 offen offset:1024 sc1
    buffer_load_dwordx4 v[144:147], v12, s[36:39], s75 offen offset:1024 sc1
    ds_read_b64_tr_b16 v[244:245], v5 offset:0
    ds_read_b64_tr_b16 v[246:247], v5 offset:8192
    ds_read_b64_tr_b16 v[248:249], v6 offset:0
    ds_read_b64_tr_b16 v[250:251], v6 offset:8192
    s_waitcnt vmcnt(12) lgkmcnt(10)
    v_mfma_f32_32x32x16_bf16 v[36:51], v[228:231], v[148:151], v[36:51]
    s_waitcnt lgkmcnt(8)
    v_mfma_f32_32x32x16_bf16 v[52:67], v[232:235], v[148:151], v[52:67]
    s_add_u32 m0, s71, 32768
    s_add_u32 s77, s88, 32768
    buffer_load_dwordx4 v4, s[40:43], s77 offen lds
    s_waitcnt vmcnt(12)
    v_mfma_f32_32x32x16_bf16 v[68:83], v[228:231], v[152:155], v[68:83]
    s_add_u32 m0, s71, 40960
    s_add_u32 s77, s88, 49152
    buffer_load_dwordx4 v4, s[40:43], s77 offen lds
    v_mfma_f32_32x32x16_bf16 v[84:99], v[232:235], v[152:155], v[84:99]
    ds_read_b64_tr_b16 v[228:229], v5 offset:49152
    ds_read_b64_tr_b16 v[230:231], v5 offset:57344
    ds_read_b64_tr_b16 v[232:233], v6 offset:49152
    ds_read_b64_tr_b16 v[234:235], v6 offset:57344
LIAa_8:
    s_cmp_eq_u32 s63, 1
    s_cbranch_scc1 LIAa_ret
LJAa_2:
    s_cmp_eq_u32 s63, 2
    s_cbranch_scc1 LJAa_6
    s_waitcnt vmcnt(12) lgkmcnt(10)
    v_mfma_f32_32x32x16_bf16 v[36:51], v[236:239], v[156:159], v[36:51]
    s_waitcnt lgkmcnt(8)
    v_mfma_f32_32x32x16_bf16 v[52:67], v[240:243], v[156:159], v[52:67]
    s_add_u32 m0, s71, 65536
    s_add_u32 s77, s88, 40960
    buffer_load_dwordx4 v4, s[40:43], s77 offen lds
    s_waitcnt vmcnt(12)
    v_mfma_f32_32x32x16_bf16 v[68:83], v[236:239], v[160:163], v[68:83]
    s_add_u32 m0, s71, 73728
    s_add_u32 s77, s88, 57344
    buffer_load_dwordx4 v4, s[40:43], s77 offen lds
    v_mfma_f32_32x32x16_bf16 v[84:99], v[240:243], v[160:163], v[84:99]
    s_cmp_eq_u64 s[14:15], s[94:95]
    s_cbranch_scc0 Lretry_48i
Lok_47:
    s_add_u32 s75, s89, 655360
    s_add_u32 s75, s75, s91
    buffer_load_dwordx4 v[180:183], v11, s[36:39], s75 offen offset:0 sc1
    buffer_load_dwordx4 v[184:187], v12, s[36:39], s75 offen offset:0 sc1
    buffer_load_dwordx4 v[188:191], v11, s[36:39], s75 offen offset:1024 sc1
    buffer_load_dwordx4 v[192:195], v12, s[36:39], s75 offen offset:1024 sc1
    s_buffer_load_dwordx4 s[20:23], s[36:39], s96 glc
    ds_read_b64_tr_b16 v[236:237], v7 offset:49152
    ds_read_b64_tr_b16 v[238:239], v7 offset:57344
    ds_read_b64_tr_b16 v[240:241], v8 offset:49152
    ds_read_b64_tr_b16 v[242:243], v8 offset:57344
    s_waitcnt vmcnt(15) lgkmcnt(10)
    v_mfma_f32_32x32x16_bf16 v[36:51], v[244:247], v[116:119], v[36:51]
    s_waitcnt lgkmcnt(8)
    v_mfma_f32_32x32x16_bf16 v[52:67], v[248:251], v[116:119], v[52:67]
    s_waitcnt vmcnt(14)
    v_mfma_f32_32x32x16_bf16 v[68:83], v[244:247], v[120:123], v[68:83]
    v_mfma_f32_32x32x16_bf16 v[84:99], v[248:251], v[120:123], v[84:99]
    ds_read_b64_tr_b16 v[244:245], v9 offset:8192
    ds_read_b64_tr_b16 v[246:247], v9 offset:16384
    ds_read_b64_tr_b16 v[248:249], v10 offset:8192
    ds_read_b64_tr_b16 v[250:251], v10 offset:16384
    s_waitcnt vmcnt(13) lgkmcnt(10)
    v_mfma_f32_32x32x16_bf16 v[36:51], v[228:231], v[124:127], v[36:51]
    s_waitcnt lgkmcnt(8)
    v_mfma_f32_32x32x16_bf16 v[52:67], v[232:235], v[124:127], v[52:67]
    s_waitcnt vmcnt(12)
    v_mfma_f32_32x32x16_bf16 v[68:83], v[228:231], v[128:131], v[68:83]
    v_mfma_f32_32x32x16_bf16 v[84:99], v[232:235], v[128:131], v[84:99]
    s_waitcnt lgkmcnt(0)
    s_cmp_eq_u64 s[20:21], s[94:95]
    s_cbranch_scc0 Lretry_50i
Lok_49:
    buffer_load_dwordx4 v[196:199], v11, s[36:39], s90 offen offset:0 sc1
    buffer_load_dwordx4 v[200:203], v12, s[36:39], s90 offen offset:0 sc1
    buffer_load_dwordx4 v[204:207], v11, s[36:39], s90 offen offset:1024 sc1
    buffer_load_dwordx4 v[208:211], v12, s[36:39], s90 offen offset:1024 sc1
    s_buffer_load_dwordx4 s[20:23], s[36:39], s96 glc
    ds_read_b64_tr_b16 v[228:229], v7 offset:24576
    ds_read_b64_tr_b16 v[230:231], v7 offset:32768
    ds_read_b64_tr_b16 v[232:233], v8 offset:24576
    ds_read_b64_tr_b16 v[234:235], v8 offset:32768
    s_waitcnt vmcnt(15)
    v_mfma_f32_32x32x16_bf16 v[36:51], v[236:239], v[132:135], v[36:51]
    v_mfma_f32_32x32x16_bf16 v[52:67], v[240:243], v[132:135], v[52:67]
    s_waitcnt vmcnt(14)
    v_mfma_f32_32x32x16_bf16 v[68:83], v[236:239], v[136:139], v[68:83]
    v_mfma_f32_32x32x16_bf16 v[84:99], v[240:243], v[136:139], v[84:99]
    ds_read_b64_tr_b16 v[236:237], v5 offset:16384
    ds_read_b64_tr_b16 v[238:239], v5 offset:24576
    ds_read_b64_tr_b16 v[240:241], v6 offset:16384
    ds_read_b64_tr_b16 v[242:243], v6 offset:24576
    s_waitcnt vmcnt(13)
    v_mfma_f32_32x32x16_bf16 v[36:51], v[244:247], v[140:143], v[36:51]
    v_mfma_f32_32x32x16_bf16 v[52:67], v[248:251], v[140:143], v[52:67]
    s_waitcnt vmcnt(12)
    v_mfma_f32_32x32x16_bf16 v[68:83], v[244:247], v[144:147], v[68:83]
    v_mfma_f32_32x32x16_bf16 v[84:99], v[248:251], v[144:147], v[84:99]
    s_cmp_eq_u64 s[22:23], s[94:95]
    s_cbranch_scc0 Lretry_52i
Lok_51:
    s_add_u32 s75, s90, 131072
    buffer_load_dwordx4 v[100:103], v11, s[36:39], s75 offen offset:0 sc1
    buffer_load_dwordx4 v[104:107], v12, s[36:39], s75 offen offset:0 sc1
    buffer_load_dwordx4 v[108:111], v11, s[36:39], s75 offen offset:1024 sc1
    buffer_load_dwordx4 v[112:115], v12, s[36:39], s75 offen offset:1024 sc1
    buffer_load_dword v18, v29, s[36:39], 0 offen sc1
    ds_read_b64_tr_b16 v[244:245], v7 offset:16384
    ds_read_b64_tr_b16 v[246:247], v7 offset:40960
    ds_read_b64_tr_b16 v[248:249], v8 offset:16384
    ds_read_b64_tr_b16 v[250:251], v8 offset:40960
    s_waitcnt vmcnt(12) lgkmcnt(10)
    v_mfma_f32_32x32x16_bf16 v[36:51], v[228:231], v[180:183], v[36:51]
    s_waitcnt lgkmcnt(8)
    v_mfma_f32_32x32x16_bf16 v[52:67], v[232:235], v[180:183], v[52:67]
    s_waitcnt vmcnt(11)
    v_mfma_f32_32x32x16_bf16 v[68:83], v[228:231], v[184:187], v[68:83]
    v_mfma_f32_32x32x16_bf16 v[84:99], v[232:235], v[184:187], v[84:99]
    ds_read_b64_tr_b16 v[228:229], v9 offset:0
    ds_read_b64_tr_b16 v[230:231], v9 offset:24576
    ds_read_b64_tr_b16 v[232:233], v10 offset:0
    ds_read_b64_tr_b16 v[234:235], v10 offset:24576
    s_waitcnt vmcnt(10) lgkmcnt(10)
    v_mfma_f32_32x32x16_bf16 v[36:51], v[236:239], v[188:191], v[36:51]
    s_waitcnt lgkmcnt(8)
    v_mfma_f32_32x32x16_bf16 v[52:67], v[240:243], v[188:191], v[52:67]
    s_waitcnt vmcnt(9)
    v_mfma_f32_32x32x16_bf16 v[68:83], v[236:239], v[192:195], v[68:83]
    v_mfma_f32_32x32x16_bf16 v[84:99], v[240:243], v[192:195], v[84:99]
    ds_read_b64_tr_b16 v[236:237], v5 offset:32768
    ds_read_b64_tr_b16 v[238:239], v5 offset:40960
    ds_read_b64_tr_b16 v[240:241], v6 offset:32768
    ds_read_b64_tr_b16 v[242:243], v6 offset:40960
    s_waitcnt vmcnt(8) lgkmcnt(10)
    v_mfma_f32_32x32x16_bf16 v[36:51], v[244:247], v[196:199], v[36:51]
    s_waitcnt lgkmcnt(8)
    v_mfma_f32_32x32x16_bf16 v[52:67], v[248:251], v[196:199], v[52:67]
    s_waitcnt vmcnt(7)
    v_mfma_f32_32x32x16_bf16 v[68:83], v[244:247], v[200:203], v[68:83]
    v_mfma_f32_32x32x16_bf16 v[84:99], v[248:251], v[200:203], v[84:99]
    ds_read_b64_tr_b16 v[244:245], v7 offset:0
    ds_read_b64_tr_b16 v[246:247], v7 offset:8192
    ds_read_b64_tr_b16 v[248:249], v8 offset:0
    ds_read_b64_tr_b16 v[250:251], v8 offset:8192
    s_waitcnt vmcnt(6) lgkmcnt(10)
    v_mfma_f32_32x32x16_bf16 v[36:51], v[228:231], v[204:207], v[36:51]
    s_waitcnt lgkmcnt(8)
    v_mfma_f32_32x32x16_bf16 v[52:67], v[232:235], v[204:207], v[52:67]
    s_waitcnt vmcnt(5)
    v_mfma_f32_32x32x16_bf16 v[68:83], v[228:231], v[208:211], v[68:83]
    v_mfma_f32_32x32x16_bf16 v[84:99], v[232:235], v[208:211], v[84:99]
    s_waitcnt vmcnt(4) lgkmcnt(4)
    v_mfma_f32_32x32x16_bf16 v[52:67], v[240:243], v[100:103], v[52:67]
    s_waitcnt vmcnt(2) lgkmcnt(0)
    v_mfma_f32_32x32x16_bf16 v[52:67], v[248:251], v[108:111], v[52:67]
    v_add_u32 v22, s71, v2
    v_add_u32 v23, 0x10000, v22
    s_lshl_b32 s74, s65, 10
    v_add_u32 v20, s74, v2
    v_xor_b32 v5, 0x0, v20
    v_mfma_f32_32x32x16_bf16 v[68:83], v[236:239], v[104:107], v[68:83]
    v_xor_b32 v6, 0x4400, v20
    v_xor_b32 v7, 0xc800, v20
    v_xor_b32 v8, 0x14c00, v20
    s_lshl_b32 s74, s69, 1
    s_lshr_b32 s75, s65, 1
    s_waitcnt vmcnt(1)
    v_mfma_f32_32x32x16_bf16 v[68:83], v[244:247], v[112:115], v[68:83]
    ds_write_b128 v22, v[52:55] offset:16384
    ds_write_b128 v22, v[56:59] offset:24576
    ds_write_b128 v22, v[60:63] offset:32768
    ds_write_b128 v22, v[64:67] offset:40960
    v_mfma_f32_32x32x16_bf16 v[84:99], v[240:243], v[104:107], v[84:99]
    s_add_u32 s74, s74, s75
    s_lshl_b32 s74, s74, 15
LIAa_9:
    s_cmp_eq_u32 s63, 1
    s_cbranch_scc1 LIAa_ret
LJAa_3:
    s_cmp_eq_u32 s63, 2
    s_cbranch_scc1 LJAa_7
    s_lshl_b32 s75, s70, 7
    s_add_u32 s74, s74, s75
    s_and_b32 s75, s65, 1
    s_lshl_b32 s75, s75, 6
    v_mfma_f32_32x32x16_bf16 v[84:99], v[248:251], v[112:115], v[84:99]
    ds_write_b128 v22, v[68:71] offset:49152
    ds_write_b128 v22, v[72:75] offset:57344
    ds_write_b128 v23, v[76:79] offset:0
    ds_write_b128 v23, v[80:83] offset:8192
    v_mfma_f32_32x32x16_bf16 v[36:51], v[236:239], v[100:103], v[36:51]
    s_add_u32 s74, s74, s75
    v_lshrrev_b32 v11, 5, v1
    v_lshlrev_b32 v11, 4, v11
    v_and_b32 v21, 31, v1
    v_lshl_add_u32 v11, v21, 10, v11
    v_lshlrev_b32 v196, 16, v24
    v_mfma_f32_32x32x16_bf16 v[36:51], v[244:247], v[108:111], v[36:51]
    ds_write_b128 v23, v[84:87] offset:16384
    ds_write_b128 v23, v[88:91] offset:24576
    ds_write_b128 v23, v[92:95] offset:32768
    ds_write_b128 v23, v[96:99] offset:40960
    v_and_b32 v197, 0xffff0000, v24
    v_lshlrev_b32 v198, 16, v25
    v_and_b32 v199, 0xffff0000, v25
    v_lshlrev_b32 v200, 16, v26
    v_and_b32 v201, 0xffff0000, v26
    v_lshlrev_b32 v202, 16, v27
    v_and_b32 v203, 0xffff0000, v27
    s_nop 0
    ds_write_b128 v22, v[44:47] offset:0
    s_waitcnt lgkmcnt(12)
    ds_write_b128 v22, v[48:51] offset:8192
    v_pk_add_f32 v[36:37], v[36:37], v[196:197]
    v_pk_add_f32 v[38:39], v[38:39], v[198:199]
    v_pk_add_f32 v[40:41], v[40:41], v[200:201]
    v_pk_add_f32 v[42:43], v[42:43], v[202:203]
    s_waitcnt lgkmcnt(0)
    s_barrier
    ds_read_b128 v[100:103], v6 offset:0
    ds_read_b128 v[108:111], v7 offset:0
    ds_read_b128 v[116:119], v8 offset:0
    ds_read_b128 v[124:127], v5 offset:4096
    ds_read_b128 v[132:135], v6 offset:4096
    ds_read_b128 v[140:143], v7 offset:4096
    ds_read_b128 v[148:151], v8 offset:4096
    ds_read_b128 v[104:107], v6 offset:8192
    ds_read_b128 v[112:115], v7 offset:8192
    ds_read_b128 v[120:123], v8 offset:8192
    ds_read_b128 v[128:131], v5 offset:12288
    ds_read_b128 v[136:139], v6 offset:12288
    ds_read_b128 v[144:147], v7 offset:12288
    s_waitcnt lgkmcnt(12)
    ds_read_b128 v[152:155], v8 offset:12288
    s_waitcnt vmcnt(0)
    v_add_f32 v18, 1.0, v18
    v_rcp_f32 v18, v18
    s_nop 0
    v_mov_b32 v19, v18
    v_pk_add_f32 v[36:37], v[36:37], v[100:101]
    v_pk_add_f32 v[38:39], v[38:39], v[102:103]
    s_waitcnt lgkmcnt(12)
    v_pk_add_f32 v[36:37], v[36:37], v[108:109]
    v_pk_add_f32 v[38:39], v[38:39], v[110:111]
    s_waitcnt lgkmcnt(11)
    v_pk_add_f32 v[36:37], v[36:37], v[116:117]
    v_pk_add_f32 v[38:39], v[38:39], v[118:119]
    s_waitcnt lgkmcnt(10)
    v_pk_add_f32 v[36:37], v[36:37], v[124:125]
    v_pk_add_f32 v[38:39], v[38:39], v[126:127]
    s_waitcnt lgkmcnt(9)
    v_pk_add_f32 v[36:37], v[36:37], v[132:133]
    v_pk_add_f32 v[38:39], v[38:39], v[134:135]
    s_waitcnt lgkmcnt(8)
    v_pk_add_f32 v[36:37], v[36:37], v[140:141]
    v_pk_add_f32 v[38:39], v[38:39], v[142:143]
    s_waitcnt lgkmcnt(7)
    v_pk_add_f32 v[36:37], v[36:37], v[148:149]
    v_pk_add_f32 v[38:39], v[38:39], v[150:151]
    v_pk_mul_f32 v[36:37], v[36:37], v[18:19]
    v_pk_mul_f32 v[38:39], v[38:39], v[18:19]
    v_cvt_pk_bf16_f32 v164, v36, v37
    v_cvt_pk_bf16_f32 v165, v38, v39
    s_waitcnt lgkmcnt(6)
    v_pk_add_f32 v[40:41], v[40:41], v[104:105]
    v_pk_add_f32 v[42:43], v[42:43], v[106:107]
    s_waitcnt lgkmcnt(5)
    v_pk_add_f32 v[40:41], v[40:41], v[112:113]
    v_pk_add_f32 v[42:43], v[42:43], v[114:115]
    s_waitcnt lgkmcnt(4)
    v_pk_add_f32 v[40:41], v[40:41], v[120:121]
    v_pk_add_f32 v[42:43], v[42:43], v[122:123]
    s_waitcnt lgkmcnt(3)
    v_pk_add_f32 v[40:41], v[40:41], v[128:129]
    v_pk_add_f32 v[42:43], v[42:43], v[130:131]
    s_waitcnt lgkmcnt(2)
    v_pk_add_f32 v[40:41], v[40:41], v[136:137]
    v_pk_add_f32 v[42:43], v[42:43], v[138:139]
    s_waitcnt lgkmcnt(1)
    v_pk_add_f32 v[40:41], v[40:41], v[144:145]
    v_pk_add_f32 v[42:43], v[42:43], v[146:147]
    s_waitcnt lgkmcnt(0)
    v_pk_add_f32 v[40:41], v[40:41], v[152:153]
    v_pk_add_f32 v[42:43], v[42:43], v[154:155]
    v_pk_mul_f32 v[40:41], v[40:41], v[18:19]
    v_pk_mul_f32 v[42:43], v[42:43], v[18:19]
    v_cvt_pk_bf16_f32 v166, v40, v41
    v_cvt_pk_bf16_f32 v167, v42, v43
    s_nop 0
    v_permlane32_swap_b32 v164, v166
    v_permlane32_swap_b32 v165, v167
    buffer_store_dwordx4 v[164:167], v11, s[32:35], s74 offen offset:0
    s_endpgm
Lretry_28i:
    s_mov_b32 s0, 20000
Lretry_28:
    s_sub_u32 s0, s0, 1
    s_cbranch_scc1 Lok_27
    s_sleep 1
    s_buffer_load_dword s94, s[24:27], 0 glc
Lretry_28w:
    s_waitcnt lgkmcnt(0)
    s_cmp_lg_u32 s94, 0
    s_cbranch_scc0 Lretry_28
    s_branch Lok_27
Lretry_30i:
    s_mov_b32 s0, 20000
Lretry_30:
    s_sub_u32 s0, s0, 1
    s_cbranch_scc1 Lok_29
    s_sleep 1
    s_lshl_b32 s76, s68, 2
    s_buffer_load_dword s1, s[24:27], s76 offset:128 glc
Lretry_30w:
    s_waitcnt lgkmcnt(0)
    s_cmp_eq_u32 s1, 1
    s_cbranch_scc0 Lretry_30
    s_branch Lok_29
Lretry_33i:
    s_mov_b32 s0, 20000
    s_branch Lretry_33w
Lretry_33:
    s_sub_u32 s0, s0, 1
    s_cbranch_scc1 Lok_32
    s_sleep 1
    s_buffer_load_dwordx16 s[4:19], s[36:39], s96 offset:16384 glc
Lretry_33w:
    s_waitcnt lgkmcnt(0)
    s_cmp_eq_u64 s[4:5], s[94:95]
    s_cbranch_scc0 Lretry_33
    s_branch Lok_32
Lretry_36i:
    s_mov_b32 s0, 20000
    s_branch Lretry_36w
Lretry_36:
    s_sub_u32 s0, s0, 1
    s_cbranch_scc1 Lok_35
    s_sleep 1
    s_buffer_load_dwordx4 s[44:47], s[36:39], s85 offset:16 glc
Lretry_36w:
    s_waitcnt lgkmcnt(0)
    s_cmp_eq_u32 s44, 16
    s_cbranch_scc0 Lretry_36
    s_branch Lok_35
Lretry_38i:
    s_mov_b32 s0, 20000
    s_branch Lretry_38w
Lretry_38:
    s_sub_u32 s0, s0, 1
    s_cbranch_scc1 Lok_37
    s_sleep 1
    s_buffer_load_dwordx4 s[44:47], s[36:39], s85 offset:16 glc
Lretry_38w:
    s_waitcnt lgkmcnt(0)
    s_cmp_eq_u64 s[46:47], s[94:95]
    s_cbranch_scc0 Lretry_38
    s_branch Lok_37
Lretry_40i:
    s_mov_b32 s0, 20000
    s_branch Lretry_40w
Lretry_40:
    s_sub_u32 s0, s0, 1
    s_cbranch_scc1 Lok_39
    s_sleep 1
    s_buffer_load_dwordx16 s[4:19], s[36:39], s96 offset:16384 glc
Lretry_40w:
LIAa_10:
    s_cmp_eq_u32 s63, 1
    s_cbranch_scc1 LIAa_ret
LJAa_4:
    s_cmp_eq_u32 s63, 2
    s_cbranch_scc1 LJAa_8
    s_waitcnt lgkmcnt(0)
    s_cmp_eq_u64 s[8:9], s[94:95]
    s_cbranch_scc0 Lretry_40
    s_branch Lok_39
Lretry_42i:
    s_mov_b32 s0, 20000
    s_branch Lretry_42w
Lretry_42:
    s_sub_u32 s0, s0, 1
    s_cbranch_scc1 Lok_41
    s_sleep 1
    s_buffer_load_dwordx16 s[4:19], s[36:39], s96 offset:16384 glc
Lretry_42w:
    s_waitcnt lgkmcnt(0)
    s_cmp_eq_u64 s[12:13], s[94:95]
    s_cbranch_scc0 Lretry_42
    s_branch Lok_41
Lretry_44i:
    s_mov_b32 s0, 20000
    s_branch Lretry_44w
Lretry_44:
    s_sub_u32 s0, s0, 1
    s_cbranch_scc1 Lok_43
    s_sleep 1
    s_buffer_load_dwordx16 s[4:19], s[36:39], s96 offset:16384 glc
Lretry_44w:
    s_waitcnt lgkmcnt(0)
    s_cmp_eq_u64 s[6:7], s[94:95]
    s_cbranch_scc0 Lretry_44
    s_branch Lok_43
Lretry_46i:
    s_mov_b32 s0, 20000
    s_branch Lretry_46w
Lretry_46:
    s_sub_u32 s0, s0, 1
    s_cbranch_scc1 Lok_45
    s_sleep 1
    s_buffer_load_dwordx16 s[4:19], s[36:39], s96 offset:16384 glc
Lretry_46w:
    s_waitcnt lgkmcnt(0)
    s_cmp_eq_u64 s[10:11], s[94:95]
    s_cbranch_scc0 Lretry_46
    s_branch Lok_45
Lretry_48i:
    s_mov_b32 s0, 20000
    s_branch Lretry_48w
Lretry_48:
    s_sub_u32 s0, s0, 1
    s_cbranch_scc1 Lok_47
    s_sleep 1
    s_buffer_load_dwordx16 s[4:19], s[36:39], s96 offset:16384 glc
Lretry_48w:
    s_waitcnt lgkmcnt(0)
    s_cmp_eq_u64 s[14:15], s[94:95]
    s_cbranch_scc0 Lretry_48
    s_branch Lok_47
Lretry_50i:
    s_mov_b32 s0, 20000
Lretry_50:
    s_sub_u32 s0, s0, 1
    s_cbranch_scc1 Lok_49
    s_sleep 1
    s_buffer_load_dwordx4 s[20:23], s[36:39], s96 glc
Lretry_50w:
    s_waitcnt lgkmcnt(0)
    s_cmp_eq_u64 s[20:21], s[94:95]
    s_cbranch_scc0 Lretry_50
    s_branch Lok_49
Lretry_52i:
    s_mov_b32 s0, 20000
    s_branch Lretry_52w
Lretry_52:
    s_sub_u32 s0, s0, 1
    s_cbranch_scc1 Lok_51
    s_sleep 1
    s_buffer_load_dwordx4 s[20:23], s[36:39], s96 glc
Lretry_52w:
    s_waitcnt lgkmcnt(0)
    s_cmp_eq_u64 s[22:23], s[94:95]
    s_cbranch_scc0 Lretry_52
    s_branch Lok_51
.p2align 12
L_pathAb:
    s_load_dwordx2 s[12:13], s[0:1], 40
    s_load_dwordx2 s[24:25], s[0:1], 80
    s_load_dwordx2 s[28:29], s[0:1], 48
    s_load_dwordx2 s[40:41], s[0:1], 16
    s_load_dwordx2 s[32:33], s[0:1], 72
    s_load_dwordx2 s[16:17], s[0:1], 56
    v_lshrrev_b32 v20, 3, v1
    v_and_b32 v21, 7, v1
    v_lshrrev_b32 v22, 4, v1
    v_xor_b32 v23, v21, v22
    v_lshlrev_b32 v23, 4, v23
    v_lshl_add_u32 v23, v20, 10, v23
    s_lshl_b32 s76, s66, 3
    s_add_u32 s76, s76, s64
    s_lshl_b32 s77, s76, 14
    v_add_u32 v96, s77, v23
    v_xor_b32 v97, 64, v96
    v_add_u32 v97, 7168, v97
    v_and_b32 v22, 1, v22
    v_lshlrev_b32 v22, 2, v22
    v_xor_b32 v21, v21, v22
    v_lshlrev_b32 v21, 4, v21
    s_and_b32 s62, s92, 7
    s_and_b32 s75, s93, 6
    s_xor_b32 s62, s62, s75
    s_lshl_b32 s62, s62, 7
    s_mul_i32 s75, s62, 1536
    s_lshl_b32 s72, s64, 11
    s_lshl_b32 s71, s64, 10
    s_add_u32 s73, s71, 65536
    s_mov_b32 m0, s72
    s_mov_b32 s6, 0x200000
    s_mov_b32 s7, 0x20000
    s_mov_b32 s10, 0x180000
    s_mov_b32 s11, 0x20000
    s_lshl_b32 s3, s68, 7
    s_mul_i32 s77, s64, 24576
    s_add_u32 s77, s77, s3
    v_mul_u32_u24 v98, 3072, v20
    v_lshl_add_u32 v4, v20, 10, v21
    s_and_b32 s76, s64, 1
    s_lshl_b32 s76, s76, 5
    v_xor_b32 v21, s76, v21
    v_add3_u32 v98, v98, v21, s77
    s_waitcnt lgkmcnt(0)
    buffer_load_dwordx4 v96, s[4:7], s62 offen offset:0 lds
    buffer_load_dwordx4 v97, s[4:7], s62 offen offset:1024 lds
    s_add_u32 m0, s73, -1024
    s_nop 0
    buffer_load_dwordx4 v98, s[8:11], s75 offen offset:1024 lds
    s_add_u32 m0, s73, 6144
    s_nop 0
    buffer_load_dwordx4 v98, s[8:11], s75 offen offset:2048 lds
    s_add_u32 m0, s73, 16384
    s_nop 0
    buffer_load_dwordx4 v98, s[8:11], s75 offen offset:0 lds
    s_lshl_b32 s76, s2, 3
    s_add_u32 s76, s76, s64
    s_lshl_b32 s77, s76, 10
    s_add_u32 s77, s77, 0x800000
    s_lshl_b32 s76, s76, 7
    s_add_u32 s76, s76, 0x77a000
    s_cmp_lt_u32 s2, 64
    s_cselect_b32 s76, s77, s76
    s_cmp_lt_u32 s2, 80
    s_cbranch_scc0 Lnop_53
    s_load_dword s95, s[36:37], s76 glc
Lnop_53:
    s_mov_b32 s63, 1
    s_and_b32 s76, s93, 3
    s_lshl_b32 s76, s76, 2
    s_add_u32 s76, s76, s64
    s_cmp_eq_u32 s76, 4
    s_cbranch_scc1 LIAb_0
    s_cmp_eq_u32 s76, 5
    s_cbranch_scc1 LIAb_1
    s_cmp_eq_u32 s76, 6
    s_cbranch_scc1 LIAb_2
    s_cmp_eq_u32 s76, 7
    s_cbranch_scc1 LIAb_3
    s_cmp_eq_u32 s76, 8
    s_cbranch_scc1 LIAb_4
    s_cmp_eq_u32 s76, 9
    s_cbranch_scc1 LIAb_5
    s_cmp_eq_u32 s76, 10
    s_cbranch_scc1 LIAb_6
    s_cmp_eq_u32 s76, 11
    s_cbranch_scc1 LIAb_7
    s_cmp_eq_u32 s76, 12
    s_cbranch_scc1 LIAb_8
    s_cmp_eq_u32 s76, 13
    s_cbranch_scc1 LIAb_9
    s_cmp_eq_u32 s76, 14
    s_cbranch_scc1 LIAb_10
    s_cmp_eq_u32 s76, 15
    s_cbranch_scc1 LIAb_11
    s_cmp_eq_u32 s76, 16
    s_cbranch_scc1 LIAb_12
LIAb_10:
LIAb_11:
LIAb_12:
LIAb_ret:
    s_mov_b32 s63, 0
    s_barrier
    s_add_u32 m0, s72, 16384
    s_xor_b32 s74, s62, 128
    buffer_load_dwordx4 v96, s[4:7], s74 offen offset:0 lds
    buffer_load_dwordx4 v97, s[4:7], s74 offen offset:1024 lds
    s_add_u32 m0, s73, 23552
    s_xor_b32 s75, s62, 128
    s_mul_i32 s75, s75, 1536
    buffer_load_dwordx4 v98, s[8:11], s75 offen offset:1024 lds
    s_add_u32 m0, s73, 30720
    s_nop 0
    buffer_load_dwordx4 v98, s[8:11], s75 offen offset:2048 lds
    s_add_u32 m0, s73, 40960
    s_nop 0
    buffer_load_dwordx4 v98, s[8:11], s75 offen offset:0 lds
    s_and_b32 s65, s64, 3
    v_and_b32 v20, 15, v1
    v_lshrrev_b32 v21, 4, v1
    v_bfe_u32 v22, v1, 1, 3
    v_xor_b32 v22, v22, v21
    v_lshlrev_b32 v22, 4, v22
    v_lshl_add_u32 v22, v20, 7, v22
    s_lshl_b32 s76, s65, 12
    v_add_u32 v180, s76, v22
    v_xor_b32 v181, 64, v180
    v_bfe_u32 v20, v1, 2, 2
    v_and_b32 v22, 3, v1
    v_lshlrev_b32 v22, 3, v22
    v_bfe_u32 v23, v1, 4, 1
    v_lshl_add_u32 v22, v23, 5, v22
    v_bfe_u32 v23, v1, 3, 1
    v_lshl_add_u32 v22, v23, 6, v22
    v_lshl_add_u32 v22, v20, 7, v22
    v_lshl_add_u32 v23, v21, 10, v22
    v_xor_b32 v182, 0x10040, v23
    v_add_u32 v183, 49152, v182
    v_xor_b32 v184, 32, v182
    v_xor_b32 v185, 32, v183
    v_lshrrev_b32 v21, 5, v1
    v_lshl_add_u32 v5, v21, 9, v22
    v_lshlrev_b32 v2, 4, v1
    v_mov_b32 v33, 0
    s_mov_b32 s38, 0x900080
    s_mov_b32 s39, 0x20000
    s_mov_b32 s26, 0x100
    s_mov_b32 s27, 0x20000
    s_lshl_b32 s80, s66, 2
    s_add_u32 s80, s80, s65
    s_lshl_b32 s79, s80, 11
    v_and_b32 v20, 15, v1
    v_lshrrev_b32 v22, 4, v1
    v_lshlrev_b32 v22, 9, v22
    v_lshl_add_u32 v22, v20, 4, v22
    v_add_u32 v28, s79, v22
    s_lshr_b32 s79, s68, 1
    s_lshl_b32 s79, s79, 13
    s_lshl_b32 s80, s80, 7
    s_add_u32 s79, s79, s80
    s_add_u32 s79, s79, 0x798000
    v_and_b32 v20, 15, v1
    v_lshl_add_u32 v35, v20, 2, s79
    s_lshl_b32 s86, s68, 18
    s_lshl_b32 s69, s92, 2
    s_and_b32 s79, s93, 3
    s_add_u32 s69, s69, s79
    s_lshr_b32 s70, s93, 2
    s_lshl_b32 s79, s70, 7
    v_add_u32 v4, s79, v4
    s_or_b32 s77, s66, s65
    s_cbranch_scc1 Lnoinit_54
    v_mov_b32 v156, 0
    v_mov_b32 v157, 0
    v_mov_b32 v158, 0
    v_mov_b32 v159, 0
    s_mul_i32 s76, s68, 4608
    s_add_u32 s76, s76, 0x780000
    buffer_store_dwordx4 v[156:159], v2, s[36:39], s76 offen offset:0 sc1
    buffer_store_dwordx4 v[156:159], v2, s[36:39], s76 offen offset:1024 sc1
    buffer_store_dwordx4 v[156:159], v2, s[36:39], s76 offen offset:2048 sc1
    buffer_store_dwordx4 v[156:159], v2, s[36:39], s76 offen offset:3072 sc1
    s_add_u32 s76, s76, 4096
    s_mov_b32 exec_hi, 0
    buffer_store_dwordx4 v[156:159], v2, s[36:39], s76 offen sc1
    v_lshrrev_b32 v160, 1, v1
    v_and_b32 v161, 1, v1
    v_lshlrev_b32 v160, 15, v160
    s_lshl_b32 s76, s68, 11
    v_lshl_add_u32 v160, v161, 10, v160
LIAb_0:
    s_cmp_eq_u32 s63, 1
    s_cbranch_scc1 LIAb_ret
    s_add_u32 s76, s76, 0x800000
    buffer_store_dword v156, v160, s[36:39], s76 offen offset:16 sc1
    s_mov_b64 exec, -1
Lnoinit_54:
    s_nop 1
    s_waitcnt lgkmcnt(0)
    s_waitcnt vmcnt(11)
    s_or_b32 s77, s66, s65
    s_cbranch_scc0 Liw_55
    s_waitcnt vmcnt(5)
Liw_55:
    s_barrier
    ds_read_b128 v[72:75], v180 offset:0
    ds_read_b64_tr_b16 v[36:37], v182 offset:0
    ds_read_b64_tr_b16 v[38:39], v182 offset:512
    ds_read_b64_tr_b16 v[40:41], v182 offset:8192
    ds_read_b64_tr_b16 v[42:43], v182 offset:8704
    ds_read_b64_tr_b16 v[44:45], v182 offset:16384
    ds_read_b64_tr_b16 v[46:47], v182 offset:16896
    ds_read_b128 v[76:79], v180 offset:2048
    ds_read_b64_tr_b16 v[48:49], v184 offset:0
    ds_read_b64_tr_b16 v[50:51], v184 offset:512
    ds_read_b64_tr_b16 v[52:53], v184 offset:8192
    ds_read_b64_tr_b16 v[54:55], v184 offset:8704
    ds_read_b64_tr_b16 v[56:57], v184 offset:16384
    ds_read_b64_tr_b16 v[58:59], v184 offset:16896
    s_waitcnt lgkmcnt(11)
    v_mfma_f32_16x16x32_bf16 v[100:103], v[72:75], v[36:39], 0
    ds_read_b128 v[80:83], v181 offset:0
    ds_read_b64_tr_b16 v[60:61], v182 offset:4096
    s_waitcnt lgkmcnt(8)
    v_mfma_f32_16x16x32_bf16 v[104:107], v[76:79], v[36:39], 0
    ds_read_b64_tr_b16 v[62:63], v182 offset:4608
    s_add_u32 m0, s72, 32768
    s_xor_b32 s74, s62, 256
    buffer_load_dwordx4 v96, s[4:7], s74 offen offset:0 lds
    s_mov_b32 s30, 0x158000
    s_mov_b32 s31, 0x20000
    v_mfma_f32_16x16x32_bf16 v[116:119], v[72:75], v[40:43], 0
    ds_read_b64_tr_b16 v[64:65], v182 offset:12288
    ds_read_b64_tr_b16 v[66:67], v182 offset:12800
    v_mfma_f32_16x16x32_bf16 v[120:123], v[76:79], v[40:43], 0
    s_mov_b32 s42, 0x80000
    s_mov_b32 s43, 0x20000
    v_mfma_f32_16x16x32_bf16 v[132:135], v[44:47], v[72:75], 0
    ds_read_b64_tr_b16 v[68:69], v182 offset:20480
    ds_read_b64_tr_b16 v[70:71], v182 offset:20992
    v_mfma_f32_16x16x32_bf16 v[140:143], v[44:47], v[76:79], 0
    s_mul_i32 s79, s64, 5
    s_min_u32 s80, s64, 3
    s_add_u32 s79, s79, s80
    s_lshl_b32 s87, s79, 15
    s_add_u32 s79, s79, 16
    s_lshl_b32 s89, s79, 17
    s_waitcnt lgkmcnt(11)
    v_mfma_f32_16x16x32_bf16 v[108:111], v[72:75], v[48:51], 0
    ds_read_b128 v[84:87], v181 offset:2048
    ds_read_b64_tr_b16 v[36:37], v184 offset:4096
    v_mfma_f32_16x16x32_bf16 v[112:115], v[76:79], v[48:51], 0
    ds_read_b64_tr_b16 v[38:39], v184 offset:4608
    buffer_load_dwordx4 v97, s[4:7], s74 offen offset:1024 lds
    s_lshl_b32 s88, s64, 16
    s_lshl_b32 s90, s64, 18
    s_waitcnt lgkmcnt(12)
    v_mfma_f32_16x16x32_bf16 v[124:127], v[72:75], v[52:55], 0
    ds_read_b64_tr_b16 v[40:41], v184 offset:12288
    ds_read_b64_tr_b16 v[42:43], v184 offset:12800
    v_mfma_f32_16x16x32_bf16 v[128:131], v[76:79], v[52:55], 0
    s_add_u32 m0, s73, 48128
    s_xor_b32 s75, s62, 256
    s_mul_i32 s75, s75, 1536
    buffer_load_dwordx4 v98, s[8:11], s75 offen offset:1024 lds
    s_mov_b32 s82, 0x3fb8aa3b
    s_mov_b32 s83, 0x3fb8aa3b
    s_waitcnt lgkmcnt(12)
    v_mfma_f32_16x16x32_bf16 v[136:139], v[56:59], v[72:75], 0
    ds_read_b64_tr_b16 v[44:45], v184 offset:20480
    ds_read_b64_tr_b16 v[46:47], v184 offset:20992
    v_mfma_f32_16x16x32_bf16 v[144:147], v[56:59], v[76:79], 0
    s_lshr_b32 s79, s65, 1
    s_add_u32 s79, s79, s65
    s_lshl_b32 s79, s79, 13
    s_add_u32 s79, s79, 118784
    v_add_u32 v34, s79, v2
    v_lshl_add_u32 v34, v21, 9, v34
    s_waitcnt lgkmcnt(0)
    s_waitcnt vmcnt(9)
    s_or_b32 s77, s66, s65
    s_cbranch_scc0 Liw_56
    s_waitcnt vmcnt(3)
Liw_56:
    s_barrier
    v_mfma_f32_16x16x32_bf16 v[100:103], v[80:83], v[60:63], v[100:103]
    ds_read_b128 v[72:75], v180 offset:16384
    ds_read_b64_tr_b16 v[48:49], v182 offset:24576
    v_mfma_f32_16x16x32_bf16 v[104:107], v[84:87], v[60:63], v[104:107]
    ds_read_b64_tr_b16 v[50:51], v182 offset:25088
    s_add_u32 m0, s73, 55296
    s_nop 0
    buffer_load_dwordx4 v98, s[8:11], s75 offen offset:2048 lds
    s_add_u32 s79, s71, 114688
    v_lshl_add_u32 v188, v1, 2, s79
    s_add_u32 s79, s79, 512
    v_bfe_u32 v189, v1, 2, 1
    v_and_b32 v190, 3, v1
    v_lshlrev_b32 v190, 2, v190
    v_lshl_add_u32 v189, v189, 8, v190
    v_add_u32 v189, s79, v189
    v_mfma_f32_16x16x32_bf16 v[116:119], v[80:83], v[64:67], v[116:119]
    ds_read_b64_tr_b16 v[52:53], v182 offset:32768
    ds_read_b64_tr_b16 v[54:55], v182 offset:33280
    v_mfma_f32_16x16x32_bf16 v[120:123], v[84:87], v[64:67], v[120:123]
    v_cmp_gt_u32 vcc, 8, v1
    v_lshlrev_b32 v190, 2, v1
    v_mov_b32 v191, 0x40000000
    v_cndmask_b32 v191, v191, v190, vcc
    v_mfma_f32_16x16x32_bf16 v[132:135], v[68:71], v[80:83], v[132:135]
    ds_read_b64_tr_b16 v[56:57], v182 offset:40960
    ds_read_b64_tr_b16 v[58:59], v182 offset:41472
    v_mfma_f32_16x16x32_bf16 v[140:143], v[68:71], v[84:87], v[140:143]
    s_lshl_b32 s79, s68, 3
    s_add_u32 s79, s79, s64
    s_mul_i32 s78, s79, 576
    s_add_u32 s78, s78, 0x780000
    v_mfma_f32_16x16x32_bf16 v[108:111], v[80:83], v[36:39], v[108:111]
    ds_read_b128 v[76:79], v180 offset:18432
    ds_read_b64_tr_b16 v[60:61], v184 offset:24576
    v_mfma_f32_16x16x32_bf16 v[112:115], v[84:87], v[36:39], v[112:115]
    ds_read_b64_tr_b16 v[62:63], v184 offset:25088
    s_add_u32 m0, s73, 65536
    s_nop 0
    buffer_load_dwordx4 v98, s[8:11], s75 offen offset:0 lds
    s_mul_i32 s79, s68, 4608
    s_add_u32 s79, s79, 0x780900
    v_mul_u32_u24 v22, 576, v21
    v_add_u32 v22, s79, v22
    v_and_b32 v20, 31, v1
    v_lshl_add_u32 v32, v20, 4, v22
    v_and_b32 v20, 16, v1
    v_add_u32 v22, v20, v22
    v_and_b32 v20, 1, v1
    v_mul_u32_u24 v20, 1152, v20
    v_add_u32 v15, v20, v22
    v_mfma_f32_16x16x32_bf16 v[124:127], v[80:83], v[40:43], v[124:127]
    ds_read_b64_tr_b16 v[64:65], v184 offset:32768
    ds_read_b64_tr_b16 v[66:67], v184 offset:33280
    v_mfma_f32_16x16x32_bf16 v[128:131], v[84:87], v[40:43], v[128:131]
    s_add_u32 m0, s72, 49152
    s_xor_b32 s74, s62, 384
    buffer_load_dwordx4 v96, s[4:7], s74 offen offset:0 lds
    s_lshl_b32 s81, s66, 15
    s_lshr_b32 s79, s65, 1
    s_lshl_b32 s79, s79, 10
    s_add_u32 s81, s81, s79
    s_and_b32 s79, s65, 1
    s_lshl_b32 s79, s79, 2
    s_add_u32 s81, s81, s79
    s_add_u32 s81, s81, 0x800000
LIAb_1:
    s_cmp_eq_u32 s63, 1
    s_cbranch_scc1 LIAb_ret
    v_mfma_f32_16x16x32_bf16 v[136:139], v[44:47], v[80:83], v[136:139]
    ds_read_b64_tr_b16 v[68:69], v184 offset:40960
    ds_read_b64_tr_b16 v[70:71], v184 offset:41472
    v_mfma_f32_16x16x32_bf16 v[144:147], v[44:47], v[84:87], v[144:147]
    s_lshl_b32 s79, s67, 11
    s_add_u32 s79, s79, s81
    v_mov_b32 v13, s79
    s_waitcnt lgkmcnt(11)
    v_mfma_f32_16x16x32_bf16 v[100:103], v[72:75], v[48:51], v[100:103]
    ds_read_b128 v[80:83], v181 offset:16384
    ds_read_b64_tr_b16 v[36:37], v182 offset:28672
    s_waitcnt lgkmcnt(8)
    v_mfma_f32_16x16x32_bf16 v[104:107], v[76:79], v[48:51], v[104:107]
    ds_read_b64_tr_b16 v[38:39], v182 offset:29184
    buffer_load_dwordx4 v97, s[4:7], s74 offen offset:1024 lds
    s_lshl_b32 s79, s67, 11
    s_add_u32 s79, s79, s81
    s_andn2_b32 s85, s79, 7
    v_mfma_f32_16x16x32_bf16 v[116:119], v[72:75], v[52:55], v[116:119]
    ds_read_b64_tr_b16 v[40:41], v182 offset:36864
    ds_read_b64_tr_b16 v[42:43], v182 offset:37376
    v_mfma_f32_16x16x32_bf16 v[120:123], v[76:79], v[52:55], v[120:123]
    s_and_b32 s79, s64, 1
    s_lshl_b32 s79, s79, 6
    s_add_u32 s79, s79, s71
    v_xor_b32 v5, s79, v5
    v_xor_b32 v6, 64, v5
    v_mfma_f32_16x16x32_bf16 v[132:135], v[56:59], v[72:75], v[132:135]
    ds_read_b64_tr_b16 v[44:45], v182 offset:45056
    ds_read_b64_tr_b16 v[46:47], v182 offset:45568
    v_mfma_f32_16x16x32_bf16 v[140:143], v[56:59], v[76:79], v[140:143]
    v_add_u32 v7, 0x10000, v5
    v_add_u32 v8, 0x10000, v6
    v_lshlrev_b32 v206, 7, v1
    v_mov_b32 v207, 0x40000000
    v_cmp_gt_u32 vcc, 8, v1
    s_lshl_b32 s76, s2, 3
    s_add_u32 s76, s76, s64
    v_cndmask_b32 v206, v207, v206, vcc
    s_lshl_b32 s76, s76, 10
    s_sub_u32 s77, s76, 1409024
    s_cbranch_scc0 Ltu_57
    buffer_load_dword v207, v206, s[28:31], s76 offen
    s_branch Ltv_58
Ltu_57:
    buffer_load_dword v207, v206, s[40:43], s77 offen
Ltv_58:
    s_mov_b32 s18, 0x400
    s_mov_b32 s19, 0x20000
    s_lshl_b32 s79, s70, 7
    s_and_b32 s80, s65, 1
    s_lshl_b32 s80, s80, 6
    s_add_u32 s79, s79, s80
    v_lshlrev_b32 v22, 3, v21
    buffer_load_dwordx2 v[24:25], v22, s[16:19], s79 offen offset:32
    buffer_load_dwordx2 v[26:27], v22, s[16:19], s79 offen offset:48
    s_waitcnt lgkmcnt(11)
    v_mfma_f32_16x16x32_bf16 v[108:111], v[72:75], v[60:63], v[108:111]
    ds_read_b128 v[84:87], v181 offset:18432
    ds_read_b64_tr_b16 v[48:49], v184 offset:28672
    v_mfma_f32_16x16x32_bf16 v[112:115], v[76:79], v[60:63], v[112:115]
    ds_read_b64_tr_b16 v[50:51], v184 offset:29184
    s_add_u32 m0, s73, 72704
    s_xor_b32 s75, s62, 384
    s_mul_i32 s75, s75, 1536
    buffer_load_dwordx4 v98, s[8:11], s75 offen offset:1024 lds
    v_add_u32 v9, 0x10000, v7
    v_add_u32 v10, 0x10000, v8
    s_waitcnt lgkmcnt(12)
    v_mfma_f32_16x16x32_bf16 v[124:127], v[72:75], v[64:67], v[124:127]
    ds_read_b64_tr_b16 v[52:53], v184 offset:36864
    ds_read_b64_tr_b16 v[54:55], v184 offset:37376
    v_mfma_f32_16x16x32_bf16 v[128:131], v[76:79], v[64:67], v[128:131]
    s_add_u32 m0, s73, 79872
    s_nop 0
    buffer_load_dwordx4 v98, s[8:11], s75 offen offset:2048 lds
    s_mov_b32 s34, 0x200000
    s_mov_b32 s35, 0x20000
    s_waitcnt lgkmcnt(12)
    v_mfma_f32_16x16x32_bf16 v[136:139], v[68:71], v[72:75], v[136:139]
    ds_read_b64_tr_b16 v[56:57], v184 offset:45056
    ds_read_b64_tr_b16 v[58:59], v184 offset:45568
    v_mfma_f32_16x16x32_bf16 v[144:147], v[68:71], v[76:79], v[144:147]
    s_lshl_b32 s79, s69, 1
    s_lshr_b32 s80, s65, 1
    s_add_u32 s79, s79, s80
    s_lshl_b32 s80, s79, 11
    v_add_u32 v11, s80, v2
    v_xor_b32 v12, 2048, v11
    s_lshl_b32 s79, s79, 7
    s_lshr_b32 s80, s64, 1
    s_lshl_b32 s80, s80, 13
    s_add_u32 s79, s79, s80
    s_add_u32 s79, s79, 0x798000
    v_and_b32 v20, 31, v1
    v_lshl_add_u32 v29, v20, 2, s79
    s_waitcnt vmcnt(7) lgkmcnt(0)
    s_barrier
    v_mfma_f32_16x16x32_bf16 v[100:103], v[80:83], v[36:39], v[100:103]
    ds_read_b128 v[72:75], v180 offset:32768
    ds_read_b64_tr_b16 v[60:61], v183 offset:0
    v_mfma_f32_16x16x32_bf16 v[104:107], v[84:87], v[36:39], v[104:107]
    ds_read_b64_tr_b16 v[62:63], v183 offset:512
    s_add_u32 m0, s73, 90112
    s_nop 0
    buffer_load_dwordx4 v98, s[8:11], s75 offen offset:0 lds
    s_lshr_b32 s79, s69, 1
    s_lshl_b32 s79, s79, 15
    s_and_b32 s80, s69, 1
    s_lshl_b32 s80, s80, 10
    s_add_u32 s79, s79, s80
    s_add_u32 s79, s79, 0x800000
    s_add_u32 s96, s79, s72
    v_mfma_f32_16x16x32_bf16 v[116:119], v[80:83], v[40:43], v[116:119]
    ds_read_b64_tr_b16 v[64:65], v183 offset:8192
    ds_read_b64_tr_b16 v[66:67], v183 offset:8704
    v_mfma_f32_16x16x32_bf16 v[120:123], v[84:87], v[40:43], v[120:123]
    v_mfma_f32_16x16x32_bf16 v[132:135], v[44:47], v[80:83], v[132:135]
    ds_read_b64_tr_b16 v[68:69], v183 offset:16384
    ds_read_b64_tr_b16 v[70:71], v183 offset:16896
    v_mfma_f32_16x16x32_bf16 v[140:143], v[44:47], v[84:87], v[140:143]
    v_mfma_f32_16x16x32_bf16 v[108:111], v[80:83], v[48:51], v[108:111]
    ds_read_b128 v[76:79], v180 offset:34816
    ds_read_b64_tr_b16 v[36:37], v185 offset:0
    v_mfma_f32_16x16x32_bf16 v[112:115], v[84:87], v[48:51], v[112:115]
    ds_read_b64_tr_b16 v[38:39], v185 offset:512
    s_add_u32 m0, s72, 0
    s_xor_b32 s74, s62, 512
    buffer_load_dwordx4 v96, s[4:7], s74 offen offset:0 lds
    v_mfma_f32_16x16x32_bf16 v[124:127], v[80:83], v[52:55], v[124:127]
    ds_read_b64_tr_b16 v[40:41], v185 offset:8192
    ds_read_b64_tr_b16 v[42:43], v185 offset:8704
    v_mfma_f32_16x16x32_bf16 v[128:131], v[84:87], v[52:55], v[128:131]
    buffer_load_dwordx4 v97, s[4:7], s74 offen offset:1024 lds
    v_mfma_f32_16x16x32_bf16 v[136:139], v[56:59], v[80:83], v[136:139]
    ds_read_b64_tr_b16 v[44:45], v185 offset:16384
    ds_read_b64_tr_b16 v[46:47], v185 offset:16896
    v_mfma_f32_16x16x32_bf16 v[144:147], v[56:59], v[84:87], v[144:147]
    s_or_b32 s77, s66, s65
    s_cbranch_scc1 Lnopub_59
    v_mov_b32 v18, 1
    s_lshl_b32 s76, s68, 2
    buffer_store_dword v18, v33, s[24:27], s76 offen offset:128 sc1
Lnopub_59:
    s_waitcnt lgkmcnt(11)
    v_mfma_f32_16x16x32_bf16 v[100:103], v[72:75], v[60:63], v[100:103]
    ds_read_b128 v[80:83], v181 offset:32768
    ds_read_b64_tr_b16 v[48:49], v183 offset:4096
    s_waitcnt lgkmcnt(8)
    v_mfma_f32_16x16x32_bf16 v[104:107], v[76:79], v[60:63], v[104:107]
    ds_read_b64_tr_b16 v[50:51], v183 offset:4608
    s_add_u32 m0, s73, -1024
    s_xor_b32 s75, s62, 512
    s_mul_i32 s75, s75, 1536
    buffer_load_dwordx4 v98, s[8:11], s75 offen offset:1024 lds
    v_mfma_f32_16x16x32_bf16 v[116:119], v[72:75], v[64:67], v[116:119]
    ds_read_b64_tr_b16 v[52:53], v183 offset:12288
    ds_read_b64_tr_b16 v[54:55], v183 offset:12800
LIAb_2:
    s_cmp_eq_u32 s63, 1
    s_cbranch_scc1 LIAb_ret
    v_mfma_f32_16x16x32_bf16 v[120:123], v[76:79], v[64:67], v[120:123]
    v_mfma_f32_16x16x32_bf16 v[132:135], v[68:71], v[72:75], v[132:135]
    ds_read_b64_tr_b16 v[56:57], v183 offset:20480
    ds_read_b64_tr_b16 v[58:59], v183 offset:20992
    v_mfma_f32_16x16x32_bf16 v[140:143], v[68:71], v[76:79], v[140:143]
    s_waitcnt lgkmcnt(11)
    v_mfma_f32_16x16x32_bf16 v[108:111], v[72:75], v[36:39], v[108:111]
    ds_read_b128 v[84:87], v181 offset:34816
    ds_read_b64_tr_b16 v[60:61], v185 offset:4096
    v_mfma_f32_16x16x32_bf16 v[112:115], v[76:79], v[36:39], v[112:115]
    ds_read_b64_tr_b16 v[62:63], v185 offset:4608
    s_add_u32 m0, s73, 6144
    s_nop 0
    buffer_load_dwordx4 v98, s[8:11], s75 offen offset:2048 lds
    s_waitcnt lgkmcnt(12)
    v_mfma_f32_16x16x32_bf16 v[124:127], v[72:75], v[40:43], v[124:127]
    ds_read_b64_tr_b16 v[64:65], v185 offset:12288
    ds_read_b64_tr_b16 v[66:67], v185 offset:12800
    v_mfma_f32_16x16x32_bf16 v[128:131], v[76:79], v[40:43], v[128:131]
    s_add_u32 m0, s72, 16384
    s_xor_b32 s74, s62, 640
    buffer_load_dwordx4 v96, s[4:7], s74 offen offset:0 lds
    s_waitcnt lgkmcnt(12)
    v_mfma_f32_16x16x32_bf16 v[136:139], v[44:47], v[72:75], v[136:139]
    ds_read_b64_tr_b16 v[68:69], v185 offset:20480
    ds_read_b64_tr_b16 v[70:71], v185 offset:20992
    v_mfma_f32_16x16x32_bf16 v[144:147], v[44:47], v[76:79], v[144:147]
    s_waitcnt vmcnt(5) lgkmcnt(0)
    s_barrier
    v_mfma_f32_16x16x32_bf16 v[100:103], v[80:83], v[48:51], v[100:103]
    ds_read_b128 v[72:75], v180 offset:49152
    ds_read_b64_tr_b16 v[36:37], v183 offset:24576
    v_mfma_f32_16x16x32_bf16 v[104:107], v[84:87], v[48:51], v[104:107]
    ds_read_b64_tr_b16 v[38:39], v183 offset:25088
    buffer_load_dwordx4 v97, s[4:7], s74 offen offset:1024 lds
    v_mfma_f32_16x16x32_bf16 v[116:119], v[80:83], v[52:55], v[116:119]
    ds_read_b64_tr_b16 v[40:41], v183 offset:32768
    ds_read_b64_tr_b16 v[42:43], v183 offset:33280
    v_mfma_f32_16x16x32_bf16 v[120:123], v[84:87], v[52:55], v[120:123]
    v_mfma_f32_16x16x32_bf16 v[132:135], v[56:59], v[80:83], v[132:135]
    ds_read_b64_tr_b16 v[44:45], v183 offset:40960
    ds_read_b64_tr_b16 v[46:47], v183 offset:41472
    v_mfma_f32_16x16x32_bf16 v[140:143], v[56:59], v[84:87], v[140:143]
    v_mfma_f32_16x16x32_bf16 v[108:111], v[80:83], v[60:63], v[108:111]
    ds_read_b128 v[76:79], v180 offset:51200
    ds_read_b64_tr_b16 v[48:49], v185 offset:24576
    v_mfma_f32_16x16x32_bf16 v[112:115], v[84:87], v[60:63], v[112:115]
    ds_read_b64_tr_b16 v[50:51], v185 offset:25088
    s_add_u32 m0, s73, 23552
    s_xor_b32 s75, s62, 640
    s_mul_i32 s75, s75, 1536
    buffer_load_dwordx4 v98, s[8:11], s75 offen offset:1024 lds
    v_mfma_f32_16x16x32_bf16 v[124:127], v[80:83], v[64:67], v[124:127]
    ds_read_b64_tr_b16 v[52:53], v185 offset:32768
    ds_read_b64_tr_b16 v[54:55], v185 offset:33280
    v_mfma_f32_16x16x32_bf16 v[128:131], v[84:87], v[64:67], v[128:131]
    s_add_u32 m0, s73, 30720
    s_nop 0
    buffer_load_dwordx4 v98, s[8:11], s75 offen offset:2048 lds
    v_mfma_f32_16x16x32_bf16 v[136:139], v[68:71], v[80:83], v[136:139]
    ds_read_b64_tr_b16 v[56:57], v185 offset:40960
    ds_read_b64_tr_b16 v[58:59], v185 offset:41472
    v_mfma_f32_16x16x32_bf16 v[144:147], v[68:71], v[84:87], v[144:147]
    s_waitcnt lgkmcnt(11)
    v_mfma_f32_16x16x32_bf16 v[100:103], v[72:75], v[36:39], v[100:103]
    ds_read_b128 v[80:83], v181 offset:49152
    ds_read_b64_tr_b16 v[60:61], v183 offset:28672
    s_waitcnt lgkmcnt(8)
    v_mfma_f32_16x16x32_bf16 v[104:107], v[76:79], v[36:39], v[104:107]
    ds_read_b64_tr_b16 v[62:63], v183 offset:29184
    s_add_u32 m0, s72, 32768
    s_xor_b32 s74, s62, 768
    buffer_load_dwordx4 v96, s[4:7], s74 offen offset:0 lds
    v_mfma_f32_16x16x32_bf16 v[116:119], v[72:75], v[40:43], v[116:119]
    ds_read_b64_tr_b16 v[64:65], v183 offset:36864
    ds_read_b64_tr_b16 v[66:67], v183 offset:37376
    v_mfma_f32_16x16x32_bf16 v[120:123], v[76:79], v[40:43], v[120:123]
    v_mfma_f32_16x16x32_bf16 v[132:135], v[44:47], v[72:75], v[132:135]
    ds_read_b64_tr_b16 v[68:69], v183 offset:45056
    ds_read_b64_tr_b16 v[70:71], v183 offset:45568
    v_mfma_f32_16x16x32_bf16 v[140:143], v[44:47], v[76:79], v[140:143]
    s_waitcnt lgkmcnt(11)
    v_mfma_f32_16x16x32_bf16 v[108:111], v[72:75], v[48:51], v[108:111]
    ds_read_b128 v[84:87], v181 offset:51200
    ds_read_b64_tr_b16 v[36:37], v185 offset:28672
    v_mfma_f32_16x16x32_bf16 v[112:115], v[76:79], v[48:51], v[112:115]
    ds_read_b64_tr_b16 v[38:39], v185 offset:29184
    buffer_load_dwordx4 v97, s[4:7], s74 offen offset:1024 lds
    s_waitcnt lgkmcnt(12)
    v_mfma_f32_16x16x32_bf16 v[124:127], v[72:75], v[52:55], v[124:127]
    ds_read_b64_tr_b16 v[40:41], v185 offset:36864
    ds_read_b64_tr_b16 v[42:43], v185 offset:37376
    v_mfma_f32_16x16x32_bf16 v[128:131], v[76:79], v[52:55], v[128:131]
    s_add_u32 m0, s73, 48128
    s_xor_b32 s75, s62, 768
    s_mul_i32 s75, s75, 1536
    buffer_load_dwordx4 v98, s[8:11], s75 offen offset:1024 lds
    s_waitcnt lgkmcnt(12)
    v_mfma_f32_16x16x32_bf16 v[136:139], v[56:59], v[72:75], v[136:139]
    ds_read_b64_tr_b16 v[44:45], v185 offset:45056
    ds_read_b64_tr_b16 v[46:47], v185 offset:45568
    v_mfma_f32_16x16x32_bf16 v[144:147], v[56:59], v[76:79], v[144:147]
    s_waitcnt vmcnt(7) lgkmcnt(0)
    s_barrier
    v_mfma_f32_16x16x32_bf16 v[100:103], v[80:83], v[60:63], v[100:103]
    ds_read_b128 v[192:195], v180 offset:0
    ds_read_b64_tr_b16 v[48:49], v182 offset:0
    v_mfma_f32_16x16x32_bf16 v[104:107], v[84:87], v[60:63], v[104:107]
    ds_read_b64_tr_b16 v[50:51], v182 offset:512
    s_add_u32 m0, s73, 55296
    s_nop 0
    buffer_load_dwordx4 v98, s[8:11], s75 offen offset:2048 lds
    v_mfma_f32_16x16x32_bf16 v[116:119], v[80:83], v[64:67], v[116:119]
    ds_read_b64_tr_b16 v[52:53], v182 offset:8192
    ds_read_b64_tr_b16 v[54:55], v182 offset:8704
    v_mfma_f32_16x16x32_bf16 v[120:123], v[84:87], v[64:67], v[120:123]
    v_mfma_f32_16x16x32_bf16 v[132:135], v[68:71], v[80:83], v[132:135]
    v_mfma_f32_16x16x32_bf16 v[140:143], v[68:71], v[84:87], v[140:143]
    v_mfma_f32_16x16x32_bf16 v[108:111], v[80:83], v[36:39], v[108:111]
    ds_read_b128 v[196:199], v180 offset:2048
    ds_read_b64_tr_b16 v[60:61], v184 offset:0
    v_mfma_f32_16x16x32_bf16 v[112:115], v[84:87], v[36:39], v[112:115]
    ds_read_b64_tr_b16 v[62:63], v184 offset:512
    s_add_u32 m0, s72, 49152
    s_xor_b32 s74, s62, 896
    buffer_load_dwordx4 v96, s[4:7], s74 offen offset:0 lds
    v_mfma_f32_16x16x32_bf16 v[124:127], v[80:83], v[40:43], v[124:127]
    ds_read_b64_tr_b16 v[64:65], v184 offset:8192
    ds_read_b64_tr_b16 v[66:67], v184 offset:8704
    v_mfma_f32_16x16x32_bf16 v[128:131], v[84:87], v[40:43], v[128:131]
    buffer_load_dwordx4 v97, s[4:7], s74 offen offset:1024 lds
    v_mfma_f32_16x16x32_bf16 v[136:139], v[44:47], v[80:83], v[136:139]
    v_mfma_f32_16x16x32_bf16 v[144:147], v[44:47], v[84:87], v[144:147]
    s_waitcnt lgkmcnt(7)
    v_mfma_f32_16x16x32_bf16 v[100:103], v[192:195], v[48:51], v[100:103]
LIAb_3:
    s_cmp_eq_u32 s63, 1
    s_cbranch_scc1 LIAb_ret
    ds_read_b128 v[200:203], v181 offset:0
    ds_read_b64_tr_b16 v[36:37], v182 offset:4096
    s_waitcnt lgkmcnt(6)
    v_mfma_f32_16x16x32_bf16 v[104:107], v[196:199], v[48:51], v[104:107]
    ds_read_b64_tr_b16 v[38:39], v182 offset:4608
    s_add_u32 m0, s73, 72704
    s_xor_b32 s75, s62, 896
    s_mul_i32 s75, s75, 1536
    buffer_load_dwordx4 v98, s[8:11], s75 offen offset:1024 lds
    v_mfma_f32_16x16x32_bf16 v[116:119], v[192:195], v[52:55], v[116:119]
    ds_read_b64_tr_b16 v[40:41], v182 offset:12288
    ds_read_b64_tr_b16 v[42:43], v182 offset:12800
    v_mfma_f32_16x16x32_bf16 v[120:123], v[196:199], v[52:55], v[120:123]
    s_waitcnt lgkmcnt(7)
    v_mfma_f32_16x16x32_bf16 v[108:111], v[192:195], v[60:63], v[108:111]
    ds_read_b128 v[204:207], v181 offset:2048
    ds_read_b64_tr_b16 v[48:49], v184 offset:4096
    v_mfma_f32_16x16x32_bf16 v[112:115], v[196:199], v[60:63], v[112:115]
    ds_read_b64_tr_b16 v[50:51], v184 offset:4608
    s_add_u32 m0, s73, 79872
    s_nop 0
    buffer_load_dwordx4 v98, s[8:11], s75 offen offset:2048 lds
    s_waitcnt lgkmcnt(8)
    v_mfma_f32_16x16x32_bf16 v[124:127], v[192:195], v[64:67], v[124:127]
    ds_read_b64_tr_b16 v[52:53], v184 offset:12288
    ds_read_b64_tr_b16 v[54:55], v184 offset:12800
    v_mfma_f32_16x16x32_bf16 v[128:131], v[196:199], v[64:67], v[128:131]
    s_add_u32 m0, s73, 16384
    s_xor_b32 s75, s62, 512
    s_mul_i32 s75, s75, 1536
    buffer_load_dwordx4 v98, s[8:11], s75 offen offset:0 lds
    s_waitcnt vmcnt(9) lgkmcnt(0)
    s_barrier
    v_mfma_f32_16x16x32_bf16 v[100:103], v[200:203], v[36:39], v[100:103]
    ds_read_b128 v[208:211], v180 offset:16384
    ds_read_b64_tr_b16 v[60:61], v182 offset:24576
    v_mfma_f32_16x16x32_bf16 v[104:107], v[204:207], v[36:39], v[104:107]
    ds_read_b64_tr_b16 v[62:63], v182 offset:25088
    s_add_u32 m0, s73, 40960
    s_xor_b32 s75, s62, 640
    s_mul_i32 s75, s75, 1536
    buffer_load_dwordx4 v98, s[8:11], s75 offen offset:0 lds
    v_mfma_f32_16x16x32_bf16 v[116:119], v[200:203], v[40:43], v[116:119]
    ds_read_b64_tr_b16 v[64:65], v182 offset:32768
    ds_read_b64_tr_b16 v[66:67], v182 offset:33280
    v_mfma_f32_16x16x32_bf16 v[120:123], v[204:207], v[40:43], v[120:123]
    v_mfma_f32_16x16x32_bf16 v[108:111], v[200:203], v[48:51], v[108:111]
    ds_read_b128 v[212:215], v180 offset:18432
    ds_read_b64_tr_b16 v[36:37], v184 offset:24576
    v_mfma_f32_16x16x32_bf16 v[112:115], v[204:207], v[48:51], v[112:115]
    ds_read_b64_tr_b16 v[38:39], v184 offset:25088
    s_add_u32 m0, s73, 65536
    s_xor_b32 s75, s62, 768
    s_mul_i32 s75, s75, 1536
    buffer_load_dwordx4 v98, s[8:11], s75 offen offset:0 lds
    v_mfma_f32_16x16x32_bf16 v[124:127], v[200:203], v[52:55], v[124:127]
    ds_read_b64_tr_b16 v[40:41], v184 offset:32768
    ds_read_b64_tr_b16 v[42:43], v184 offset:33280
    v_mfma_f32_16x16x32_bf16 v[128:131], v[204:207], v[52:55], v[128:131]
    s_add_u32 m0, s73, 90112
    s_xor_b32 s75, s62, 896
    s_mul_i32 s75, s75, 1536
    buffer_load_dwordx4 v98, s[8:11], s75 offen offset:0 lds
    v_mov_b32 v80, 0x3f803f80
    v_mov_b32 v81, 0x3f803f80
    v_mov_b32 v82, 0x3f803f80
    v_mov_b32 v83, 0x3f803f80
    s_waitcnt lgkmcnt(7)
    v_mfma_f32_16x16x32_bf16 v[100:103], v[208:211], v[60:63], v[100:103]
    ds_read_b128 v[216:219], v181 offset:16384
    ds_read_b64_tr_b16 v[48:49], v182 offset:28672
    s_waitcnt lgkmcnt(6)
    v_mfma_f32_16x16x32_bf16 v[104:107], v[212:215], v[60:63], v[104:107]
    ds_read_b64_tr_b16 v[50:51], v182 offset:29184
    s_add_u32 m0, s71, 65536
    s_add_u32 s77, s87, 0
    buffer_load_dwordx4 v4, s[28:31], s77 offen lds
    v_mfma_f32_16x16x32_bf16 v[116:119], v[208:211], v[64:67], v[116:119]
    ds_read_b64_tr_b16 v[52:53], v182 offset:36864
    ds_read_b64_tr_b16 v[54:55], v182 offset:37376
    v_mfma_f32_16x16x32_bf16 v[120:123], v[212:215], v[64:67], v[120:123]
    s_waitcnt lgkmcnt(7)
    v_mfma_f32_16x16x32_bf16 v[108:111], v[208:211], v[36:39], v[108:111]
    ds_read_b128 v[220:223], v181 offset:18432
    ds_read_b64_tr_b16 v[60:61], v184 offset:28672
    v_mfma_f32_16x16x32_bf16 v[112:115], v[212:215], v[36:39], v[112:115]
    ds_read_b64_tr_b16 v[62:63], v184 offset:29184
    s_add_u32 m0, s71, 73728
    s_add_u32 s77, s87, 16384
    buffer_load_dwordx4 v4, s[28:31], s77 offen lds
    s_waitcnt lgkmcnt(8)
    v_mfma_f32_16x16x32_bf16 v[124:127], v[208:211], v[40:43], v[124:127]
    ds_read_b64_tr_b16 v[64:65], v184 offset:36864
    ds_read_b64_tr_b16 v[66:67], v184 offset:37376
    v_mfma_f32_16x16x32_bf16 v[128:131], v[212:215], v[40:43], v[128:131]
    s_waitcnt vmcnt(10) lgkmcnt(0)
    s_barrier
    v_mfma_f32_16x16x32_bf16 v[100:103], v[216:219], v[48:51], v[100:103]
    ds_read_b128 v[224:227], v180 offset:32768
    ds_read_b64_tr_b16 v[36:37], v183 offset:0
    v_mfma_f32_16x16x32_bf16 v[104:107], v[220:223], v[48:51], v[104:107]
    ds_read_b64_tr_b16 v[38:39], v183 offset:512
    s_add_u32 m0, s71, 0
    s_add_u32 s77, s87, 8192
    buffer_load_dwordx4 v4, s[28:31], s77 offen lds
    v_mfma_f32_16x16x32_bf16 v[116:119], v[216:219], v[52:55], v[116:119]
    ds_read_b64_tr_b16 v[40:41], v183 offset:8192
    ds_read_b64_tr_b16 v[42:43], v183 offset:8704
    v_mfma_f32_16x16x32_bf16 v[120:123], v[220:223], v[52:55], v[120:123]
    s_buffer_load_dword s94, s[24:27], 0
    v_mfma_f32_16x16x32_bf16 v[108:111], v[216:219], v[60:63], v[108:111]
    ds_read_b128 v[228:231], v180 offset:34816
    ds_read_b64_tr_b16 v[48:49], v185 offset:0
    v_mfma_f32_16x16x32_bf16 v[112:115], v[220:223], v[60:63], v[112:115]
    ds_read_b64_tr_b16 v[50:51], v185 offset:512
    s_add_u32 m0, s71, 8192
    s_add_u32 s77, s87, 24576
    buffer_load_dwordx4 v4, s[28:31], s77 offen lds
    v_mfma_f32_16x16x32_bf16 v[124:127], v[216:219], v[64:67], v[124:127]
    ds_read_b64_tr_b16 v[52:53], v185 offset:8192
    ds_read_b64_tr_b16 v[54:55], v185 offset:8704
    v_mfma_f32_16x16x32_bf16 v[128:131], v[220:223], v[64:67], v[128:131]
    s_add_u32 m0, s71, 90112
    s_add_u32 s77, s87, 65536
    buffer_load_dwordx4 v4, s[28:31], s77 offen lds
    s_waitcnt lgkmcnt(7)
    v_mfma_f32_16x16x32_bf16 v[100:103], v[224:227], v[36:39], v[100:103]
    ds_read_b128 v[232:235], v181 offset:32768
    ds_read_b64_tr_b16 v[60:61], v183 offset:4096
    s_waitcnt lgkmcnt(6)
    v_mfma_f32_16x16x32_bf16 v[104:107], v[228:231], v[36:39], v[104:107]
    ds_read_b64_tr_b16 v[62:63], v183 offset:4608
    s_add_u32 m0, s71, 98304
    s_add_u32 s77, s87, 81920
    buffer_load_dwordx4 v4, s[28:31], s77 offen lds
LIAb_4:
    s_cmp_eq_u32 s63, 1
    s_cbranch_scc1 LIAb_ret
    v_mfma_f32_16x16x32_bf16 v[116:119], v[224:227], v[40:43], v[116:119]
    ds_read_b64_tr_b16 v[64:65], v183 offset:12288
    ds_read_b64_tr_b16 v[66:67], v183 offset:12800
    v_mfma_f32_16x16x32_bf16 v[120:123], v[228:231], v[40:43], v[120:123]
    s_waitcnt lgkmcnt(7)
    v_mfma_f32_16x16x32_bf16 v[108:111], v[224:227], v[48:51], v[108:111]
    ds_read_b128 v[236:239], v181 offset:34816
    ds_read_b64_tr_b16 v[36:37], v185 offset:4096
    v_mfma_f32_16x16x32_bf16 v[112:115], v[228:231], v[48:51], v[112:115]
    ds_read_b64_tr_b16 v[38:39], v185 offset:4608
    s_add_u32 m0, s71, 16384
    s_add_u32 s77, s87, 73728
    buffer_load_dwordx4 v4, s[28:31], s77 offen lds
    s_waitcnt lgkmcnt(8)
    v_mfma_f32_16x16x32_bf16 v[124:127], v[224:227], v[52:55], v[124:127]
    ds_read_b64_tr_b16 v[40:41], v185 offset:12288
    ds_read_b64_tr_b16 v[42:43], v185 offset:12800
    v_mfma_f32_16x16x32_bf16 v[128:131], v[228:231], v[52:55], v[128:131]
    s_waitcnt lgkmcnt(0)
    s_cmp_lg_u32 s94, 0
    s_cbranch_scc0 Lretry_61i
Lok_60:
    s_mov_b32 s95, s94
    v_mov_b32 v17, s94
    s_waitcnt vmcnt(11)
    s_barrier
    v_mfma_f32_16x16x32_bf16 v[100:103], v[232:235], v[60:63], v[100:103]
    ds_read_b128 v[240:243], v180 offset:49152
    ds_read_b64_tr_b16 v[48:49], v183 offset:24576
    v_mfma_f32_16x16x32_bf16 v[104:107], v[236:239], v[60:63], v[104:107]
    ds_read_b64_tr_b16 v[50:51], v183 offset:25088
    s_add_u32 m0, s71, 24576
    s_add_u32 s77, s87, 90112
    buffer_load_dwordx4 v4, s[28:31], s77 offen lds
    v_mfma_f32_16x16x32_bf16 v[116:119], v[232:235], v[64:67], v[116:119]
    ds_read_b64_tr_b16 v[52:53], v183 offset:32768
    ds_read_b64_tr_b16 v[54:55], v183 offset:33280
    v_mfma_f32_16x16x32_bf16 v[120:123], v[236:239], v[64:67], v[120:123]
    v_mfma_f32_16x16x32_bf16 v[108:111], v[232:235], v[36:39], v[108:111]
    ds_read_b128 v[244:247], v180 offset:51200
    ds_read_b64_tr_b16 v[60:61], v185 offset:24576
    v_mfma_f32_16x16x32_bf16 v[112:115], v[236:239], v[36:39], v[112:115]
    ds_read_b64_tr_b16 v[62:63], v185 offset:25088
    s_add_u32 m0, s71, 32768
    s_add_u32 s77, s87, 131072
    buffer_load_dwordx4 v4, s[28:31], s77 offen lds
    s_waitcnt vmcnt(7)
    ds_read_b64_tr_b16 v[148:149], v7 offset:0
    ds_read_b64_tr_b16 v[150:151], v7 offset:8192
    ds_read_b64_tr_b16 v[152:153], v8 offset:0
    ds_read_b64_tr_b16 v[154:155], v8 offset:8192
    v_mfma_f32_16x16x32_bf16 v[124:127], v[232:235], v[40:43], v[124:127]
    ds_read_b64_tr_b16 v[64:65], v185 offset:32768
    ds_read_b64_tr_b16 v[66:67], v185 offset:33280
    v_mfma_f32_16x16x32_bf16 v[128:131], v[236:239], v[40:43], v[128:131]
    s_add_u32 m0, s71, 40960
    s_add_u32 s77, s87, 147456
    buffer_load_dwordx4 v4, s[28:31], s77 offen lds
    s_waitcnt lgkmcnt(11)
    v_mfma_f32_16x16x32_bf16 v[100:103], v[240:243], v[48:51], v[100:103]
    ds_read_b128 v[248:251], v181 offset:49152
    ds_read_b64_tr_b16 v[36:37], v183 offset:28672
    s_waitcnt lgkmcnt(10)
    v_mfma_f32_16x16x32_bf16 v[104:107], v[244:247], v[48:51], v[104:107]
    ds_read_b64_tr_b16 v[38:39], v183 offset:29184
    v_mfma_f32_16x16x32_bf16 v[116:119], v[240:243], v[52:55], v[116:119]
    ds_read_b64_tr_b16 v[40:41], v183 offset:36864
    ds_read_b64_tr_b16 v[42:43], v183 offset:37376
    v_mfma_f32_16x16x32_bf16 v[120:123], v[244:247], v[52:55], v[120:123]
    s_waitcnt lgkmcnt(11)
    v_mfma_f32_16x16x32_bf16 v[108:111], v[240:243], v[60:63], v[108:111]
    ds_read_b128 v[252:255], v181 offset:51200
    ds_read_b64_tr_b16 v[48:49], v185 offset:28672
    v_mfma_f32_16x16x32_bf16 v[112:115], v[244:247], v[60:63], v[112:115]
    ds_read_b64_tr_b16 v[50:51], v185 offset:29184
    s_waitcnt vmcnt(6)
    ds_read_b64_tr_b16 v[156:157], v5 offset:0
    s_waitcnt lgkmcnt(14)
    ds_read_b64_tr_b16 v[158:159], v5 offset:8192
    s_waitcnt lgkmcnt(14)
    ds_read_b64_tr_b16 v[160:161], v6 offset:0
    s_waitcnt lgkmcnt(14)
    ds_read_b64_tr_b16 v[162:163], v6 offset:8192
    s_waitcnt lgkmcnt(12)
    v_mfma_f32_16x16x32_bf16 v[124:127], v[240:243], v[64:67], v[124:127]
    ds_read_b64_tr_b16 v[52:53], v185 offset:36864
    ds_read_b64_tr_b16 v[54:55], v185 offset:37376
    v_mfma_f32_16x16x32_bf16 v[128:131], v[244:247], v[64:67], v[128:131]
    s_add_u32 m0, s71, 65536
    s_add_u32 s77, s87, 139264
    buffer_load_dwordx4 v4, s[28:31], s77 offen lds
    s_add_u32 m0, s71, 73728
    s_add_u32 s77, s87, 155648
    buffer_load_dwordx4 v4, s[28:31], s77 offen lds
    s_waitcnt lgkmcnt(11)
    v_mfma_f32_16x16x32_bf16 v[100:103], v[248:251], v[36:39], v[100:103]
    s_waitcnt lgkmcnt(8)
    v_mfma_f32_16x16x32_bf16 v[104:107], v[252:255], v[36:39], v[104:107]
    v_mfma_f32_16x16x32_bf16 v[116:119], v[248:251], v[40:43], v[116:119]
    v_mfma_f32_16x16x32_bf16 v[120:123], v[252:255], v[40:43], v[120:123]
    s_lshl_b32 s76, s68, 2
    s_buffer_load_dword s1, s[24:27], s76 offset:128
    s_waitcnt lgkmcnt(6)
    v_mfma_f32_16x16x32_bf16 v[108:111], v[248:251], v[48:51], v[108:111]
    v_mfma_f32_16x16x32_bf16 v[112:115], v[252:255], v[48:51], v[112:115]
    s_waitcnt lgkmcnt(0)
    v_mfma_f32_16x16x32_bf16 v[124:127], v[248:251], v[52:55], v[124:127]
    v_mfma_f32_16x16x32_bf16 v[128:131], v[252:255], v[52:55], v[128:131]
    s_add_u32 m0, s71, 0
    s_add_u32 s77, s87, 32768
    buffer_load_dwordx4 v4, s[28:31], s77 offen lds
    s_add_u32 m0, s71, 8192
    s_add_u32 s77, s87, 49152
    buffer_load_dwordx4 v4, s[28:31], s77 offen lds
LDAb:
    s_barrier
    v_pk_mul_f32 v[84:85], v[100:101], s[82:83]
    v_pk_mul_f32 v[86:87], v[102:103], s[82:83]
    v_pk_mul_f32 v[88:89], v[104:105], s[82:83]
    v_pk_mul_f32 v[90:91], v[106:107], s[82:83]
    v_cvt_pk_bf16_f32 v72, v116, v117
    v_cvt_pk_bf16_f32 v73, v118, v119
    v_cvt_pk_bf16_f32 v74, v120, v121
    v_cvt_pk_bf16_f32 v75, v122, v123
    v_cvt_pk_bf16_f32 v76, v124, v125
    v_cvt_pk_bf16_f32 v77, v126, v127
    v_cvt_pk_bf16_f32 v78, v128, v129
    v_cvt_pk_bf16_f32 v79, v130, v131
    s_add_u32 m0, s71, 49152
    s_add_u32 s77, s87, 40960
    buffer_load_dwordx4 v4, s[28:31], s77 offen lds
    v_exp_f32 v84, v84 clamp
    v_exp_f32 v85, v85 clamp
    v_exp_f32 v86, v86 clamp
    v_exp_f32 v87, v87 clamp
    v_exp_f32 v88, v88 clamp
    v_exp_f32 v89, v89 clamp
    v_exp_f32 v90, v90 clamp
    v_exp_f32 v91, v91 clamp
    v_max_f32 v100, 0x358637bd, v100
    v_max_f32 v101, 0x358637bd, v101
    v_max_f32 v102, 0x358637bd, v102
LIAb_5:
    s_cmp_eq_u32 s63, 1
    s_cbranch_scc1 LIAb_ret
    s_add_u32 m0, s71, 57344
    s_add_u32 s77, s87, 57344
    buffer_load_dwordx4 v4, s[28:31], s77 offen lds
    v_max_f32 v103, 0x358637bd, v103
    v_max_f32 v104, 0x358637bd, v104
    v_max_f32 v105, 0x358637bd, v105
    v_max_f32 v106, 0x358637bd, v106
    v_max_f32 v107, 0x358637bd, v107
    v_pk_add_f32 v[84:85], v[84:85], v[100:101]
    v_pk_add_f32 v[86:87], v[86:87], v[102:103]
    v_pk_add_f32 v[88:89], v[88:89], v[104:105]
    v_pk_add_f32 v[90:91], v[90:91], v[106:107]
    v_cvt_pk_bf16_f32 v92, v84, v85
    v_cvt_pk_bf16_f32 v93, v86, v87
    v_cvt_pk_bf16_f32 v94, v88, v89
    v_cvt_pk_bf16_f32 v95, v90, v91
    v_pk_mul_f32 v[84:85], v[108:109], s[82:83]
    v_pk_mul_f32 v[86:87], v[110:111], s[82:83]
    v_pk_mul_f32 v[88:89], v[112:113], s[82:83]
    v_pk_mul_f32 v[90:91], v[114:115], s[82:83]
    v_exp_f32 v84, v84 clamp
    v_exp_f32 v85, v85 clamp
    v_exp_f32 v86, v86 clamp
    v_exp_f32 v87, v87 clamp
    v_exp_f32 v88, v88 clamp
    v_exp_f32 v89, v89 clamp
    v_exp_f32 v90, v90 clamp
    v_exp_f32 v91, v91 clamp
    v_max_f32 v108, 0x358637bd, v108
    v_max_f32 v109, 0x358637bd, v109
    v_max_f32 v110, 0x358637bd, v110
    v_max_f32 v111, 0x358637bd, v111
    v_max_f32 v112, 0x358637bd, v112
    v_max_f32 v113, 0x358637bd, v113
    v_max_f32 v114, 0x358637bd, v114
    v_max_f32 v115, 0x358637bd, v115
    v_pk_add_f32 v[84:85], v[84:85], v[108:109]
    v_pk_add_f32 v[86:87], v[86:87], v[110:111]
    v_pk_add_f32 v[88:89], v[88:89], v[112:113]
    v_pk_add_f32 v[90:91], v[90:91], v[114:115]
    v_cvt_pk_bf16_f32 v96, v84, v85
    v_cvt_pk_bf16_f32 v97, v86, v87
    v_cvt_pk_bf16_f32 v98, v88, v89
    v_cvt_pk_bf16_f32 v99, v90, v91
    v_mfma_f32_16x16x32_bf16 v[40:43], v[92:95], v[80:83], 0
    s_nop 0
    v_mfma_f32_16x16x32_bf16 v[48:51], v[96:99], v[80:83], 0
    v_mfma_f32_16x16x32_bf16 v[36:39], v[92:95], v[72:75], 0
    v_mfma_f32_16x16x32_bf16 v[44:47], v[96:99], v[76:79], 0
    s_nop 6
    ds_write_b128 v34, v[36:39] offset:0
    ds_write_b128 v34, v[40:43] offset:512
    ds_write_b128 v34, v[44:47] offset:2048
    ds_write_b128 v34, v[48:51] offset:2560
    s_waitcnt lgkmcnt(0)
    s_barrier
    ds_read2st64_b32 v[36:37], v188 offset0:0 offset1:1
    ds_read2st64_b32 v[38:39], v188 offset0:32 offset1:33
    ds_read2st64_b32 v[40:41], v188 offset0:96 offset1:97
    ds_read2st64_b32 v[42:43], v188 offset0:128 offset1:129
    ds_read2st64_b32 v[44:45], v189 offset0:0 offset1:32
    ds_read2st64_b32 v[46:47], v189 offset0:96 offset1:128
    s_waitcnt lgkmcnt(4)
    v_pk_add_f32 v[36:37], v[36:37], v[38:39]
    s_waitcnt lgkmcnt(2)
    v_pk_add_f32 v[40:41], v[40:41], v[42:43]
    s_waitcnt lgkmcnt(0)
    v_pk_add_f32 v[44:45], v[44:45], v[46:47]
    v_pk_add_f32 v[36:37], v[36:37], v[40:41]
    v_add_f32 v44, v44, v45
    s_waitcnt lgkmcnt(0)
    s_cmp_eq_u32 s1, 1
    s_cbranch_scc0 Lretry_63i
Lok_62:
    buffer_atomic_add_f32 v36, v190, s[36:39], s78 offen offset:0
    buffer_atomic_add_f32 v37, v190, s[36:39], s78 offen offset:256
    buffer_atomic_add_f32 v44, v191, s[36:39], s78 offen offset:512
    ds_read_b64_tr_b16 v[68:69], v182 offset:16384
    ds_read_b64_tr_b16 v[70:71], v182 offset:16896
    ds_read_b64_tr_b16 v[72:73], v184 offset:16384
    ds_read_b64_tr_b16 v[74:75], v184 offset:16896
    ds_read_b64_tr_b16 v[76:77], v182 offset:20480
    ds_read_b64_tr_b16 v[78:79], v182 offset:20992
    s_waitcnt lgkmcnt(4)
    v_mfma_f32_16x16x32_bf16 v[132:135], v[68:71], v[192:195], v[132:135]
    v_mfma_f32_16x16x32_bf16 v[140:143], v[68:71], v[196:199], v[140:143]
    s_add_u32 m0, s71, 114688
    s_add_u32 s77, s87, 98304
    buffer_load_dwordx4 v4, s[28:31], s77 offen lds
    s_waitcnt vmcnt(14)
    ds_read_b64_tr_b16 v[164:165], v7 offset:24576
    ds_read_b64_tr_b16 v[166:167], v7 offset:32768
    ds_read_b64_tr_b16 v[168:169], v8 offset:24576
    ds_read_b64_tr_b16 v[170:171], v8 offset:32768
    ds_read_b64_tr_b16 v[80:81], v184 offset:20480
    ds_read_b64_tr_b16 v[82:83], v184 offset:20992
    s_waitcnt lgkmcnt(8)
    v_mfma_f32_16x16x32_bf16 v[136:139], v[72:75], v[192:195], v[136:139]
    v_mfma_f32_16x16x32_bf16 v[144:147], v[72:75], v[196:199], v[144:147]
    s_add_u32 m0, s71, 122880
    s_add_u32 s77, s87, 114688
    buffer_load_dwordx4 v4, s[28:31], s77 offen lds
    s_waitcnt vmcnt(13)
    ds_read_b64_tr_b16 v[172:173], v5 offset:16384
    ds_read_b64_tr_b16 v[174:175], v5 offset:24576
    ds_read_b64_tr_b16 v[176:177], v6 offset:16384
    ds_read_b64_tr_b16 v[178:179], v6 offset:24576
    ds_read_b64_tr_b16 v[68:69], v182 offset:40960
    s_waitcnt lgkmcnt(12)
    ds_read_b64_tr_b16 v[70:71], v182 offset:41472
    s_waitcnt lgkmcnt(12)
    v_mfma_f32_16x16x32_bf16 v[132:135], v[76:79], v[200:203], v[132:135]
    v_mfma_f32_16x16x32_bf16 v[140:143], v[76:79], v[204:207], v[140:143]
    s_add_u32 m0, s71, 139264
    s_add_u32 s77, s87, 106496
    buffer_load_dwordx4 v4, s[28:31], s77 offen lds
    ds_read_b64_tr_b16 v[72:73], v184 offset:40960
    s_waitcnt lgkmcnt(12)
    ds_read_b64_tr_b16 v[74:75], v184 offset:41472
    s_waitcnt lgkmcnt(8)
    v_mfma_f32_16x16x32_bf16 v[136:139], v[80:83], v[200:203], v[136:139]
    v_mfma_f32_16x16x32_bf16 v[144:147], v[80:83], v[204:207], v[144:147]
    s_add_u32 m0, s71, 147456
    s_add_u32 s77, s87, 122880
    buffer_load_dwordx4 v4, s[28:31], s77 offen lds
    ds_read_b64_tr_b16 v[76:77], v182 offset:45056
    ds_read_b64_tr_b16 v[78:79], v182 offset:45568
    s_waitcnt lgkmcnt(4)
    v_mfma_f32_16x16x32_bf16 v[132:135], v[68:71], v[208:211], v[132:135]
    v_mfma_f32_16x16x32_bf16 v[140:143], v[68:71], v[212:215], v[140:143]
    s_add_u32 m0, s71, 90112
    s_add_u32 s77, s88, 0
    buffer_load_dwordx4 v4, s[40:43], s77 offen lds
    ds_read_b64_tr_b16 v[80:81], v184 offset:45056
    ds_read_b64_tr_b16 v[82:83], v184 offset:45568
    s_waitcnt lgkmcnt(4)
    v_mfma_f32_16x16x32_bf16 v[136:139], v[72:75], v[208:211], v[136:139]
    v_mfma_f32_16x16x32_bf16 v[144:147], v[72:75], v[212:215], v[144:147]
    s_add_u32 m0, s71, 98304
LIAb_6:
    s_cmp_eq_u32 s63, 1
    s_cbranch_scc1 LIAb_ret
    s_add_u32 s77, s88, 16384
    buffer_load_dwordx4 v4, s[40:43], s77 offen lds
    s_buffer_load_dwordx16 s[4:19], s[36:39], s96 offset:16384 glc
    s_mov_b32 s63, 2
    s_cmp_eq_u32 s64, 4
    s_cbranch_scc1 LJAb_0
    s_cmp_eq_u32 s64, 5
    s_cbranch_scc1 LJAb_1
    s_cmp_eq_u32 s64, 6
    s_cbranch_scc1 LJAb_2
    s_cmp_eq_u32 s64, 7
    s_cbranch_scc1 LJAb_3
LJAb_3:
LJAb_4:
LJAb_5:
LJAb_6:
LJAb_ret:
    s_mov_b32 s63, 0
    s_waitcnt vmcnt(6)
    s_barrier
    ds_read_b64_tr_b16 v[68:69], v183 offset:16384
    ds_read_b64_tr_b16 v[70:71], v183 offset:16896
    s_waitcnt lgkmcnt(4)
    v_mfma_f32_16x16x32_bf16 v[132:135], v[76:79], v[216:219], v[132:135]
    v_mfma_f32_16x16x32_bf16 v[140:143], v[76:79], v[220:223], v[140:143]
    s_add_u32 m0, s71, 16384
    s_add_u32 s77, s88, 8192
    buffer_load_dwordx4 v4, s[40:43], s77 offen lds
    ds_read_b64_tr_b16 v[72:73], v185 offset:16384
    ds_read_b64_tr_b16 v[74:75], v185 offset:16896
    s_waitcnt lgkmcnt(4)
    v_mfma_f32_16x16x32_bf16 v[136:139], v[80:83], v[216:219], v[136:139]
    v_mfma_f32_16x16x32_bf16 v[144:147], v[80:83], v[220:223], v[144:147]
    s_add_u32 m0, s71, 24576
    s_add_u32 s77, s88, 24576
    buffer_load_dwordx4 v4, s[40:43], s77 offen lds
    ds_read_b64_tr_b16 v[76:77], v183 offset:20480
    ds_read_b64_tr_b16 v[78:79], v183 offset:20992
    s_waitcnt lgkmcnt(4)
    v_mfma_f32_16x16x32_bf16 v[132:135], v[68:71], v[224:227], v[132:135]
    v_mfma_f32_16x16x32_bf16 v[140:143], v[68:71], v[228:231], v[140:143]
    ds_read_b64_tr_b16 v[80:81], v185 offset:20480
    ds_read_b64_tr_b16 v[82:83], v185 offset:20992
    s_waitcnt lgkmcnt(4)
    v_mfma_f32_16x16x32_bf16 v[136:139], v[72:75], v[224:227], v[136:139]
    v_mfma_f32_16x16x32_bf16 v[144:147], v[72:75], v[228:231], v[144:147]
    ds_read_b64_tr_b16 v[68:69], v183 offset:40960
    ds_read_b64_tr_b16 v[70:71], v183 offset:41472
    s_waitcnt lgkmcnt(4)
    v_mfma_f32_16x16x32_bf16 v[132:135], v[76:79], v[232:235], v[132:135]
    v_mfma_f32_16x16x32_bf16 v[140:143], v[76:79], v[236:239], v[140:143]
    ds_read_b64_tr_b16 v[72:73], v185 offset:40960
    ds_read_b64_tr_b16 v[74:75], v185 offset:41472
    s_waitcnt lgkmcnt(4)
    v_mfma_f32_16x16x32_bf16 v[136:139], v[80:83], v[232:235], v[136:139]
    v_mfma_f32_16x16x32_bf16 v[144:147], v[80:83], v[236:239], v[144:147]
    ds_read_b64_tr_b16 v[76:77], v183 offset:45056
    ds_read_b64_tr_b16 v[78:79], v183 offset:45568
    s_waitcnt lgkmcnt(4)
    v_mfma_f32_16x16x32_bf16 v[132:135], v[68:71], v[240:243], v[132:135]
    v_mfma_f32_16x16x32_bf16 v[140:143], v[68:71], v[244:247], v[140:143]
    ds_read_b64_tr_b16 v[80:81], v185 offset:45056
    ds_read_b64_tr_b16 v[82:83], v185 offset:45568
    s_waitcnt lgkmcnt(4)
    v_mfma_f32_16x16x32_bf16 v[136:139], v[72:75], v[240:243], v[136:139]
    v_mfma_f32_16x16x32_bf16 v[144:147], v[72:75], v[244:247], v[144:147]
    s_waitcnt lgkmcnt(2)
    v_mfma_f32_16x16x32_bf16 v[132:135], v[76:79], v[248:251], v[132:135]
    v_mfma_f32_16x16x32_bf16 v[140:143], v[76:79], v[252:255], v[140:143]
    s_waitcnt lgkmcnt(0)
    v_mfma_f32_16x16x32_bf16 v[136:139], v[80:83], v[248:251], v[136:139]
    v_mfma_f32_16x16x32_bf16 v[144:147], v[80:83], v[252:255], v[144:147]
    s_barrier
    s_waitcnt lgkmcnt(0)
    s_nop 1
    v_pk_mul_f32 v[84:85], v[132:133], s[82:83]
    v_pk_mul_f32 v[86:87], v[134:135], s[82:83]
    s_nop 0
    v_pk_mul_f32 v[88:89], v[136:137], s[82:83]
    v_pk_mul_f32 v[90:91], v[138:139], s[82:83]
    v_exp_f32 v84, v84 clamp
    v_exp_f32 v85, v85 clamp
    v_exp_f32 v86, v86 clamp
    s_add_u32 m0, s71, 81920
    s_add_u32 s77, s88, 32768
    buffer_load_dwordx4 v4, s[40:43], s77 offen lds
    v_exp_f32 v87, v87 clamp
    v_exp_f32 v88, v88 clamp
    v_exp_f32 v89, v89 clamp
    v_exp_f32 v90, v90 clamp
    v_exp_f32 v91, v91 clamp
    v_max_f32 v132, 0x358637bd, v132
    v_max_f32 v133, 0x358637bd, v133
    v_max_f32 v134, 0x358637bd, v134
    s_add_u32 m0, s71, 106496
    s_add_u32 s77, s88, 49152
    buffer_load_dwordx4 v4, s[40:43], s77 offen lds
    s_buffer_load_dwordx16 s[4:19], s[36:39], s96 offset:16384 glc
    s_buffer_load_dwordx4 s[44:47], s[36:39], s85 offset:16 glc
    v_max_f32 v135, 0x358637bd, v135
    v_max_f32 v136, 0x358637bd, v136
    v_max_f32 v137, 0x358637bd, v137
    v_max_f32 v138, 0x358637bd, v138
    v_max_f32 v139, 0x358637bd, v139
    v_pk_add_f32 v[84:85], v[84:85], v[132:133]
    v_pk_add_f32 v[86:87], v[86:87], v[134:135]
    v_pk_add_f32 v[88:89], v[88:89], v[136:137]
    s_add_u32 m0, s71, 131072
    s_add_u32 s77, s88, 40960
    buffer_load_dwordx4 v4, s[40:43], s77 offen lds
    v_pk_add_f32 v[90:91], v[90:91], v[138:139]
    v_cvt_pk_bf16_f32 v108, v84, v85
    v_cvt_pk_bf16_f32 v109, v86, v87
    v_cvt_pk_bf16_f32 v110, v88, v89
    v_cvt_pk_bf16_f32 v111, v90, v91
    v_pk_mul_f32 v[84:85], v[140:141], s[82:83]
    v_pk_mul_f32 v[86:87], v[142:143], s[82:83]
    v_pk_mul_f32 v[88:89], v[144:145], s[82:83]
    s_add_u32 m0, s71, 155648
    s_add_u32 s77, s88, 57344
    buffer_load_dwordx4 v4, s[40:43], s77 offen lds
    v_pk_mul_f32 v[90:91], v[146:147], s[82:83]
    v_exp_f32 v84, v84 clamp
    v_exp_f32 v85, v85 clamp
    v_exp_f32 v86, v86 clamp
    v_exp_f32 v87, v87 clamp
    v_exp_f32 v88, v88 clamp
    v_exp_f32 v89, v89 clamp
    v_exp_f32 v90, v90 clamp
    v_exp_f32 v91, v91 clamp
    v_max_f32 v140, 0x358637bd, v140
    v_max_f32 v141, 0x358637bd, v141
    v_max_f32 v142, 0x358637bd, v142
    v_max_f32 v143, 0x358637bd, v143
    v_max_f32 v144, 0x358637bd, v144
    v_max_f32 v145, 0x358637bd, v145
    v_max_f32 v146, 0x358637bd, v146
    v_max_f32 v147, 0x358637bd, v147
    v_pk_add_f32 v[84:85], v[84:85], v[140:141]
    v_pk_add_f32 v[86:87], v[86:87], v[142:143]
    v_pk_add_f32 v[88:89], v[88:89], v[144:145]
    v_pk_add_f32 v[90:91], v[90:91], v[146:147]
    v_cvt_pk_bf16_f32 v112, v84, v85
    v_cvt_pk_bf16_f32 v113, v86, v87
    v_cvt_pk_bf16_f32 v114, v88, v89
LIAb_7:
    s_cmp_eq_u32 s63, 1
    s_cbranch_scc1 LIAb_ret
LJAb_0:
    s_cmp_eq_u32 s63, 2
    s_cbranch_scc1 LJAb_4
    v_cvt_pk_bf16_f32 v115, v90, v91
    s_cmp_eq_u64 s[4:5], s[94:95]
    s_cbranch_scc0 Lretry_65i
Lok_64:
    buffer_load_dwordx4 v[116:119], v11, s[36:39], s89 offen offset:0 sc1
    buffer_load_dwordx4 v[120:123], v12, s[36:39], s89 offen offset:0 sc1
    buffer_load_dwordx4 v[124:127], v11, s[36:39], s89 offen offset:1024 sc1
    buffer_load_dwordx4 v[128:131], v12, s[36:39], s89 offen offset:1024 sc1
    s_waitcnt lgkmcnt(0)
    s_barrier
    s_setprio 3
    s_cmp_eq_u64 s[46:47], s[94:95]
    s_cbranch_scc0 Lretry_67i
Lok_66:
    buffer_load_dwordx4 v[204:207], v15, s[36:39], 0 offen offset:512 sc1
    buffer_load_dwordx4 v[196:199], v32, s[36:39], 0 offen offset:0 sc1
    buffer_load_dwordx4 v[200:203], v32, s[36:39], 0 offen offset:1152 sc1
    s_buffer_load_dwordx16 s[4:19], s[36:39], s96 offset:16384 glc
    buffer_load_dword v30, v35, s[36:39], 0 offen sc1
    buffer_load_dword v31, v35, s[36:39], 0 offen offset:64 sc1
    s_cmp_eq_u64 s[8:9], s[94:95]
    s_cbranch_scc0 Lretry_69i
Lok_68:
    s_add_u32 s75, s89, 262144
    buffer_load_dwordx4 v[212:215], v11, s[36:39], s75 offen offset:0 sc1
    buffer_load_dwordx4 v[216:219], v12, s[36:39], s75 offen offset:0 sc1
    buffer_load_dwordx4 v[220:223], v11, s[36:39], s75 offen offset:1024 sc1
    buffer_load_dwordx4 v[224:227], v12, s[36:39], s75 offen offset:1024 sc1
    s_waitcnt vmcnt(12)
    v_mfma_f32_32x32x16_bf16 v[36:51], v[148:151], v[116:119], 0
    v_mfma_f32_32x32x16_bf16 v[52:67], v[152:155], v[116:119], 0
    s_waitcnt vmcnt(11)
    v_mfma_f32_32x32x16_bf16 v[68:83], v[148:151], v[120:123], 0
    v_mfma_f32_32x32x16_bf16 v[84:99], v[152:155], v[120:123], 0
    s_waitcnt vmcnt(10)
    v_mfma_f32_32x32x16_bf16 v[36:51], v[156:159], v[124:127], v[36:51]
    v_mfma_f32_32x32x16_bf16 v[52:67], v[160:163], v[124:127], v[52:67]
    s_waitcnt vmcnt(9)
    v_mfma_f32_32x32x16_bf16 v[68:83], v[156:159], v[128:131], v[68:83]
    v_mfma_f32_32x32x16_bf16 v[84:99], v[160:163], v[128:131], v[84:99]
    s_waitcnt vmcnt(8)
    v_cvt_pk_bf16_f32 v204, v204, v205
    v_cvt_pk_bf16_f32 v205, v206, v207
    s_nop 1
    v_mfma_f32_16x16x16_bf16 v[140:143], v[204:205], v[108:109], 0
    v_mfma_f32_16x16x16_bf16 v[144:147], v[204:205], v[110:111], 0
    v_mfma_f32_16x16x16_bf16 v[188:191], v[204:205], v[112:113], 0
    v_mfma_f32_16x16x16_bf16 v[192:195], v[204:205], v[114:115], 0
    s_waitcnt vmcnt(7)
    v_cvt_pk_bf16_f32 v196, v196, v197
    v_cvt_pk_bf16_f32 v197, v198, v199
    s_nop 1
    v_mfma_f32_16x16x16_bf16 v[132:135], v[196:197], v[108:109], 0
    v_mfma_f32_16x16x16_bf16 v[180:183], v[196:197], v[112:113], 0
    s_waitcnt vmcnt(6)
    v_cvt_pk_bf16_f32 v200, v200, v201
    v_cvt_pk_bf16_f32 v201, v202, v203
    s_nop 1
    v_mfma_f32_16x16x16_bf16 v[136:139], v[200:201], v[110:111], 0
    v_mfma_f32_16x16x16_bf16 v[184:187], v[200:201], v[114:115], 0
    v_add_f32 v140, 0x358637bd, v140
    v_add_f32 v145, 0x358637bd, v145
    v_add_f32 v188, 0x358637bd, v188
    v_add_f32 v193, 0x358637bd, v193
    v_rcp_f32 v140, v140
    v_rcp_f32 v145, v145
    v_rcp_f32 v188, v188
    v_rcp_f32 v193, v193
    s_waitcnt vmcnt(5)
    v_mul_f32 v141, v140, v30
    v_mul_f32 v140, v140, v30
    v_mul_f32 v144, v145, v30
    v_mul_f32 v145, v145, v30
    s_waitcnt vmcnt(4)
    v_mul_f32 v189, v188, v31
    v_mul_f32 v188, v188, v31
    v_mul_f32 v192, v193, v31
    v_mul_f32 v193, v193, v31
    v_pk_mul_f32 v[132:133], v[132:133], v[140:141]
    v_pk_mul_f32 v[134:135], v[134:135], v[140:141]
    v_pk_mul_f32 v[136:137], v[136:137], v[144:145]
    v_pk_mul_f32 v[138:139], v[138:139], v[144:145]
    v_cvt_pk_bf16_f32 v100, v132, v133
    v_cvt_pk_bf16_f32 v101, v134, v135
    v_cvt_pk_bf16_f32 v102, v136, v137
    v_cvt_pk_bf16_f32 v103, v138, v139
    s_add_u32 s76, s86, 131072
    buffer_store_dwordx4 v[100:103], v28, s[36:39], s76 offen offset:0 sc1
    v_pk_mul_f32 v[180:181], v[180:181], v[188:189]
    v_pk_mul_f32 v[182:183], v[182:183], v[188:189]
    v_pk_mul_f32 v[184:185], v[184:185], v[192:193]
    v_pk_mul_f32 v[186:187], v[186:187], v[192:193]
    v_cvt_pk_bf16_f32 v104, v180, v181
    v_cvt_pk_bf16_f32 v105, v182, v183
    v_cvt_pk_bf16_f32 v106, v184, v185
    v_cvt_pk_bf16_f32 v107, v186, v187
    s_add_u32 s76, s86, 131072
    buffer_store_dwordx4 v[104:107], v28, s[36:39], s76 offen offset:256 sc1
    s_setprio 1
    s_cmp_eq_u64 s[12:13], s[94:95]
    s_cbranch_scc0 Lretry_71i
Lok_70:
    s_add_u32 s75, s89, 524288
    buffer_load_dwordx4 v[148:151], v11, s[36:39], s75 offen offset:0 sc1
    buffer_load_dwordx4 v[152:155], v12, s[36:39], s75 offen offset:0 sc1
    buffer_load_dwordx4 v[156:159], v11, s[36:39], s75 offen offset:1024 sc1
    buffer_load_dwordx4 v[160:163], v12, s[36:39], s75 offen offset:1024 sc1
    s_buffer_load_dwordx16 s[4:19], s[36:39], s96 offset:16384 glc
    ds_read_b64_tr_b16 v[228:229], v5 offset:32768
    ds_read_b64_tr_b16 v[230:231], v5 offset:40960
    ds_read_b64_tr_b16 v[232:233], v6 offset:32768
    ds_read_b64_tr_b16 v[234:235], v6 offset:40960
    s_waitcnt vmcnt(9)
    v_mfma_f32_32x32x16_bf16 v[36:51], v[164:167], v[212:215], v[36:51]
    v_mfma_f32_32x32x16_bf16 v[52:67], v[168:171], v[212:215], v[52:67]
    s_waitcnt vmcnt(8)
    v_mfma_f32_32x32x16_bf16 v[68:83], v[164:167], v[216:219], v[68:83]
    v_mfma_f32_32x32x16_bf16 v[84:99], v[168:171], v[216:219], v[84:99]
    ds_read_b64_tr_b16 v[236:237], v7 offset:0
    ds_read_b64_tr_b16 v[238:239], v7 offset:8192
    ds_read_b64_tr_b16 v[240:241], v8 offset:0
    ds_read_b64_tr_b16 v[242:243], v8 offset:8192
    s_waitcnt vmcnt(7)
    v_mfma_f32_32x32x16_bf16 v[36:51], v[172:175], v[220:223], v[36:51]
    v_mfma_f32_32x32x16_bf16 v[52:67], v[176:179], v[220:223], v[52:67]
    s_waitcnt vmcnt(6)
    v_mfma_f32_32x32x16_bf16 v[68:83], v[172:175], v[224:227], v[68:83]
    v_mfma_f32_32x32x16_bf16 v[84:99], v[176:179], v[224:227], v[84:99]
    s_waitcnt vmcnt(4)
    buffer_store_dword v17, v13, s[36:39], 0 offen offset:8 sc1
    s_cmp_eq_u64 s[6:7], s[94:95]
    s_cbranch_scc0 Lretry_73i
Lok_72:
    s_add_u32 s75, s89, 131072
    buffer_load_dwordx4 v[116:119], v11, s[36:39], s75 offen offset:0 sc1
    buffer_load_dwordx4 v[120:123], v12, s[36:39], s75 offen offset:0 sc1
    buffer_load_dwordx4 v[124:127], v11, s[36:39], s75 offen offset:1024 sc1
    buffer_load_dwordx4 v[128:131], v12, s[36:39], s75 offen offset:1024 sc1
    s_cmp_eq_u64 s[10:11], s[94:95]
    s_cbranch_scc0 Lretry_75i
Lok_74:
    s_add_u32 s75, s89, 393216
    buffer_load_dwordx4 v[132:135], v11, s[36:39], s75 offen offset:0 sc1
    buffer_load_dwordx4 v[136:139], v12, s[36:39], s75 offen offset:0 sc1
    buffer_load_dwordx4 v[140:143], v11, s[36:39], s75 offen offset:1024 sc1
    buffer_load_dwordx4 v[144:147], v12, s[36:39], s75 offen offset:1024 sc1
    ds_read_b64_tr_b16 v[244:245], v5 offset:0
    ds_read_b64_tr_b16 v[246:247], v5 offset:8192
    ds_read_b64_tr_b16 v[248:249], v6 offset:0
    ds_read_b64_tr_b16 v[250:251], v6 offset:8192
    s_waitcnt vmcnt(12) lgkmcnt(10)
    v_mfma_f32_32x32x16_bf16 v[36:51], v[228:231], v[148:151], v[36:51]
    s_waitcnt lgkmcnt(8)
    v_mfma_f32_32x32x16_bf16 v[52:67], v[232:235], v[148:151], v[52:67]
    s_waitcnt vmcnt(11)
    v_mfma_f32_32x32x16_bf16 v[68:83], v[228:231], v[152:155], v[68:83]
LIAb_8:
    s_cmp_eq_u32 s63, 1
    s_cbranch_scc1 LIAb_ret
LJAb_1:
    s_cmp_eq_u32 s63, 2
    s_cbranch_scc1 LJAb_5
    v_mfma_f32_32x32x16_bf16 v[84:99], v[232:235], v[152:155], v[84:99]
    ds_read_b64_tr_b16 v[228:229], v5 offset:49152
    ds_read_b64_tr_b16 v[230:231], v5 offset:57344
    ds_read_b64_tr_b16 v[232:233], v6 offset:49152
    ds_read_b64_tr_b16 v[234:235], v6 offset:57344
    s_waitcnt vmcnt(10) lgkmcnt(10)
    v_mfma_f32_32x32x16_bf16 v[36:51], v[236:239], v[156:159], v[36:51]
    s_waitcnt lgkmcnt(8)
    v_mfma_f32_32x32x16_bf16 v[52:67], v[240:243], v[156:159], v[52:67]
    s_waitcnt vmcnt(9)
    v_mfma_f32_32x32x16_bf16 v[68:83], v[236:239], v[160:163], v[68:83]
    v_mfma_f32_32x32x16_bf16 v[84:99], v[240:243], v[160:163], v[84:99]
    s_setprio 0
    ds_read_b64_tr_b16 v[236:237], v7 offset:49152
    ds_read_b64_tr_b16 v[238:239], v7 offset:57344
    ds_read_b64_tr_b16 v[240:241], v8 offset:49152
    ds_read_b64_tr_b16 v[242:243], v8 offset:57344
    s_waitcnt vmcnt(7) lgkmcnt(10)
    v_mfma_f32_32x32x16_bf16 v[36:51], v[244:247], v[116:119], v[36:51]
    s_waitcnt lgkmcnt(8)
    v_mfma_f32_32x32x16_bf16 v[52:67], v[248:251], v[116:119], v[52:67]
    s_waitcnt vmcnt(6)
    v_mfma_f32_32x32x16_bf16 v[68:83], v[244:247], v[120:123], v[68:83]
    v_mfma_f32_32x32x16_bf16 v[84:99], v[248:251], v[120:123], v[84:99]
    ds_read_b64_tr_b16 v[244:245], v9 offset:8192
    ds_read_b64_tr_b16 v[246:247], v9 offset:16384
    ds_read_b64_tr_b16 v[248:249], v10 offset:8192
    ds_read_b64_tr_b16 v[250:251], v10 offset:16384
    s_waitcnt vmcnt(5) lgkmcnt(10)
    v_mfma_f32_32x32x16_bf16 v[36:51], v[228:231], v[124:127], v[36:51]
    s_waitcnt lgkmcnt(8)
    v_mfma_f32_32x32x16_bf16 v[52:67], v[232:235], v[124:127], v[52:67]
    s_waitcnt vmcnt(4)
    v_mfma_f32_32x32x16_bf16 v[68:83], v[228:231], v[128:131], v[68:83]
    v_mfma_f32_32x32x16_bf16 v[84:99], v[232:235], v[128:131], v[84:99]
    s_buffer_load_dwordx4 s[20:23], s[36:39], s96 glc
    ds_read_b64_tr_b16 v[228:229], v7 offset:24576
    ds_read_b64_tr_b16 v[230:231], v7 offset:32768
    ds_read_b64_tr_b16 v[232:233], v8 offset:24576
    ds_read_b64_tr_b16 v[234:235], v8 offset:32768
    s_waitcnt vmcnt(3) lgkmcnt(10)
    v_mfma_f32_32x32x16_bf16 v[36:51], v[236:239], v[132:135], v[36:51]
    s_waitcnt lgkmcnt(8)
    v_mfma_f32_32x32x16_bf16 v[52:67], v[240:243], v[132:135], v[52:67]
    s_waitcnt vmcnt(2)
    v_mfma_f32_32x32x16_bf16 v[68:83], v[236:239], v[136:139], v[68:83]
    v_mfma_f32_32x32x16_bf16 v[84:99], v[240:243], v[136:139], v[84:99]
    ds_read_b64_tr_b16 v[236:237], v5 offset:16384
    ds_read_b64_tr_b16 v[238:239], v5 offset:24576
    ds_read_b64_tr_b16 v[240:241], v6 offset:16384
    ds_read_b64_tr_b16 v[242:243], v6 offset:24576
    s_waitcnt vmcnt(1) lgkmcnt(10)
    v_mfma_f32_32x32x16_bf16 v[36:51], v[244:247], v[140:143], v[36:51]
    s_waitcnt lgkmcnt(8)
    v_mfma_f32_32x32x16_bf16 v[52:67], v[248:251], v[140:143], v[52:67]
    s_waitcnt vmcnt(0)
    v_mfma_f32_32x32x16_bf16 v[68:83], v[244:247], v[144:147], v[68:83]
    v_mfma_f32_32x32x16_bf16 v[84:99], v[248:251], v[144:147], v[84:99]
    s_waitcnt lgkmcnt(0)
    s_cmp_eq_u64 s[20:21], s[94:95]
    s_cbranch_scc0 Lretry_77i
Lok_76:
    buffer_load_dwordx4 v[180:183], v11, s[36:39], s90 offen offset:0 sc1
    buffer_load_dwordx4 v[184:187], v12, s[36:39], s90 offen offset:0 sc1
    buffer_load_dwordx4 v[188:191], v11, s[36:39], s90 offen offset:1024 sc1
    buffer_load_dwordx4 v[192:195], v12, s[36:39], s90 offen offset:1024 sc1
    s_cmp_eq_u64 s[22:23], s[94:95]
    s_cbranch_scc0 Lretry_79i
Lok_78:
    s_add_u32 s75, s90, 131072
    buffer_load_dwordx4 v[196:199], v11, s[36:39], s75 offen offset:0 sc1
    buffer_load_dwordx4 v[200:203], v12, s[36:39], s75 offen offset:0 sc1
    buffer_load_dwordx4 v[204:207], v11, s[36:39], s75 offen offset:1024 sc1
    buffer_load_dwordx4 v[208:211], v12, s[36:39], s75 offen offset:1024 sc1
    buffer_load_dword v18, v29, s[36:39], 0 offen sc1
    ds_read_b64_tr_b16 v[244:245], v7 offset:16384
    ds_read_b64_tr_b16 v[246:247], v7 offset:40960
    ds_read_b64_tr_b16 v[248:249], v8 offset:16384
    ds_read_b64_tr_b16 v[250:251], v8 offset:40960
    s_waitcnt vmcnt(8)
    v_mfma_f32_32x32x16_bf16 v[36:51], v[228:231], v[180:183], v[36:51]
    v_mfma_f32_32x32x16_bf16 v[52:67], v[232:235], v[180:183], v[52:67]
    s_waitcnt vmcnt(7)
    v_mfma_f32_32x32x16_bf16 v[68:83], v[228:231], v[184:187], v[68:83]
    v_mfma_f32_32x32x16_bf16 v[84:99], v[232:235], v[184:187], v[84:99]
    ds_read_b64_tr_b16 v[228:229], v9 offset:0
    ds_read_b64_tr_b16 v[230:231], v9 offset:24576
    ds_read_b64_tr_b16 v[232:233], v10 offset:0
    ds_read_b64_tr_b16 v[234:235], v10 offset:24576
    s_waitcnt vmcnt(6)
    v_mfma_f32_32x32x16_bf16 v[36:51], v[236:239], v[188:191], v[36:51]
    v_mfma_f32_32x32x16_bf16 v[52:67], v[240:243], v[188:191], v[52:67]
    s_waitcnt vmcnt(5)
    v_mfma_f32_32x32x16_bf16 v[68:83], v[236:239], v[192:195], v[68:83]
    v_mfma_f32_32x32x16_bf16 v[84:99], v[240:243], v[192:195], v[84:99]
    s_waitcnt vmcnt(4) lgkmcnt(4)
    v_mfma_f32_32x32x16_bf16 v[52:67], v[248:251], v[196:199], v[52:67]
    s_waitcnt vmcnt(2) lgkmcnt(0)
    v_mfma_f32_32x32x16_bf16 v[52:67], v[232:235], v[204:207], v[52:67]
    v_add_u32 v22, s71, v2
    v_add_u32 v23, 0x10000, v22
    s_lshl_b32 s74, s65, 10
    v_add_u32 v20, s74, v2
    v_xor_b32 v5, 0x0, v20
    v_mfma_f32_32x32x16_bf16 v[68:83], v[244:247], v[200:203], v[68:83]
    v_xor_b32 v6, 0x8400, v20
    v_xor_b32 v7, 0x10800, v20
    v_xor_b32 v8, 0x18c00, v20
    s_lshl_b32 s74, s69, 1
    s_lshr_b32 s75, s65, 1
    s_waitcnt vmcnt(1)
    v_mfma_f32_32x32x16_bf16 v[68:83], v[228:231], v[208:211], v[68:83]
    ds_write_b128 v22, v[52:55] offset:16384
    ds_write_b128 v22, v[56:59] offset:24576
    ds_write_b128 v22, v[60:63] offset:32768
    ds_write_b128 v22, v[64:67] offset:40960
    v_mfma_f32_32x32x16_bf16 v[84:99], v[248:251], v[200:203], v[84:99]
    s_add_u32 s74, s74, s75
    s_lshl_b32 s74, s74, 15
    s_lshl_b32 s75, s70, 7
    s_add_u32 s74, s74, s75
    s_and_b32 s75, s65, 1
    s_lshl_b32 s75, s75, 6
    v_mfma_f32_32x32x16_bf16 v[84:99], v[232:235], v[208:211], v[84:99]
    ds_write_b128 v22, v[68:71] offset:49152
    ds_write_b128 v22, v[72:75] offset:57344
    ds_write_b128 v23, v[76:79] offset:0
    ds_write_b128 v23, v[80:83] offset:8192
    v_mfma_f32_32x32x16_bf16 v[36:51], v[244:247], v[196:199], v[36:51]
    s_add_u32 s74, s74, s75
    v_lshrrev_b32 v11, 5, v1
    v_lshlrev_b32 v11, 4, v11
    v_and_b32 v21, 31, v1
    v_lshl_add_u32 v11, v21, 10, v11
    v_lshlrev_b32 v180, 16, v24
    v_mfma_f32_32x32x16_bf16 v[36:51], v[228:231], v[204:207], v[36:51]
    ds_write_b128 v23, v[84:87] offset:16384
    ds_write_b128 v23, v[88:91] offset:24576
    ds_write_b128 v23, v[92:95] offset:32768
    ds_write_b128 v23, v[96:99] offset:40960
    v_and_b32 v181, 0xffff0000, v24
    v_lshlrev_b32 v182, 16, v25
    v_and_b32 v183, 0xffff0000, v25
    v_lshlrev_b32 v184, 16, v26
    v_and_b32 v185, 0xffff0000, v26
    v_lshlrev_b32 v186, 16, v27
    v_and_b32 v187, 0xffff0000, v27
    s_nop 0
    ds_write_b128 v22, v[36:39] offset:0
    s_waitcnt lgkmcnt(12)
    ds_write_b128 v22, v[40:43] offset:8192
    v_pk_add_f32 v[44:45], v[44:45], v[180:181]
    v_pk_add_f32 v[46:47], v[46:47], v[182:183]
LIAb_9:
    s_cmp_eq_u32 s63, 1
    s_cbranch_scc1 LIAb_ret
LJAb_2:
    s_cmp_eq_u32 s63, 2
    s_cbranch_scc1 LJAb_6
    v_pk_add_f32 v[48:49], v[48:49], v[184:185]
    v_pk_add_f32 v[50:51], v[50:51], v[186:187]
    s_waitcnt lgkmcnt(0)
    s_barrier
    ds_read_b128 v[100:103], v5 offset:0
    ds_read_b128 v[108:111], v6 offset:0
    ds_read_b128 v[116:119], v7 offset:0
    ds_read_b128 v[124:127], v8 offset:0
    ds_read_b128 v[132:135], v6 offset:4096
    ds_read_b128 v[140:143], v7 offset:4096
    ds_read_b128 v[148:151], v8 offset:4096
    ds_read_b128 v[104:107], v5 offset:8192
    ds_read_b128 v[112:115], v6 offset:8192
    ds_read_b128 v[120:123], v7 offset:8192
    ds_read_b128 v[128:131], v8 offset:8192
    ds_read_b128 v[136:139], v6 offset:12288
    ds_read_b128 v[144:147], v7 offset:12288
    s_waitcnt lgkmcnt(12)
    ds_read_b128 v[152:155], v8 offset:12288
    s_waitcnt vmcnt(0)
    v_add_f32 v18, 1.0, v18
    v_rcp_f32 v18, v18
    s_nop 0
    v_mov_b32 v19, v18
    v_pk_add_f32 v[44:45], v[44:45], v[100:101]
    v_pk_add_f32 v[46:47], v[46:47], v[102:103]
    s_waitcnt lgkmcnt(12)
    v_pk_add_f32 v[44:45], v[44:45], v[108:109]
    v_pk_add_f32 v[46:47], v[46:47], v[110:111]
    s_waitcnt lgkmcnt(11)
    v_pk_add_f32 v[44:45], v[44:45], v[116:117]
    v_pk_add_f32 v[46:47], v[46:47], v[118:119]
    s_waitcnt lgkmcnt(10)
    v_pk_add_f32 v[44:45], v[44:45], v[124:125]
    v_pk_add_f32 v[46:47], v[46:47], v[126:127]
    s_waitcnt lgkmcnt(9)
    v_pk_add_f32 v[44:45], v[44:45], v[132:133]
    v_pk_add_f32 v[46:47], v[46:47], v[134:135]
    s_waitcnt lgkmcnt(8)
    v_pk_add_f32 v[44:45], v[44:45], v[140:141]
    v_pk_add_f32 v[46:47], v[46:47], v[142:143]
    s_waitcnt lgkmcnt(7)
    v_pk_add_f32 v[44:45], v[44:45], v[148:149]
    v_pk_add_f32 v[46:47], v[46:47], v[150:151]
    v_pk_mul_f32 v[44:45], v[44:45], v[18:19]
    v_pk_mul_f32 v[46:47], v[46:47], v[18:19]
    v_cvt_pk_bf16_f32 v164, v44, v45
    v_cvt_pk_bf16_f32 v165, v46, v47
    s_waitcnt lgkmcnt(6)
    v_pk_add_f32 v[48:49], v[48:49], v[104:105]
    v_pk_add_f32 v[50:51], v[50:51], v[106:107]
    s_waitcnt lgkmcnt(5)
    v_pk_add_f32 v[48:49], v[48:49], v[112:113]
    v_pk_add_f32 v[50:51], v[50:51], v[114:115]
    s_waitcnt lgkmcnt(4)
    v_pk_add_f32 v[48:49], v[48:49], v[120:121]
    v_pk_add_f32 v[50:51], v[50:51], v[122:123]
    s_waitcnt lgkmcnt(3)
    v_pk_add_f32 v[48:49], v[48:49], v[128:129]
    v_pk_add_f32 v[50:51], v[50:51], v[130:131]
    s_waitcnt lgkmcnt(2)
    v_pk_add_f32 v[48:49], v[48:49], v[136:137]
    v_pk_add_f32 v[50:51], v[50:51], v[138:139]
    s_waitcnt lgkmcnt(1)
    v_pk_add_f32 v[48:49], v[48:49], v[144:145]
    v_pk_add_f32 v[50:51], v[50:51], v[146:147]
    s_waitcnt lgkmcnt(0)
    v_pk_add_f32 v[48:49], v[48:49], v[152:153]
    v_pk_add_f32 v[50:51], v[50:51], v[154:155]
    v_pk_mul_f32 v[48:49], v[48:49], v[18:19]
    v_pk_mul_f32 v[50:51], v[50:51], v[18:19]
    v_cvt_pk_bf16_f32 v166, v48, v49
    v_cvt_pk_bf16_f32 v167, v50, v51
    s_nop 0
    v_permlane32_swap_b32 v164, v166
    v_permlane32_swap_b32 v165, v167
    buffer_store_dwordx4 v[164:167], v11, s[32:35], s74 offen offset:32
    s_endpgm
Lretry_61i:
    s_mov_b32 s0, 20000
Lretry_61:
    s_sub_u32 s0, s0, 1
    s_cbranch_scc1 Lok_60
    s_sleep 1
    s_buffer_load_dword s94, s[24:27], 0 glc
Lretry_61w:
    s_waitcnt lgkmcnt(0)
    s_cmp_lg_u32 s94, 0
    s_cbranch_scc0 Lretry_61
    s_branch Lok_60
Lretry_63i:
    s_mov_b32 s0, 20000
Lretry_63:
    s_sub_u32 s0, s0, 1
    s_cbranch_scc1 Lok_62
    s_sleep 1
    s_lshl_b32 s76, s68, 2
    s_buffer_load_dword s1, s[24:27], s76 offset:128 glc
Lretry_63w:
    s_waitcnt lgkmcnt(0)
    s_cmp_eq_u32 s1, 1
    s_cbranch_scc0 Lretry_63
    s_branch Lok_62
Lretry_65i:
    s_mov_b32 s0, 20000
    s_branch Lretry_65w
Lretry_65:
    s_sub_u32 s0, s0, 1
    s_cbranch_scc1 Lok_64
    s_sleep 1
    s_buffer_load_dwordx16 s[4:19], s[36:39], s96 offset:16384 glc
Lretry_65w:
    s_waitcnt lgkmcnt(0)
    s_cmp_eq_u64 s[4:5], s[94:95]
    s_cbranch_scc0 Lretry_65
    s_branch Lok_64
Lretry_67i:
    s_mov_b32 s0, 20000
    s_branch Lretry_67w
Lretry_67:
    s_sub_u32 s0, s0, 1
    s_cbranch_scc1 Lok_66
    s_sleep 1
    s_buffer_load_dwordx4 s[44:47], s[36:39], s85 offset:16 glc
Lretry_67w:
    s_waitcnt lgkmcnt(0)
    s_cmp_eq_u64 s[46:47], s[94:95]
    s_cbranch_scc0 Lretry_67
    s_branch Lok_66
Lretry_69i:
    s_mov_b32 s0, 20000
    s_branch Lretry_69w
Lretry_69:
    s_sub_u32 s0, s0, 1
    s_cbranch_scc1 Lok_68
    s_sleep 1
    s_buffer_load_dwordx16 s[4:19], s[36:39], s96 offset:16384 glc
Lretry_69w:
    s_waitcnt lgkmcnt(0)
    s_cmp_eq_u64 s[8:9], s[94:95]
    s_cbranch_scc0 Lretry_69
    s_branch Lok_68
Lretry_71i:
    s_mov_b32 s0, 20000
    s_branch Lretry_71w
Lretry_71:
    s_sub_u32 s0, s0, 1
    s_cbranch_scc1 Lok_70
    s_sleep 1
    s_buffer_load_dwordx16 s[4:19], s[36:39], s96 offset:16384 glc
Lretry_71w:
    s_waitcnt lgkmcnt(0)
    s_cmp_eq_u64 s[12:13], s[94:95]
    s_cbranch_scc0 Lretry_71
    s_branch Lok_70
Lretry_73i:
    s_mov_b32 s0, 20000
    s_branch Lretry_73w
Lretry_73:
    s_sub_u32 s0, s0, 1
    s_cbranch_scc1 Lok_72
    s_sleep 1
    s_buffer_load_dwordx16 s[4:19], s[36:39], s96 offset:16384 glc
Lretry_73w:
    s_waitcnt lgkmcnt(0)
    s_cmp_eq_u64 s[6:7], s[94:95]
    s_cbranch_scc0 Lretry_73
    s_branch Lok_72
Lretry_75i:
    s_mov_b32 s0, 20000
    s_branch Lretry_75w
Lretry_75:
    s_sub_u32 s0, s0, 1
    s_cbranch_scc1 Lok_74
    s_sleep 1
    s_buffer_load_dwordx16 s[4:19], s[36:39], s96 offset:16384 glc
Lretry_75w:
    s_waitcnt lgkmcnt(0)
    s_cmp_eq_u64 s[10:11], s[94:95]
    s_cbranch_scc0 Lretry_75
    s_branch Lok_74
Lretry_77i:
    s_mov_b32 s0, 20000
Lretry_77:
    s_sub_u32 s0, s0, 1
    s_cbranch_scc1 Lok_76
    s_sleep 1
    s_buffer_load_dwordx4 s[20:23], s[36:39], s96 glc
Lretry_77w:
    s_waitcnt lgkmcnt(0)
    s_cmp_eq_u64 s[20:21], s[94:95]
    s_cbranch_scc0 Lretry_77
    s_branch Lok_76
Lretry_79i:
    s_mov_b32 s0, 20000
    s_branch Lretry_79w
Lretry_79:
    s_sub_u32 s0, s0, 1
    s_cbranch_scc1 Lok_78
    s_sleep 1
    s_buffer_load_dwordx4 s[20:23], s[36:39], s96 glc
Lretry_79w:
    s_waitcnt lgkmcnt(0)
    s_cmp_eq_u64 s[22:23], s[94:95]
    s_cbranch_scc0 Lretry_79
    s_branch Lok_78
.p2align 12
L_pathFb:
    s_load_dwordx2 s[12:13], s[0:1], 40
    s_load_dwordx2 s[24:25], s[0:1], 80
    s_load_dwordx2 s[28:29], s[0:1], 48
    s_load_dwordx2 s[40:41], s[0:1], 16
    s_load_dwordx2 s[32:33], s[0:1], 72
    s_load_dwordx2 s[16:17], s[0:1], 56
    v_lshrrev_b32 v20, 3, v1
    v_and_b32 v21, 7, v1
    v_lshrrev_b32 v22, 4, v1
    v_xor_b32 v23, v21, v22
    v_lshlrev_b32 v23, 4, v23
    v_lshl_add_u32 v23, v20, 10, v23
    s_lshl_b32 s76, s66, 3
    s_add_u32 s76, s76, s64
    s_lshl_b32 s77, s76, 14
    v_add_u32 v96, s77, v23
    v_xor_b32 v97, 64, v96
    v_add_u32 v97, 7168, v97
    v_and_b32 v22, 1, v22
    v_lshlrev_b32 v22, 2, v22
    v_xor_b32 v21, v21, v22
    v_lshlrev_b32 v21, 4, v21
    s_and_b32 s62, s92, 7
    s_and_b32 s75, s93, 6
    s_xor_b32 s62, s62, s75
    s_lshl_b32 s62, s62, 7
    s_mul_i32 s75, s62, 1376
    s_lshl_b32 s72, s64, 11
    s_lshl_b32 s71, s64, 10
    s_add_u32 s73, s71, 65536
    s_mov_b32 m0, s72
    s_mov_b32 s6, 0x200000
    s_mov_b32 s7, 0x20000
    s_mov_b32 s22, 0x158000
    s_mov_b32 s23, 0x20000
    s_mul_i32 s3, s68, 5
    s_min_u32 s77, s68, 3
    s_add_u32 s3, s3, s77
    s_lshl_b32 s3, s3, 6
    s_mul_i32 s77, s64, 22016
    s_add_u32 s77, s77, s3
    v_mul_u32_u24 v98, 2752, v20
    v_lshl_add_u32 v4, v20, 10, v21
    s_and_b32 s76, s64, 1
    s_lshl_b32 s76, s76, 5
    v_xor_b32 v21, s76, v21
    v_and_b32 v22, 0x70, v21
    v_add3_u32 v99, v98, v22, s77
    v_add3_u32 v98, v98, v21, s77
    v_lshrrev_b32 v23, 4, v1
    v_lshlrev_b32 v15, 3, v23
    s_mov_b32 s14, 0xac0
    s_mov_b32 s15, 0x20000
    s_waitcnt lgkmcnt(0)
    buffer_load_dwordx4 v96, s[4:7], s62 offen offset:0 lds
    buffer_load_dwordx4 v97, s[4:7], s62 offen offset:1024 lds
    s_add_u32 m0, s73, 0
    s_nop 0
    buffer_load_dwordx4 v98, s[20:23], s75 offen offset:0 lds
    s_add_u32 m0, s73, 8064
    s_nop 0
    buffer_load_dwordx4 v98, s[20:23], s75 offen offset:128 lds
    s_add_u32 m0, s73, 16128
    s_nop 0
    buffer_load_dwordx4 v99, s[20:23], s75 offen offset:256 lds
    s_lshl_b32 s76, s2, 3
    s_add_u32 s76, s76, s64
    s_lshl_b32 s77, s76, 10
    s_add_u32 s77, s77, 0x800000
    s_lshl_b32 s76, s76, 7
    s_add_u32 s76, s76, 0x77a000
    s_cmp_lt_u32 s2, 64
    s_cselect_b32 s76, s77, s76
    s_cmp_lt_u32 s2, 80
    s_cbranch_scc0 Lnop_80
    s_load_dword s95, s[36:37], s76 glc
Lnop_80:
    s_mov_b32 s63, 1
    s_and_b32 s76, s93, 3
    s_lshl_b32 s76, s76, 2
    s_add_u32 s76, s76, s64
    s_cmp_eq_u32 s76, 4
    s_cbranch_scc1 LIFb_0
    s_cmp_eq_u32 s76, 5
    s_cbranch_scc1 LIFb_1
    s_cmp_eq_u32 s76, 6
    s_cbranch_scc1 LIFb_2
    s_cmp_eq_u32 s76, 7
    s_cbranch_scc1 LIFb_3
    s_cmp_eq_u32 s76, 8
    s_cbranch_scc1 LIFb_4
    s_cmp_eq_u32 s76, 9
    s_cbranch_scc1 LIFb_5
    s_cmp_eq_u32 s76, 10
    s_cbranch_scc1 LIFb_6
    s_cmp_eq_u32 s76, 11
    s_cbranch_scc1 LIFb_7
    s_cmp_eq_u32 s76, 12
    s_cbranch_scc1 LIFb_8
    s_cmp_eq_u32 s76, 13
    s_cbranch_scc1 LIFb_9
    s_cmp_eq_u32 s76, 14
    s_cbranch_scc1 LIFb_10
    s_cmp_eq_u32 s76, 15
    s_cbranch_scc1 LIFb_11
    s_cmp_eq_u32 s76, 16
    s_cbranch_scc1 LIFb_12
LIFb_10:
LIFb_11:
LIFb_12:
LIFb_ret:
    s_mov_b32 s63, 0
    s_barrier
    buffer_load_dwordx2 v[150:151], v15, s[12:15], s3 offen offset:64
    buffer_load_dwordx2 v[154:155], v15, s[12:15], s3 offen offset:96
    buffer_load_dwordx2 v[158:159], v15, s[12:15], s3 offen offset:192
    buffer_load_dwordx2 v[162:163], v15, s[12:15], s3 offen offset:224
    buffer_load_dwordx2 v[166:167], v15, s[12:15], s3 offen offset:320
    buffer_load_dwordx2 v[170:171], v15, s[12:15], s3 offen offset:352
    s_add_u32 m0, s72, 16384
    s_xor_b32 s74, s62, 128
    buffer_load_dwordx4 v96, s[4:7], s74 offen offset:0 lds
    buffer_load_dwordx4 v97, s[4:7], s74 offen offset:1024 lds
    s_add_u32 m0, s73, 24576
    s_xor_b32 s75, s62, 128
    s_mul_i32 s75, s75, 1376
    buffer_load_dwordx4 v98, s[20:23], s75 offen offset:0 lds
    s_add_u32 m0, s73, 32640
    s_nop 0
    buffer_load_dwordx4 v98, s[20:23], s75 offen offset:128 lds
    s_add_u32 m0, s73, 40704
    s_nop 0
    buffer_load_dwordx4 v99, s[20:23], s75 offen offset:256 lds
    s_and_b32 s65, s64, 3
    v_and_b32 v20, 15, v1
    v_lshrrev_b32 v21, 4, v1
    v_bfe_u32 v22, v1, 1, 3
    v_xor_b32 v22, v22, v21
    v_lshlrev_b32 v22, 4, v22
    v_lshl_add_u32 v22, v20, 7, v22
    s_lshl_b32 s76, s65, 12
    v_add_u32 v180, s76, v22
    v_xor_b32 v181, 64, v180
    v_bfe_u32 v20, v1, 2, 2
    v_and_b32 v22, 3, v1
    v_lshlrev_b32 v22, 3, v22
    v_bfe_u32 v23, v1, 4, 1
    v_lshl_add_u32 v22, v23, 5, v22
    v_bfe_u32 v23, v1, 3, 1
    v_lshl_add_u32 v22, v23, 6, v22
    v_lshl_add_u32 v22, v20, 7, v22
    v_lshl_add_u32 v23, v21, 10, v22
    v_xor_b32 v182, 0x10040, v23
    v_add_u32 v183, 49152, v182
    v_xor_b32 v184, 32, v182
    v_xor_b32 v185, 32, v183
    v_lshrrev_b32 v21, 5, v1
    v_lshl_add_u32 v5, v21, 9, v22
    v_lshlrev_b32 v2, 4, v1
    v_mov_b32 v33, 0
    s_mov_b32 s38, 0x900080
    s_mov_b32 s39, 0x20000
    s_mov_b32 s26, 0x100
    s_mov_b32 s27, 0x20000
    s_lshl_b32 s80, s66, 2
    s_add_u32 s80, s80, s65
    s_lshl_b32 s79, s80, 11
    v_and_b32 v20, 15, v1
    v_lshrrev_b32 v22, 4, v1
    v_lshlrev_b32 v22, 9, v22
    v_lshl_add_u32 v22, v20, 4, v22
    v_add_u32 v28, s79, v22
    s_lshl_b32 s86, s3, 11
    s_add_u32 s86, s86, 2097152
    s_lshl_b32 s69, s92, 2
    s_and_b32 s79, s93, 3
    s_add_u32 s69, s69, s79
    s_lshr_b32 s70, s93, 2
    s_lshl_b32 s79, s70, 7
    v_add_u32 v4, s79, v4
    s_mov_b32 s30, 0x158000
    s_mov_b32 s31, 0x20000
    s_mov_b32 s42, 0x80000
    s_mov_b32 s43, 0x20000
    s_waitcnt lgkmcnt(0)
    s_waitcnt vmcnt(11)
    s_barrier
    ds_read_b128 v[72:75], v180 offset:0
LIFb_0:
    s_cmp_eq_u32 s63, 1
    s_cbranch_scc1 LIFb_ret
    ds_read_b64_tr_b16 v[36:37], v182 offset:0
    ds_read_b64_tr_b16 v[38:39], v182 offset:512
    ds_read_b64_tr_b16 v[40:41], v182 offset:8192
    ds_read_b64_tr_b16 v[42:43], v182 offset:8704
    ds_read_b64_tr_b16 v[44:45], v182 offset:16384
    ds_read_b64_tr_b16 v[46:47], v182 offset:16896
    ds_read_b128 v[76:79], v180 offset:2048
    ds_read_b64_tr_b16 v[48:49], v184 offset:0
    ds_read_b64_tr_b16 v[50:51], v184 offset:512
    ds_read_b64_tr_b16 v[52:53], v184 offset:8192
    ds_read_b64_tr_b16 v[54:55], v184 offset:8704
    ds_read_b64_tr_b16 v[56:57], v184 offset:16384
    ds_read_b64_tr_b16 v[58:59], v184 offset:16896
    s_waitcnt vmcnt(10)
    v_lshlrev_b32 v148, 16, v150
    v_and_b32 v149, 0xffff0000, v150
    v_lshlrev_b32 v150, 16, v151
    v_and_b32 v151, 0xffff0000, v151
    s_waitcnt vmcnt(9)
    v_lshlrev_b32 v152, 16, v154
    v_and_b32 v153, 0xffff0000, v154
    v_lshlrev_b32 v154, 16, v155
    v_and_b32 v155, 0xffff0000, v155
    s_waitcnt vmcnt(8)
    v_lshlrev_b32 v156, 16, v158
    v_and_b32 v157, 0xffff0000, v158
    v_lshlrev_b32 v158, 16, v159
    v_and_b32 v159, 0xffff0000, v159
    s_waitcnt vmcnt(7)
    v_lshlrev_b32 v160, 16, v162
    v_and_b32 v161, 0xffff0000, v162
    v_lshlrev_b32 v162, 16, v163
    v_and_b32 v163, 0xffff0000, v163
    s_waitcnt vmcnt(6)
    v_lshlrev_b32 v164, 16, v166
    v_and_b32 v165, 0xffff0000, v166
    v_lshlrev_b32 v166, 16, v167
    v_and_b32 v167, 0xffff0000, v167
    s_waitcnt vmcnt(5)
    v_lshlrev_b32 v168, 16, v170
    v_and_b32 v169, 0xffff0000, v170
    v_lshlrev_b32 v170, 16, v171
    v_and_b32 v171, 0xffff0000, v171
    s_waitcnt lgkmcnt(11)
    v_mfma_f32_16x16x32_bf16 v[100:103], v[36:39], v[72:75], v[148:151]
    ds_read_b128 v[80:83], v181 offset:0
    ds_read_b64_tr_b16 v[60:61], v182 offset:4096
    s_waitcnt lgkmcnt(8)
    v_mfma_f32_16x16x32_bf16 v[108:111], v[36:39], v[76:79], v[148:151]
    ds_read_b64_tr_b16 v[62:63], v182 offset:4608
    s_add_u32 m0, s72, 32768
    s_xor_b32 s74, s62, 256
    buffer_load_dwordx4 v96, s[4:7], s74 offen offset:0 lds
    s_mul_i32 s79, s64, 5
    s_min_u32 s80, s64, 3
    s_add_u32 s79, s79, s80
    s_lshl_b32 s87, s79, 15
    s_add_u32 s79, s79, 16
    s_lshl_b32 s89, s79, 17
    v_mfma_f32_16x16x32_bf16 v[116:119], v[40:43], v[72:75], v[156:159]
    ds_read_b64_tr_b16 v[64:65], v182 offset:12288
    ds_read_b64_tr_b16 v[66:67], v182 offset:12800
    v_mfma_f32_16x16x32_bf16 v[124:127], v[40:43], v[76:79], v[156:159]
    s_lshl_b32 s88, s64, 16
    s_lshl_b32 s90, s64, 18
    v_mfma_f32_16x16x32_bf16 v[132:135], v[44:47], v[72:75], v[164:167]
    ds_read_b64_tr_b16 v[68:69], v182 offset:20480
    ds_read_b64_tr_b16 v[70:71], v182 offset:20992
    v_mfma_f32_16x16x32_bf16 v[140:143], v[44:47], v[76:79], v[164:167]
    s_mov_b32 s82, 0xbdd2d3e8
    s_mov_b32 s83, 0xbdd2d3e8
    s_waitcnt lgkmcnt(11)
    v_mfma_f32_16x16x32_bf16 v[104:107], v[48:51], v[72:75], v[152:155]
    ds_read_b128 v[84:87], v181 offset:2048
    ds_read_b64_tr_b16 v[36:37], v184 offset:4096
    v_mfma_f32_16x16x32_bf16 v[112:115], v[48:51], v[76:79], v[152:155]
    ds_read_b64_tr_b16 v[38:39], v184 offset:4608
    buffer_load_dwordx4 v97, s[4:7], s74 offen offset:1024 lds
    s_mov_b32 s84, 1.0
    s_mov_b32 s85, 1.0
    s_waitcnt lgkmcnt(12)
    v_mfma_f32_16x16x32_bf16 v[120:123], v[52:55], v[72:75], v[160:163]
    ds_read_b64_tr_b16 v[40:41], v184 offset:12288
    ds_read_b64_tr_b16 v[42:43], v184 offset:12800
    v_mfma_f32_16x16x32_bf16 v[128:131], v[52:55], v[76:79], v[160:163]
    s_add_u32 m0, s73, 49152
    s_xor_b32 s75, s62, 256
    s_mul_i32 s75, s75, 1376
    buffer_load_dwordx4 v98, s[20:23], s75 offen offset:0 lds
    v_mov_b32 v186, 0xc0135761
    v_mov_b32 v187, 0xc0135761
    s_waitcnt lgkmcnt(12)
    v_mfma_f32_16x16x32_bf16 v[136:139], v[56:59], v[72:75], v[168:171]
    ds_read_b64_tr_b16 v[44:45], v184 offset:20480
    ds_read_b64_tr_b16 v[46:47], v184 offset:20992
    v_mfma_f32_16x16x32_bf16 v[144:147], v[56:59], v[76:79], v[168:171]
    s_lshl_b32 s81, s66, 15
    s_lshr_b32 s79, s65, 1
    s_lshl_b32 s79, s79, 10
    s_add_u32 s81, s81, s79
    s_and_b32 s79, s65, 1
    s_lshl_b32 s79, s79, 2
    s_add_u32 s81, s81, s79
    s_add_u32 s81, s81, 0x800000
    s_waitcnt vmcnt(3) lgkmcnt(0)
    s_barrier
    v_mfma_f32_16x16x32_bf16 v[100:103], v[60:63], v[80:83], v[100:103]
    ds_read_b128 v[72:75], v180 offset:16384
    ds_read_b64_tr_b16 v[48:49], v182 offset:24576
    v_mfma_f32_16x16x32_bf16 v[108:111], v[60:63], v[84:87], v[108:111]
    ds_read_b64_tr_b16 v[50:51], v182 offset:25088
    s_add_u32 m0, s73, 57216
    s_nop 0
    buffer_load_dwordx4 v98, s[20:23], s75 offen offset:128 lds
    s_lshl_b32 s79, s67, 11
    s_add_u32 s79, s79, s81
    v_mov_b32 v13, s79
    v_mfma_f32_16x16x32_bf16 v[116:119], v[64:67], v[80:83], v[116:119]
    ds_read_b64_tr_b16 v[52:53], v182 offset:32768
    ds_read_b64_tr_b16 v[54:55], v182 offset:33280
    v_mfma_f32_16x16x32_bf16 v[124:127], v[64:67], v[84:87], v[124:127]
    s_and_b32 s79, s64, 1
    s_lshl_b32 s79, s79, 6
    s_add_u32 s79, s79, s71
    v_xor_b32 v5, s79, v5
    v_xor_b32 v6, 64, v5
    v_mfma_f32_16x16x32_bf16 v[132:135], v[68:71], v[80:83], v[132:135]
    ds_read_b64_tr_b16 v[56:57], v182 offset:40960
    ds_read_b64_tr_b16 v[58:59], v182 offset:41472
    v_mfma_f32_16x16x32_bf16 v[140:143], v[68:71], v[84:87], v[140:143]
    v_add_u32 v7, 0x10000, v5
    v_add_u32 v8, 0x10000, v6
    v_mfma_f32_16x16x32_bf16 v[104:107], v[36:39], v[80:83], v[104:107]
    ds_read_b128 v[76:79], v180 offset:18432
    ds_read_b64_tr_b16 v[60:61], v184 offset:24576
    v_mfma_f32_16x16x32_bf16 v[112:115], v[36:39], v[84:87], v[112:115]
    ds_read_b64_tr_b16 v[62:63], v184 offset:25088
    s_add_u32 m0, s73, 65280
    s_nop 0
    buffer_load_dwordx4 v99, s[20:23], s75 offen offset:256 lds
    v_add_u32 v9, 0x10000, v7
    v_add_u32 v10, 0x10000, v8
    v_mfma_f32_16x16x32_bf16 v[120:123], v[40:43], v[80:83], v[120:123]
    ds_read_b64_tr_b16 v[64:65], v184 offset:32768
    ds_read_b64_tr_b16 v[66:67], v184 offset:33280
    v_mfma_f32_16x16x32_bf16 v[128:131], v[40:43], v[84:87], v[128:131]
    s_add_u32 m0, s72, 49152
    s_xor_b32 s74, s62, 384
    buffer_load_dwordx4 v96, s[4:7], s74 offen offset:0 lds
    s_mov_b32 s34, 0x200000
    s_mov_b32 s35, 0x20000
    v_mfma_f32_16x16x32_bf16 v[136:139], v[44:47], v[80:83], v[136:139]
    ds_read_b64_tr_b16 v[68:69], v184 offset:40960
LIFb_1:
    s_cmp_eq_u32 s63, 1
    s_cbranch_scc1 LIFb_ret
    ds_read_b64_tr_b16 v[70:71], v184 offset:41472
    v_mfma_f32_16x16x32_bf16 v[144:147], v[44:47], v[84:87], v[144:147]
    s_lshl_b32 s79, s69, 1
    s_lshr_b32 s80, s65, 1
    s_add_u32 s79, s79, s80
    s_lshl_b32 s80, s79, 11
    v_add_u32 v11, s80, v2
    v_xor_b32 v12, 2048, v11
    s_lshl_b32 s79, s79, 7
    s_lshr_b32 s80, s64, 1
    s_lshl_b32 s80, s80, 13
    s_add_u32 s79, s79, s80
    s_add_u32 s79, s79, 0x798000
    v_and_b32 v20, 31, v1
    v_lshl_add_u32 v29, v20, 2, s79
    s_waitcnt lgkmcnt(11)
    v_mfma_f32_16x16x32_bf16 v[100:103], v[48:51], v[72:75], v[100:103]
    ds_read_b128 v[80:83], v181 offset:16384
    ds_read_b64_tr_b16 v[36:37], v182 offset:28672
    s_waitcnt lgkmcnt(8)
    v_mfma_f32_16x16x32_bf16 v[108:111], v[48:51], v[76:79], v[108:111]
    ds_read_b64_tr_b16 v[38:39], v182 offset:29184
    buffer_load_dwordx4 v97, s[4:7], s74 offen offset:1024 lds
    s_lshr_b32 s79, s69, 1
    s_lshl_b32 s79, s79, 15
    s_and_b32 s80, s69, 1
    s_lshl_b32 s80, s80, 10
    s_add_u32 s79, s79, s80
    s_add_u32 s79, s79, 0x800000
    s_add_u32 s96, s79, s72
    v_mfma_f32_16x16x32_bf16 v[116:119], v[52:55], v[72:75], v[116:119]
    ds_read_b64_tr_b16 v[40:41], v182 offset:36864
    ds_read_b64_tr_b16 v[42:43], v182 offset:37376
    v_mfma_f32_16x16x32_bf16 v[124:127], v[52:55], v[76:79], v[124:127]
    v_mfma_f32_16x16x32_bf16 v[132:135], v[56:59], v[72:75], v[132:135]
    ds_read_b64_tr_b16 v[44:45], v182 offset:45056
    ds_read_b64_tr_b16 v[46:47], v182 offset:45568
    v_mfma_f32_16x16x32_bf16 v[140:143], v[56:59], v[76:79], v[140:143]
    v_lshlrev_b32 v206, 7, v1
    v_mov_b32 v207, 0x40000000
    v_cmp_gt_u32 vcc, 8, v1
    s_lshl_b32 s76, s2, 3
    s_add_u32 s76, s76, s64
    v_cndmask_b32 v206, v207, v206, vcc
    s_lshl_b32 s76, s76, 10
    s_sub_u32 s77, s76, 1409024
    s_cbranch_scc0 Ltu_81
    buffer_load_dword v207, v206, s[28:31], s76 offen
    s_branch Ltv_82
Ltu_81:
    buffer_load_dword v207, v206, s[40:43], s77 offen
Ltv_82:
    s_mov_b32 s18, 0x400
    s_mov_b32 s19, 0x20000
    s_lshl_b32 s79, s70, 7
    s_and_b32 s80, s65, 1
    s_lshl_b32 s80, s80, 6
    s_add_u32 s79, s79, s80
    v_lshlrev_b32 v22, 3, v21
    buffer_load_dwordx2 v[24:25], v22, s[16:19], s79 offen offset:32
    buffer_load_dwordx2 v[26:27], v22, s[16:19], s79 offen offset:48
    s_waitcnt lgkmcnt(11)
    v_mfma_f32_16x16x32_bf16 v[104:107], v[60:63], v[72:75], v[104:107]
    ds_read_b128 v[84:87], v181 offset:18432
    ds_read_b64_tr_b16 v[48:49], v184 offset:28672
    v_mfma_f32_16x16x32_bf16 v[112:115], v[60:63], v[76:79], v[112:115]
    ds_read_b64_tr_b16 v[50:51], v184 offset:29184
    s_add_u32 m0, s73, 73728
    s_xor_b32 s75, s62, 384
    s_mul_i32 s75, s75, 1376
    buffer_load_dwordx4 v98, s[20:23], s75 offen offset:0 lds
    s_waitcnt lgkmcnt(12)
    v_mfma_f32_16x16x32_bf16 v[120:123], v[64:67], v[72:75], v[120:123]
    ds_read_b64_tr_b16 v[52:53], v184 offset:36864
    ds_read_b64_tr_b16 v[54:55], v184 offset:37376
    v_mfma_f32_16x16x32_bf16 v[128:131], v[64:67], v[76:79], v[128:131]
    s_add_u32 m0, s73, 81792
    s_nop 0
    buffer_load_dwordx4 v98, s[20:23], s75 offen offset:128 lds
    s_waitcnt lgkmcnt(12)
    v_mfma_f32_16x16x32_bf16 v[136:139], v[68:71], v[72:75], v[136:139]
    ds_read_b64_tr_b16 v[56:57], v184 offset:45056
    ds_read_b64_tr_b16 v[58:59], v184 offset:45568
    v_mfma_f32_16x16x32_bf16 v[144:147], v[68:71], v[76:79], v[144:147]
    s_waitcnt vmcnt(7) lgkmcnt(0)
    s_barrier
    v_mfma_f32_16x16x32_bf16 v[100:103], v[36:39], v[80:83], v[100:103]
    ds_read_b128 v[72:75], v180 offset:32768
    ds_read_b64_tr_b16 v[60:61], v183 offset:0
    v_mfma_f32_16x16x32_bf16 v[108:111], v[36:39], v[84:87], v[108:111]
    ds_read_b64_tr_b16 v[62:63], v183 offset:512
    s_add_u32 m0, s73, 89856
    s_nop 0
    buffer_load_dwordx4 v99, s[20:23], s75 offen offset:256 lds
    v_mfma_f32_16x16x32_bf16 v[116:119], v[40:43], v[80:83], v[116:119]
    ds_read_b64_tr_b16 v[64:65], v183 offset:8192
    ds_read_b64_tr_b16 v[66:67], v183 offset:8704
    v_mfma_f32_16x16x32_bf16 v[124:127], v[40:43], v[84:87], v[124:127]
    v_mfma_f32_16x16x32_bf16 v[132:135], v[44:47], v[80:83], v[132:135]
    ds_read_b64_tr_b16 v[68:69], v183 offset:16384
    ds_read_b64_tr_b16 v[70:71], v183 offset:16896
    v_mfma_f32_16x16x32_bf16 v[140:143], v[44:47], v[84:87], v[140:143]
    v_mfma_f32_16x16x32_bf16 v[104:107], v[48:51], v[80:83], v[104:107]
    ds_read_b128 v[76:79], v180 offset:34816
    ds_read_b64_tr_b16 v[36:37], v185 offset:0
    v_mfma_f32_16x16x32_bf16 v[112:115], v[48:51], v[84:87], v[112:115]
    ds_read_b64_tr_b16 v[38:39], v185 offset:512
    s_add_u32 m0, s72, 0
    s_xor_b32 s74, s62, 512
    buffer_load_dwordx4 v96, s[4:7], s74 offen offset:0 lds
    v_mfma_f32_16x16x32_bf16 v[120:123], v[52:55], v[80:83], v[120:123]
    ds_read_b64_tr_b16 v[40:41], v185 offset:8192
    ds_read_b64_tr_b16 v[42:43], v185 offset:8704
    v_mfma_f32_16x16x32_bf16 v[128:131], v[52:55], v[84:87], v[128:131]
    buffer_load_dwordx4 v97, s[4:7], s74 offen offset:1024 lds
    v_mfma_f32_16x16x32_bf16 v[136:139], v[56:59], v[80:83], v[136:139]
    ds_read_b64_tr_b16 v[44:45], v185 offset:16384
    ds_read_b64_tr_b16 v[46:47], v185 offset:16896
    v_mfma_f32_16x16x32_bf16 v[144:147], v[56:59], v[84:87], v[144:147]
    s_waitcnt lgkmcnt(11)
    v_mfma_f32_16x16x32_bf16 v[100:103], v[60:63], v[72:75], v[100:103]
    ds_read_b128 v[80:83], v181 offset:32768
    ds_read_b64_tr_b16 v[48:49], v183 offset:4096
    s_waitcnt lgkmcnt(8)
    v_mfma_f32_16x16x32_bf16 v[108:111], v[60:63], v[76:79], v[108:111]
    ds_read_b64_tr_b16 v[50:51], v183 offset:4608
    s_add_u32 m0, s73, 0
    s_xor_b32 s75, s62, 512
    s_mul_i32 s75, s75, 1376
    buffer_load_dwordx4 v98, s[20:23], s75 offen offset:0 lds
    v_mfma_f32_16x16x32_bf16 v[116:119], v[64:67], v[72:75], v[116:119]
    ds_read_b64_tr_b16 v[52:53], v183 offset:12288
    ds_read_b64_tr_b16 v[54:55], v183 offset:12800
    v_mfma_f32_16x16x32_bf16 v[124:127], v[64:67], v[76:79], v[124:127]
    v_mfma_f32_16x16x32_bf16 v[132:135], v[68:71], v[72:75], v[132:135]
    ds_read_b64_tr_b16 v[56:57], v183 offset:20480
    ds_read_b64_tr_b16 v[58:59], v183 offset:20992
    v_mfma_f32_16x16x32_bf16 v[140:143], v[68:71], v[76:79], v[140:143]
    s_waitcnt lgkmcnt(11)
    v_mfma_f32_16x16x32_bf16 v[104:107], v[36:39], v[72:75], v[104:107]
    ds_read_b128 v[84:87], v181 offset:34816
    ds_read_b64_tr_b16 v[60:61], v185 offset:4096
    v_mfma_f32_16x16x32_bf16 v[112:115], v[36:39], v[76:79], v[112:115]
    ds_read_b64_tr_b16 v[62:63], v185 offset:4608
    s_add_u32 m0, s73, 8064
    s_nop 0
    buffer_load_dwordx4 v98, s[20:23], s75 offen offset:128 lds
    s_waitcnt lgkmcnt(12)
    v_mfma_f32_16x16x32_bf16 v[120:123], v[40:43], v[72:75], v[120:123]
    ds_read_b64_tr_b16 v[64:65], v185 offset:12288
    ds_read_b64_tr_b16 v[66:67], v185 offset:12800
    v_mfma_f32_16x16x32_bf16 v[128:131], v[40:43], v[76:79], v[128:131]
LIFb_2:
    s_cmp_eq_u32 s63, 1
    s_cbranch_scc1 LIFb_ret
    s_add_u32 m0, s73, 16128
    s_nop 0
    buffer_load_dwordx4 v99, s[20:23], s75 offen offset:256 lds
    s_waitcnt lgkmcnt(12)
    v_mfma_f32_16x16x32_bf16 v[136:139], v[44:47], v[72:75], v[136:139]
    ds_read_b64_tr_b16 v[68:69], v185 offset:20480
    ds_read_b64_tr_b16 v[70:71], v185 offset:20992
    v_mfma_f32_16x16x32_bf16 v[144:147], v[44:47], v[76:79], v[144:147]
    s_waitcnt vmcnt(5) lgkmcnt(0)
    s_barrier
    v_mfma_f32_16x16x32_bf16 v[100:103], v[48:51], v[80:83], v[100:103]
    ds_read_b128 v[72:75], v180 offset:49152
    ds_read_b64_tr_b16 v[36:37], v183 offset:24576
    v_mfma_f32_16x16x32_bf16 v[108:111], v[48:51], v[84:87], v[108:111]
    ds_read_b64_tr_b16 v[38:39], v183 offset:25088
    s_add_u32 m0, s72, 16384
    s_xor_b32 s74, s62, 640
    buffer_load_dwordx4 v96, s[4:7], s74 offen offset:0 lds
    v_mfma_f32_16x16x32_bf16 v[116:119], v[52:55], v[80:83], v[116:119]
    ds_read_b64_tr_b16 v[40:41], v183 offset:32768
    ds_read_b64_tr_b16 v[42:43], v183 offset:33280
    v_mfma_f32_16x16x32_bf16 v[124:127], v[52:55], v[84:87], v[124:127]
    v_mfma_f32_16x16x32_bf16 v[132:135], v[56:59], v[80:83], v[132:135]
    ds_read_b64_tr_b16 v[44:45], v183 offset:40960
    ds_read_b64_tr_b16 v[46:47], v183 offset:41472
    v_mfma_f32_16x16x32_bf16 v[140:143], v[56:59], v[84:87], v[140:143]
    v_mfma_f32_16x16x32_bf16 v[104:107], v[60:63], v[80:83], v[104:107]
    ds_read_b128 v[76:79], v180 offset:51200
    ds_read_b64_tr_b16 v[48:49], v185 offset:24576
    v_mfma_f32_16x16x32_bf16 v[112:115], v[60:63], v[84:87], v[112:115]
    ds_read_b64_tr_b16 v[50:51], v185 offset:25088
    buffer_load_dwordx4 v97, s[4:7], s74 offen offset:1024 lds
    v_mfma_f32_16x16x32_bf16 v[120:123], v[64:67], v[80:83], v[120:123]
    ds_read_b64_tr_b16 v[52:53], v185 offset:32768
    ds_read_b64_tr_b16 v[54:55], v185 offset:33280
    v_mfma_f32_16x16x32_bf16 v[128:131], v[64:67], v[84:87], v[128:131]
    s_add_u32 m0, s73, 24576
    s_xor_b32 s75, s62, 640
    s_mul_i32 s75, s75, 1376
    buffer_load_dwordx4 v98, s[20:23], s75 offen offset:0 lds
    v_mfma_f32_16x16x32_bf16 v[136:139], v[68:71], v[80:83], v[136:139]
    ds_read_b64_tr_b16 v[56:57], v185 offset:40960
    ds_read_b64_tr_b16 v[58:59], v185 offset:41472
    v_mfma_f32_16x16x32_bf16 v[144:147], v[68:71], v[84:87], v[144:147]
    s_waitcnt lgkmcnt(11)
    v_mfma_f32_16x16x32_bf16 v[100:103], v[36:39], v[72:75], v[100:103]
    ds_read_b128 v[80:83], v181 offset:49152
    ds_read_b64_tr_b16 v[60:61], v183 offset:28672
    s_waitcnt lgkmcnt(8)
    v_mfma_f32_16x16x32_bf16 v[108:111], v[36:39], v[76:79], v[108:111]
    ds_read_b64_tr_b16 v[62:63], v183 offset:29184
    s_add_u32 m0, s73, 32640
    s_nop 0
    buffer_load_dwordx4 v98, s[20:23], s75 offen offset:128 lds
    v_mfma_f32_16x16x32_bf16 v[116:119], v[40:43], v[72:75], v[116:119]
    ds_read_b64_tr_b16 v[64:65], v183 offset:36864
    ds_read_b64_tr_b16 v[66:67], v183 offset:37376
    v_mfma_f32_16x16x32_bf16 v[124:127], v[40:43], v[76:79], v[124:127]
    v_mfma_f32_16x16x32_bf16 v[132:135], v[44:47], v[72:75], v[132:135]
    ds_read_b64_tr_b16 v[68:69], v183 offset:45056
    ds_read_b64_tr_b16 v[70:71], v183 offset:45568
    v_mfma_f32_16x16x32_bf16 v[140:143], v[44:47], v[76:79], v[140:143]
    s_waitcnt lgkmcnt(11)
    v_mfma_f32_16x16x32_bf16 v[104:107], v[48:51], v[72:75], v[104:107]
    ds_read_b128 v[84:87], v181 offset:51200
    ds_read_b64_tr_b16 v[36:37], v185 offset:28672
    v_mfma_f32_16x16x32_bf16 v[112:115], v[48:51], v[76:79], v[112:115]
    ds_read_b64_tr_b16 v[38:39], v185 offset:29184
    s_add_u32 m0, s73, 40704
    s_nop 0
    buffer_load_dwordx4 v99, s[20:23], s75 offen offset:256 lds
    s_waitcnt lgkmcnt(12)
    v_mfma_f32_16x16x32_bf16 v[120:123], v[52:55], v[72:75], v[120:123]
    ds_read_b64_tr_b16 v[40:41], v185 offset:36864
    ds_read_b64_tr_b16 v[42:43], v185 offset:37376
    v_mfma_f32_16x16x32_bf16 v[128:131], v[52:55], v[76:79], v[128:131]
    s_add_u32 m0, s72, 32768
    s_xor_b32 s74, s62, 768
    buffer_load_dwordx4 v96, s[4:7], s74 offen offset:0 lds
    s_waitcnt lgkmcnt(12)
    v_mfma_f32_16x16x32_bf16 v[136:139], v[56:59], v[72:75], v[136:139]
    ds_read_b64_tr_b16 v[44:45], v185 offset:45056
    ds_read_b64_tr_b16 v[46:47], v185 offset:45568
    v_mfma_f32_16x16x32_bf16 v[144:147], v[56:59], v[76:79], v[144:147]
    s_waitcnt vmcnt(6) lgkmcnt(0)
    s_barrier
    v_mfma_f32_16x16x32_bf16 v[100:103], v[60:63], v[80:83], v[100:103]
    ds_read_b128 v[72:75], v180 offset:0
    ds_read_b64_tr_b16 v[48:49], v182 offset:0
    v_mfma_f32_16x16x32_bf16 v[108:111], v[60:63], v[84:87], v[108:111]
    ds_read_b64_tr_b16 v[50:51], v182 offset:512
    buffer_load_dwordx4 v97, s[4:7], s74 offen offset:1024 lds
    v_mfma_f32_16x16x32_bf16 v[116:119], v[64:67], v[80:83], v[116:119]
    ds_read_b64_tr_b16 v[52:53], v182 offset:8192
    ds_read_b64_tr_b16 v[54:55], v182 offset:8704
    v_mfma_f32_16x16x32_bf16 v[124:127], v[64:67], v[84:87], v[124:127]
    v_mfma_f32_16x16x32_bf16 v[132:135], v[68:71], v[80:83], v[132:135]
    ds_read_b64_tr_b16 v[56:57], v182 offset:16384
    ds_read_b64_tr_b16 v[58:59], v182 offset:16896
    v_mfma_f32_16x16x32_bf16 v[140:143], v[68:71], v[84:87], v[140:143]
    v_mfma_f32_16x16x32_bf16 v[104:107], v[36:39], v[80:83], v[104:107]
    ds_read_b128 v[76:79], v180 offset:2048
    ds_read_b64_tr_b16 v[60:61], v184 offset:0
    v_mfma_f32_16x16x32_bf16 v[112:115], v[36:39], v[84:87], v[112:115]
    ds_read_b64_tr_b16 v[62:63], v184 offset:512
    s_add_u32 m0, s73, 49152
    s_xor_b32 s75, s62, 768
    s_mul_i32 s75, s75, 1376
    buffer_load_dwordx4 v98, s[20:23], s75 offen offset:0 lds
    v_mfma_f32_16x16x32_bf16 v[120:123], v[40:43], v[80:83], v[120:123]
    ds_read_b64_tr_b16 v[64:65], v184 offset:8192
    ds_read_b64_tr_b16 v[66:67], v184 offset:8704
    v_mfma_f32_16x16x32_bf16 v[128:131], v[40:43], v[84:87], v[128:131]
    s_add_u32 m0, s73, 57216
    s_nop 0
    buffer_load_dwordx4 v98, s[20:23], s75 offen offset:128 lds
    v_mfma_f32_16x16x32_bf16 v[136:139], v[44:47], v[80:83], v[136:139]
    ds_read_b64_tr_b16 v[68:69], v184 offset:16384
    ds_read_b64_tr_b16 v[70:71], v184 offset:16896
    v_mfma_f32_16x16x32_bf16 v[144:147], v[44:47], v[84:87], v[144:147]
    s_waitcnt lgkmcnt(11)
    v_mfma_f32_16x16x32_bf16 v[100:103], v[48:51], v[72:75], v[100:103]
    ds_read_b128 v[80:83], v181 offset:0
    ds_read_b64_tr_b16 v[36:37], v182 offset:4096
    s_waitcnt lgkmcnt(8)
    v_mfma_f32_16x16x32_bf16 v[108:111], v[48:51], v[76:79], v[108:111]
    ds_read_b64_tr_b16 v[38:39], v182 offset:4608
    s_add_u32 m0, s73, 65280
    s_nop 0
    buffer_load_dwordx4 v99, s[20:23], s75 offen offset:256 lds
    v_mfma_f32_16x16x32_bf16 v[116:119], v[52:55], v[72:75], v[116:119]
    ds_read_b64_tr_b16 v[40:41], v182 offset:12288
    ds_read_b64_tr_b16 v[42:43], v182 offset:12800
    v_mfma_f32_16x16x32_bf16 v[124:127], v[52:55], v[76:79], v[124:127]
    v_mfma_f32_16x16x32_bf16 v[132:135], v[56:59], v[72:75], v[132:135]
LIFb_3:
    s_cmp_eq_u32 s63, 1
    s_cbranch_scc1 LIFb_ret
    ds_read_b64_tr_b16 v[44:45], v182 offset:20480
    ds_read_b64_tr_b16 v[46:47], v182 offset:20992
    v_mfma_f32_16x16x32_bf16 v[140:143], v[56:59], v[76:79], v[140:143]
    s_and_b32 s76, s93, 15
    s_lshl_b32 s76, s76, 3
    s_add_u32 s76, s76, s64
    v_mov_b32 v30, 0x40000000
    v_lshlrev_b32 v31, 10, v1
    v_cmp_gt_u32 vcc, 11, v1
    s_mul_i32 s77, s76, 11264
    s_nop 0
    v_cndmask_b32 v19, v30, v31, vcc
    v_cmp_gt_u32 vcc, 4, v1
    s_lshl_b32 s76, s76, 12
    s_nop 0
    v_cndmask_b32 v31, v30, v31, vcc
    buffer_load_dword v30, v19, s[28:31], s77 offen offset:384
    buffer_load_dword v31, v31, s[40:43], s76 offen offset:384
    s_waitcnt lgkmcnt(11)
    v_mfma_f32_16x16x32_bf16 v[104:107], v[60:63], v[72:75], v[104:107]
    ds_read_b128 v[84:87], v181 offset:2048
    ds_read_b64_tr_b16 v[48:49], v184 offset:4096
    v_mfma_f32_16x16x32_bf16 v[112:115], v[60:63], v[76:79], v[112:115]
    ds_read_b64_tr_b16 v[50:51], v184 offset:4608
    s_add_u32 m0, s72, 49152
    s_xor_b32 s74, s62, 896
    buffer_load_dwordx4 v96, s[4:7], s74 offen offset:0 lds
    s_waitcnt lgkmcnt(12)
    v_mfma_f32_16x16x32_bf16 v[120:123], v[64:67], v[72:75], v[120:123]
    ds_read_b64_tr_b16 v[52:53], v184 offset:12288
    ds_read_b64_tr_b16 v[54:55], v184 offset:12800
    v_mfma_f32_16x16x32_bf16 v[128:131], v[64:67], v[76:79], v[128:131]
    buffer_load_dwordx4 v97, s[4:7], s74 offen offset:1024 lds
    s_waitcnt lgkmcnt(12)
    v_mfma_f32_16x16x32_bf16 v[136:139], v[68:71], v[72:75], v[136:139]
    ds_read_b64_tr_b16 v[56:57], v184 offset:20480
    ds_read_b64_tr_b16 v[58:59], v184 offset:20992
    v_mfma_f32_16x16x32_bf16 v[144:147], v[68:71], v[76:79], v[144:147]
    s_waitcnt vmcnt(9) lgkmcnt(0)
    s_barrier
    v_mfma_f32_16x16x32_bf16 v[100:103], v[36:39], v[80:83], v[100:103]
    ds_read_b128 v[72:75], v180 offset:16384
    ds_read_b64_tr_b16 v[60:61], v182 offset:24576
    v_mfma_f32_16x16x32_bf16 v[108:111], v[36:39], v[84:87], v[108:111]
    ds_read_b64_tr_b16 v[62:63], v182 offset:25088
    s_add_u32 m0, s73, 73728
    s_xor_b32 s75, s62, 896
    s_mul_i32 s75, s75, 1376
    buffer_load_dwordx4 v98, s[20:23], s75 offen offset:0 lds
    v_mfma_f32_16x16x32_bf16 v[116:119], v[40:43], v[80:83], v[116:119]
    ds_read_b64_tr_b16 v[64:65], v182 offset:32768
    ds_read_b64_tr_b16 v[66:67], v182 offset:33280
    v_mfma_f32_16x16x32_bf16 v[124:127], v[40:43], v[84:87], v[124:127]
    v_mfma_f32_16x16x32_bf16 v[132:135], v[44:47], v[80:83], v[132:135]
    ds_read_b64_tr_b16 v[68:69], v182 offset:40960
    ds_read_b64_tr_b16 v[70:71], v182 offset:41472
    v_mfma_f32_16x16x32_bf16 v[140:143], v[44:47], v[84:87], v[140:143]
    v_mfma_f32_16x16x32_bf16 v[104:107], v[48:51], v[80:83], v[104:107]
    ds_read_b128 v[76:79], v180 offset:18432
    ds_read_b64_tr_b16 v[36:37], v184 offset:24576
    v_mfma_f32_16x16x32_bf16 v[112:115], v[48:51], v[84:87], v[112:115]
    ds_read_b64_tr_b16 v[38:39], v184 offset:25088
    s_add_u32 m0, s73, 81792
    s_nop 0
    buffer_load_dwordx4 v98, s[20:23], s75 offen offset:128 lds
    v_mfma_f32_16x16x32_bf16 v[120:123], v[52:55], v[80:83], v[120:123]
    ds_read_b64_tr_b16 v[40:41], v184 offset:32768
    ds_read_b64_tr_b16 v[42:43], v184 offset:33280
    v_mfma_f32_16x16x32_bf16 v[128:131], v[52:55], v[84:87], v[128:131]
    s_add_u32 m0, s73, 89856
    s_nop 0
    buffer_load_dwordx4 v99, s[20:23], s75 offen offset:256 lds
    v_mfma_f32_16x16x32_bf16 v[136:139], v[56:59], v[80:83], v[136:139]
    ds_read_b64_tr_b16 v[44:45], v184 offset:40960
    ds_read_b64_tr_b16 v[46:47], v184 offset:41472
    v_mfma_f32_16x16x32_bf16 v[144:147], v[56:59], v[84:87], v[144:147]
    s_waitcnt lgkmcnt(11)
    v_mfma_f32_16x16x32_bf16 v[100:103], v[60:63], v[72:75], v[100:103]
    ds_read_b128 v[80:83], v181 offset:16384
    ds_read_b64_tr_b16 v[48:49], v182 offset:28672
    s_waitcnt lgkmcnt(8)
    v_mfma_f32_16x16x32_bf16 v[108:111], v[60:63], v[76:79], v[108:111]
    ds_read_b64_tr_b16 v[50:51], v182 offset:29184
    s_add_u32 m0, s71, 65536
    s_add_u32 s77, s87, 0
    buffer_load_dwordx4 v4, s[28:31], s77 offen lds
    v_mfma_f32_16x16x32_bf16 v[116:119], v[64:67], v[72:75], v[116:119]
    ds_read_b64_tr_b16 v[52:53], v182 offset:36864
    ds_read_b64_tr_b16 v[54:55], v182 offset:37376
    v_mfma_f32_16x16x32_bf16 v[124:127], v[64:67], v[76:79], v[124:127]
    v_mfma_f32_16x16x32_bf16 v[132:135], v[68:71], v[72:75], v[132:135]
    ds_read_b64_tr_b16 v[56:57], v182 offset:45056
    ds_read_b64_tr_b16 v[58:59], v182 offset:45568
    v_mfma_f32_16x16x32_bf16 v[140:143], v[68:71], v[76:79], v[140:143]
    s_waitcnt lgkmcnt(11)
    v_mfma_f32_16x16x32_bf16 v[104:107], v[36:39], v[72:75], v[104:107]
    ds_read_b128 v[84:87], v181 offset:18432
    ds_read_b64_tr_b16 v[60:61], v184 offset:28672
    v_mfma_f32_16x16x32_bf16 v[112:115], v[36:39], v[76:79], v[112:115]
    ds_read_b64_tr_b16 v[62:63], v184 offset:29184
    s_add_u32 m0, s71, 73728
    s_add_u32 s77, s87, 16384
    buffer_load_dwordx4 v4, s[28:31], s77 offen lds
    s_waitcnt lgkmcnt(12)
    v_mfma_f32_16x16x32_bf16 v[120:123], v[40:43], v[72:75], v[120:123]
    ds_read_b64_tr_b16 v[64:65], v184 offset:36864
    ds_read_b64_tr_b16 v[66:67], v184 offset:37376
    v_mfma_f32_16x16x32_bf16 v[128:131], v[40:43], v[76:79], v[128:131]
    s_waitcnt lgkmcnt(12)
    v_mfma_f32_16x16x32_bf16 v[136:139], v[44:47], v[72:75], v[136:139]
    ds_read_b64_tr_b16 v[68:69], v184 offset:45056
    ds_read_b64_tr_b16 v[70:71], v184 offset:45568
    v_mfma_f32_16x16x32_bf16 v[144:147], v[44:47], v[76:79], v[144:147]
    s_waitcnt vmcnt(9) lgkmcnt(0)
    s_barrier
    v_mfma_f32_16x16x32_bf16 v[100:103], v[48:51], v[80:83], v[100:103]
    ds_read_b128 v[72:75], v180 offset:32768
    ds_read_b64_tr_b16 v[36:37], v183 offset:0
    v_mfma_f32_16x16x32_bf16 v[108:111], v[48:51], v[84:87], v[108:111]
    ds_read_b64_tr_b16 v[38:39], v183 offset:512
    s_add_u32 m0, s71, 0
    s_add_u32 s77, s87, 8192
    buffer_load_dwordx4 v4, s[28:31], s77 offen lds
    v_mfma_f32_16x16x32_bf16 v[116:119], v[52:55], v[80:83], v[116:119]
    ds_read_b64_tr_b16 v[40:41], v183 offset:8192
    ds_read_b64_tr_b16 v[42:43], v183 offset:8704
    v_mfma_f32_16x16x32_bf16 v[124:127], v[52:55], v[84:87], v[124:127]
    v_mfma_f32_16x16x32_bf16 v[132:135], v[56:59], v[80:83], v[132:135]
    ds_read_b64_tr_b16 v[44:45], v183 offset:16384
    ds_read_b64_tr_b16 v[46:47], v183 offset:16896
    v_mfma_f32_16x16x32_bf16 v[140:143], v[56:59], v[84:87], v[140:143]
    s_buffer_load_dword s94, s[24:27], 0
    v_mfma_f32_16x16x32_bf16 v[104:107], v[60:63], v[80:83], v[104:107]
    ds_read_b128 v[76:79], v180 offset:34816
    ds_read_b64_tr_b16 v[48:49], v185 offset:0
    v_mfma_f32_16x16x32_bf16 v[112:115], v[60:63], v[84:87], v[112:115]
    ds_read_b64_tr_b16 v[50:51], v185 offset:512
    s_add_u32 m0, s71, 8192
    s_add_u32 s77, s87, 24576
    buffer_load_dwordx4 v4, s[28:31], s77 offen lds
    v_mfma_f32_16x16x32_bf16 v[120:123], v[64:67], v[80:83], v[120:123]
LIFb_4:
    s_cmp_eq_u32 s63, 1
    s_cbranch_scc1 LIFb_ret
    ds_read_b64_tr_b16 v[52:53], v185 offset:8192
    ds_read_b64_tr_b16 v[54:55], v185 offset:8704
    v_mfma_f32_16x16x32_bf16 v[128:131], v[64:67], v[84:87], v[128:131]
    s_add_u32 m0, s71, 81920
    s_add_u32 s77, s87, 65536
    buffer_load_dwordx4 v4, s[28:31], s77 offen lds
    v_mfma_f32_16x16x32_bf16 v[136:139], v[68:71], v[80:83], v[136:139]
    ds_read_b64_tr_b16 v[56:57], v185 offset:16384
    ds_read_b64_tr_b16 v[58:59], v185 offset:16896
    v_mfma_f32_16x16x32_bf16 v[144:147], v[68:71], v[84:87], v[144:147]
    s_waitcnt lgkmcnt(11)
    v_mfma_f32_16x16x32_bf16 v[100:103], v[36:39], v[72:75], v[100:103]
    ds_read_b128 v[80:83], v181 offset:32768
    ds_read_b64_tr_b16 v[60:61], v183 offset:4096
    s_waitcnt lgkmcnt(8)
    v_mfma_f32_16x16x32_bf16 v[108:111], v[36:39], v[76:79], v[108:111]
    ds_read_b64_tr_b16 v[62:63], v183 offset:4608
    s_add_u32 m0, s71, 90112
    s_add_u32 s77, s87, 81920
    buffer_load_dwordx4 v4, s[28:31], s77 offen lds
    v_mfma_f32_16x16x32_bf16 v[116:119], v[40:43], v[72:75], v[116:119]
    ds_read_b64_tr_b16 v[64:65], v183 offset:12288
    ds_read_b64_tr_b16 v[66:67], v183 offset:12800
    v_mfma_f32_16x16x32_bf16 v[124:127], v[40:43], v[76:79], v[124:127]
    v_mfma_f32_16x16x32_bf16 v[132:135], v[44:47], v[72:75], v[132:135]
    ds_read_b64_tr_b16 v[68:69], v183 offset:20480
    ds_read_b64_tr_b16 v[70:71], v183 offset:20992
    v_mfma_f32_16x16x32_bf16 v[140:143], v[44:47], v[76:79], v[140:143]
    s_waitcnt lgkmcnt(11)
    v_mfma_f32_16x16x32_bf16 v[104:107], v[48:51], v[72:75], v[104:107]
    ds_read_b128 v[84:87], v181 offset:34816
    ds_read_b64_tr_b16 v[36:37], v185 offset:4096
    v_mfma_f32_16x16x32_bf16 v[112:115], v[48:51], v[76:79], v[112:115]
    ds_read_b64_tr_b16 v[38:39], v185 offset:4608
    s_add_u32 m0, s71, 98304
    s_add_u32 s77, s87, 73728
    buffer_load_dwordx4 v4, s[28:31], s77 offen lds
    s_waitcnt lgkmcnt(12)
    v_mfma_f32_16x16x32_bf16 v[120:123], v[52:55], v[72:75], v[120:123]
    ds_read_b64_tr_b16 v[40:41], v185 offset:12288
    ds_read_b64_tr_b16 v[42:43], v185 offset:12800
    v_mfma_f32_16x16x32_bf16 v[128:131], v[52:55], v[76:79], v[128:131]
    s_waitcnt lgkmcnt(12)
    v_mfma_f32_16x16x32_bf16 v[136:139], v[56:59], v[72:75], v[136:139]
    ds_read_b64_tr_b16 v[44:45], v185 offset:20480
    ds_read_b64_tr_b16 v[46:47], v185 offset:20992
    v_mfma_f32_16x16x32_bf16 v[144:147], v[56:59], v[76:79], v[144:147]
    s_waitcnt lgkmcnt(0)
    s_cmp_lg_u32 s94, 0
    s_cbranch_scc0 Lretry_84i
Lok_83:
    s_mov_b32 s95, s94
    v_mov_b32 v17, s94
    s_waitcnt vmcnt(7)
    s_barrier
    v_mfma_f32_16x16x32_bf16 v[100:103], v[60:63], v[80:83], v[100:103]
    ds_read_b128 v[72:75], v180 offset:49152
    ds_read_b64_tr_b16 v[48:49], v183 offset:24576
    v_mfma_f32_16x16x32_bf16 v[108:111], v[60:63], v[84:87], v[108:111]
    ds_read_b64_tr_b16 v[50:51], v183 offset:25088
    s_add_u32 m0, s71, 16384
    s_add_u32 s77, s87, 90112
    buffer_load_dwordx4 v4, s[28:31], s77 offen lds
    v_mfma_f32_16x16x32_bf16 v[116:119], v[64:67], v[80:83], v[116:119]
    ds_read_b64_tr_b16 v[52:53], v183 offset:32768
    ds_read_b64_tr_b16 v[54:55], v183 offset:33280
    v_mfma_f32_16x16x32_bf16 v[124:127], v[64:67], v[84:87], v[124:127]
    v_mfma_f32_16x16x32_bf16 v[132:135], v[68:71], v[80:83], v[132:135]
    ds_read_b64_tr_b16 v[56:57], v183 offset:40960
    ds_read_b64_tr_b16 v[58:59], v183 offset:41472
    v_mfma_f32_16x16x32_bf16 v[140:143], v[68:71], v[84:87], v[140:143]
    v_mfma_f32_16x16x32_bf16 v[104:107], v[36:39], v[80:83], v[104:107]
    ds_read_b128 v[76:79], v180 offset:51200
    ds_read_b64_tr_b16 v[60:61], v185 offset:24576
    v_mfma_f32_16x16x32_bf16 v[112:115], v[36:39], v[84:87], v[112:115]
    ds_read_b64_tr_b16 v[62:63], v185 offset:25088
    s_add_u32 m0, s71, 24576
    s_add_u32 s77, s87, 131072
    buffer_load_dwordx4 v4, s[28:31], s77 offen lds
    v_mfma_f32_16x16x32_bf16 v[120:123], v[40:43], v[80:83], v[120:123]
    ds_read_b64_tr_b16 v[64:65], v185 offset:32768
    ds_read_b64_tr_b16 v[66:67], v185 offset:33280
    v_mfma_f32_16x16x32_bf16 v[128:131], v[40:43], v[84:87], v[128:131]
    s_add_u32 m0, s71, 106496
    s_add_u32 s77, s87, 147456
    buffer_load_dwordx4 v4, s[28:31], s77 offen lds
    v_mfma_f32_16x16x32_bf16 v[136:139], v[44:47], v[80:83], v[136:139]
    ds_read_b64_tr_b16 v[68:69], v185 offset:40960
    ds_read_b64_tr_b16 v[70:71], v185 offset:41472
    v_mfma_f32_16x16x32_bf16 v[144:147], v[44:47], v[84:87], v[144:147]
    s_waitcnt lgkmcnt(11)
    v_mfma_f32_16x16x32_bf16 v[100:103], v[48:51], v[72:75], v[100:103]
    ds_read_b128 v[80:83], v181 offset:49152
    ds_read_b64_tr_b16 v[36:37], v183 offset:28672
    s_waitcnt lgkmcnt(8)
    v_mfma_f32_16x16x32_bf16 v[108:111], v[48:51], v[76:79], v[108:111]
    ds_read_b64_tr_b16 v[38:39], v183 offset:29184
    s_add_u32 m0, s71, 114688
    s_add_u32 s77, s87, 139264
    buffer_load_dwordx4 v4, s[28:31], s77 offen lds
    v_mfma_f32_16x16x32_bf16 v[116:119], v[52:55], v[72:75], v[116:119]
    ds_read_b64_tr_b16 v[40:41], v183 offset:36864
    ds_read_b64_tr_b16 v[42:43], v183 offset:37376
    v_mfma_f32_16x16x32_bf16 v[124:127], v[52:55], v[76:79], v[124:127]
    v_mfma_f32_16x16x32_bf16 v[132:135], v[56:59], v[72:75], v[132:135]
    ds_read_b64_tr_b16 v[44:45], v183 offset:45056
    ds_read_b64_tr_b16 v[46:47], v183 offset:45568
    v_mfma_f32_16x16x32_bf16 v[140:143], v[56:59], v[76:79], v[140:143]
    s_waitcnt lgkmcnt(11)
    v_mfma_f32_16x16x32_bf16 v[104:107], v[60:63], v[72:75], v[104:107]
    ds_read_b128 v[84:87], v181 offset:51200
    ds_read_b64_tr_b16 v[48:49], v185 offset:28672
    v_mfma_f32_16x16x32_bf16 v[112:115], v[60:63], v[76:79], v[112:115]
    ds_read_b64_tr_b16 v[50:51], v185 offset:29184
    s_add_u32 m0, s71, 122880
    s_add_u32 s77, s87, 155648
    buffer_load_dwordx4 v4, s[28:31], s77 offen lds
    s_waitcnt lgkmcnt(12)
    v_mfma_f32_16x16x32_bf16 v[120:123], v[64:67], v[72:75], v[120:123]
    ds_read_b64_tr_b16 v[52:53], v185 offset:36864
    ds_read_b64_tr_b16 v[54:55], v185 offset:37376
    v_mfma_f32_16x16x32_bf16 v[128:131], v[64:67], v[76:79], v[128:131]
    s_waitcnt lgkmcnt(12)
    v_mfma_f32_16x16x32_bf16 v[136:139], v[68:71], v[72:75], v[136:139]
    ds_read_b64_tr_b16 v[56:57], v185 offset:45056
    ds_read_b64_tr_b16 v[58:59], v185 offset:45568
    v_mfma_f32_16x16x32_bf16 v[144:147], v[68:71], v[76:79], v[144:147]
    s_waitcnt lgkmcnt(11)
    v_mfma_f32_16x16x32_bf16 v[100:103], v[36:39], v[80:83], v[100:103]
    s_waitcnt lgkmcnt(6)
    v_mfma_f32_16x16x32_bf16 v[108:111], v[36:39], v[84:87], v[108:111]
    s_add_u32 m0, s71, 32768
    s_add_u32 s77, s87, 32768
    buffer_load_dwordx4 v4, s[28:31], s77 offen lds
    v_mfma_f32_16x16x32_bf16 v[116:119], v[40:43], v[80:83], v[116:119]
    v_mfma_f32_16x16x32_bf16 v[124:127], v[40:43], v[84:87], v[124:127]
    v_mfma_f32_16x16x32_bf16 v[132:135], v[44:47], v[80:83], v[132:135]
    v_mfma_f32_16x16x32_bf16 v[140:143], v[44:47], v[84:87], v[140:143]
LIFb_5:
    s_cmp_eq_u32 s63, 1
    s_cbranch_scc1 LIFb_ret
    s_waitcnt lgkmcnt(4)
    v_mfma_f32_16x16x32_bf16 v[104:107], v[48:51], v[80:83], v[104:107]
    v_mfma_f32_16x16x32_bf16 v[112:115], v[48:51], v[84:87], v[112:115]
    s_add_u32 m0, s71, 40960
    s_add_u32 s77, s87, 49152
    buffer_load_dwordx4 v4, s[28:31], s77 offen lds
    s_waitcnt lgkmcnt(2)
    v_mfma_f32_16x16x32_bf16 v[120:123], v[52:55], v[80:83], v[120:123]
    v_mfma_f32_16x16x32_bf16 v[128:131], v[52:55], v[84:87], v[128:131]
    s_add_u32 m0, s71, 131072
    s_add_u32 s77, s87, 40960
    buffer_load_dwordx4 v4, s[28:31], s77 offen lds
    s_waitcnt lgkmcnt(0)
    v_mfma_f32_16x16x32_bf16 v[136:139], v[56:59], v[80:83], v[136:139]
    v_mfma_f32_16x16x32_bf16 v[144:147], v[56:59], v[84:87], v[144:147]
LDFb:
    s_setprio 3
    s_mov_b32 s63, 2
    s_cmp_eq_u32 s64, 4
    s_cbranch_scc1 LJFb_0
    s_cmp_eq_u32 s64, 5
    s_cbranch_scc1 LJFb_1
    s_cmp_eq_u32 s64, 6
    s_cbranch_scc1 LJFb_2
    s_cmp_eq_u32 s64, 7
    s_cbranch_scc1 LJFb_3
LJFb_4:
LJFb_5:
LJFb_6:
LJFb_7:
LJFb_ret:
    s_mov_b32 s63, 0
    s_setprio 1
    v_pk_mul_f32 v[148:149], v[100:101], v[100:101]
    v_pk_mul_f32 v[150:151], v[102:103], v[102:103]
    v_pk_mul_f32 v[152:153], v[104:105], v[104:105]
    v_pk_mul_f32 v[154:155], v[106:107], v[106:107]
    v_pk_fma_f32 v[148:149], v[148:149], s[82:83], v[186:187]
    v_pk_fma_f32 v[150:151], v[150:151], s[82:83], v[186:187]
    v_pk_fma_f32 v[152:153], v[152:153], s[82:83], v[186:187]
    v_pk_fma_f32 v[154:155], v[154:155], s[82:83], v[186:187]
    v_pk_mul_f32 v[148:149], v[148:149], v[100:101]
    v_pk_mul_f32 v[150:151], v[150:151], v[102:103]
    v_pk_mul_f32 v[152:153], v[152:153], v[104:105]
    v_pk_mul_f32 v[154:155], v[154:155], v[106:107]
    v_exp_f32 v148, v148
    v_exp_f32 v149, v149
    v_exp_f32 v150, v150
    v_exp_f32 v151, v151
    v_exp_f32 v152, v152
    v_exp_f32 v153, v153
    v_exp_f32 v154, v154
    v_exp_f32 v155, v155
    v_pk_add_f32 v[148:149], v[148:149], s[84:85]
    v_pk_add_f32 v[150:151], v[150:151], s[84:85]
    v_pk_add_f32 v[152:153], v[152:153], s[84:85]
    v_pk_add_f32 v[154:155], v[154:155], s[84:85]
    v_rcp_f32 v148, v148
    v_rcp_f32 v149, v149
    v_rcp_f32 v150, v150
    v_rcp_f32 v151, v151
    v_rcp_f32 v152, v152
    v_rcp_f32 v153, v153
    s_waitcnt vmcnt(13)
    ds_read_b64_tr_b16 v[196:197], v7 offset:0
    ds_read_b64_tr_b16 v[198:199], v7 offset:8192
    ds_read_b64_tr_b16 v[200:201], v8 offset:0
    ds_read_b64_tr_b16 v[202:203], v8 offset:8192
    v_rcp_f32 v154, v154
    v_rcp_f32 v155, v155
    v_pk_mul_f32 v[148:149], v[148:149], v[100:101]
    v_pk_mul_f32 v[150:151], v[150:151], v[102:103]
    v_pk_mul_f32 v[152:153], v[152:153], v[104:105]
    v_pk_mul_f32 v[154:155], v[154:155], v[106:107]
    v_cvt_pk_bf16_f32 v156, v148, v149
    v_cvt_pk_bf16_f32 v157, v150, v151
    v_cvt_pk_bf16_f32 v158, v152, v153
    v_cvt_pk_bf16_f32 v159, v154, v155
    v_pk_mul_f32 v[164:165], v[108:109], v[108:109]
    v_pk_mul_f32 v[166:167], v[110:111], v[110:111]
    s_add_u32 s76, s86, 131072
    buffer_store_dwordx4 v[156:159], v28, s[36:39], s76 offen offset:0 sc1
    v_pk_mul_f32 v[168:169], v[112:113], v[112:113]
    v_pk_mul_f32 v[170:171], v[114:115], v[114:115]
    v_pk_fma_f32 v[164:165], v[164:165], s[82:83], v[186:187]
    v_pk_fma_f32 v[166:167], v[166:167], s[82:83], v[186:187]
    v_pk_fma_f32 v[168:169], v[168:169], s[82:83], v[186:187]
    v_pk_fma_f32 v[170:171], v[170:171], s[82:83], v[186:187]
    v_pk_mul_f32 v[164:165], v[164:165], v[108:109]
    v_pk_mul_f32 v[166:167], v[166:167], v[110:111]
    v_pk_mul_f32 v[168:169], v[168:169], v[112:113]
    v_pk_mul_f32 v[170:171], v[170:171], v[114:115]
    v_exp_f32 v164, v164
    v_exp_f32 v165, v165
    v_exp_f32 v166, v166
    v_exp_f32 v167, v167
    v_exp_f32 v168, v168
    v_exp_f32 v169, v169
    v_exp_f32 v170, v170
    s_waitcnt lgkmcnt(0)
    s_add_u32 m0, s71, 65536
    s_add_u32 s77, s87, 57344
    buffer_load_dwordx4 v4, s[28:31], s77 offen lds
    s_waitcnt vmcnt(13)
    ds_read_b64_tr_b16 v[204:205], v5 offset:0
    ds_read_b64_tr_b16 v[206:207], v5 offset:8192
    ds_read_b64_tr_b16 v[208:209], v6 offset:0
    ds_read_b64_tr_b16 v[210:211], v6 offset:8192
    v_exp_f32 v171, v171
    v_pk_add_f32 v[164:165], v[164:165], s[84:85]
    v_pk_add_f32 v[166:167], v[166:167], s[84:85]
    v_pk_add_f32 v[168:169], v[168:169], s[84:85]
    v_pk_add_f32 v[170:171], v[170:171], s[84:85]
    v_rcp_f32 v164, v164
    v_rcp_f32 v165, v165
    v_rcp_f32 v166, v166
    v_rcp_f32 v167, v167
    v_rcp_f32 v168, v168
    v_rcp_f32 v169, v169
    v_rcp_f32 v170, v170
    v_rcp_f32 v171, v171
    v_pk_mul_f32 v[164:165], v[164:165], v[108:109]
    v_pk_mul_f32 v[166:167], v[166:167], v[110:111]
    v_pk_mul_f32 v[168:169], v[168:169], v[112:113]
    v_pk_mul_f32 v[170:171], v[170:171], v[114:115]
    v_cvt_pk_bf16_f32 v160, v164, v165
    v_cvt_pk_bf16_f32 v161, v166, v167
    v_cvt_pk_bf16_f32 v162, v168, v169
    v_cvt_pk_bf16_f32 v163, v170, v171
    s_add_u32 s76, s86, 131072
    buffer_store_dwordx4 v[160:163], v28, s[36:39], s76 offen offset:256 sc1
    v_pk_mul_f32 v[148:149], v[116:117], v[116:117]
    v_pk_mul_f32 v[150:151], v[118:119], v[118:119]
    v_pk_mul_f32 v[152:153], v[120:121], v[120:121]
    v_pk_mul_f32 v[154:155], v[122:123], v[122:123]
    v_pk_fma_f32 v[148:149], v[148:149], s[82:83], v[186:187]
    v_pk_fma_f32 v[150:151], v[150:151], s[82:83], v[186:187]
    v_pk_fma_f32 v[152:153], v[152:153], s[82:83], v[186:187]
    v_pk_fma_f32 v[154:155], v[154:155], s[82:83], v[186:187]
    v_pk_mul_f32 v[148:149], v[148:149], v[116:117]
    v_pk_mul_f32 v[150:151], v[150:151], v[118:119]
    v_pk_mul_f32 v[152:153], v[152:153], v[120:121]
    v_pk_mul_f32 v[154:155], v[154:155], v[122:123]
    v_exp_f32 v148, v148
    v_exp_f32 v149, v149
    v_exp_f32 v150, v150
    v_exp_f32 v151, v151
    v_exp_f32 v152, v152
    v_exp_f32 v153, v153
    v_exp_f32 v154, v154
    v_exp_f32 v155, v155
    v_pk_add_f32 v[148:149], v[148:149], s[84:85]
    v_pk_add_f32 v[150:151], v[150:151], s[84:85]
    v_pk_add_f32 v[152:153], v[152:153], s[84:85]
    v_pk_add_f32 v[154:155], v[154:155], s[84:85]
    v_rcp_f32 v148, v148
    v_rcp_f32 v149, v149
    v_rcp_f32 v150, v150
    v_rcp_f32 v151, v151
    v_rcp_f32 v152, v152
    v_rcp_f32 v153, v153
    s_add_u32 m0, s71, 73728
    s_add_u32 s77, s87, 98304
    buffer_load_dwordx4 v4, s[28:31], s77 offen lds
    v_rcp_f32 v154, v154
LIFb_6:
    s_cmp_eq_u32 s63, 1
    s_cbranch_scc1 LIFb_ret
LJFb_0:
    s_cmp_eq_u32 s63, 2
    s_cbranch_scc1 LJFb_4
    v_rcp_f32 v155, v155
    v_pk_mul_f32 v[148:149], v[148:149], v[116:117]
    v_pk_mul_f32 v[150:151], v[150:151], v[118:119]
    v_pk_mul_f32 v[152:153], v[152:153], v[120:121]
    v_pk_mul_f32 v[154:155], v[154:155], v[122:123]
    v_cvt_pk_bf16_f32 v172, v148, v149
    v_cvt_pk_bf16_f32 v173, v150, v151
    v_cvt_pk_bf16_f32 v174, v152, v153
    v_cvt_pk_bf16_f32 v175, v154, v155
    v_pk_mul_f32 v[164:165], v[124:125], v[124:125]
    v_pk_mul_f32 v[166:167], v[126:127], v[126:127]
    s_add_u32 s76, s86, 393216
    buffer_store_dwordx4 v[172:175], v28, s[36:39], s76 offen offset:0 sc1
    v_pk_mul_f32 v[168:169], v[128:129], v[128:129]
    v_pk_mul_f32 v[170:171], v[130:131], v[130:131]
    v_pk_fma_f32 v[164:165], v[164:165], s[82:83], v[186:187]
    v_pk_fma_f32 v[166:167], v[166:167], s[82:83], v[186:187]
    v_pk_fma_f32 v[168:169], v[168:169], s[82:83], v[186:187]
    v_pk_fma_f32 v[170:171], v[170:171], s[82:83], v[186:187]
    v_pk_mul_f32 v[164:165], v[164:165], v[124:125]
    v_pk_mul_f32 v[166:167], v[166:167], v[126:127]
    v_pk_mul_f32 v[168:169], v[168:169], v[128:129]
    v_pk_mul_f32 v[170:171], v[170:171], v[130:131]
    v_exp_f32 v164, v164
    v_exp_f32 v165, v165
    v_exp_f32 v166, v166
    v_exp_f32 v167, v167
    v_exp_f32 v168, v168
    v_exp_f32 v169, v169
    v_exp_f32 v170, v170
    s_waitcnt lgkmcnt(0)
    s_add_u32 m0, s71, 0
    s_add_u32 s77, s87, 114688
    buffer_load_dwordx4 v4, s[28:31], s77 offen lds
    s_waitcnt vmcnt(15)
    ds_read_b64_tr_b16 v[212:213], v7 offset:16384
    ds_read_b64_tr_b16 v[214:215], v7 offset:24576
    ds_read_b64_tr_b16 v[216:217], v8 offset:16384
    ds_read_b64_tr_b16 v[218:219], v8 offset:24576
    v_exp_f32 v171, v171
    v_pk_add_f32 v[164:165], v[164:165], s[84:85]
    v_pk_add_f32 v[166:167], v[166:167], s[84:85]
    v_pk_add_f32 v[168:169], v[168:169], s[84:85]
    v_pk_add_f32 v[170:171], v[170:171], s[84:85]
    v_rcp_f32 v164, v164
    v_rcp_f32 v165, v165
    v_rcp_f32 v166, v166
    v_rcp_f32 v167, v167
    v_rcp_f32 v168, v168
    v_rcp_f32 v169, v169
    v_rcp_f32 v170, v170
    v_rcp_f32 v171, v171
    v_pk_mul_f32 v[164:165], v[164:165], v[124:125]
    v_pk_mul_f32 v[166:167], v[166:167], v[126:127]
    v_pk_mul_f32 v[168:169], v[168:169], v[128:129]
    v_pk_mul_f32 v[170:171], v[170:171], v[130:131]
    v_cvt_pk_bf16_f32 v176, v164, v165
    v_cvt_pk_bf16_f32 v177, v166, v167
    v_cvt_pk_bf16_f32 v178, v168, v169
    v_cvt_pk_bf16_f32 v179, v170, v171
    s_add_u32 s76, s86, 393216
    buffer_store_dwordx4 v[176:179], v28, s[36:39], s76 offen offset:256 sc1
    s_waitcnt vmcnt(4)
    buffer_store_dword v17, v13, s[36:39], 0 offen offset:8 sc1
    v_pk_mul_f32 v[148:149], v[132:133], v[132:133]
    v_pk_mul_f32 v[150:151], v[134:135], v[134:135]
    v_pk_mul_f32 v[152:153], v[136:137], v[136:137]
    v_pk_mul_f32 v[154:155], v[138:139], v[138:139]
    v_pk_fma_f32 v[148:149], v[148:149], s[82:83], v[186:187]
    v_pk_fma_f32 v[150:151], v[150:151], s[82:83], v[186:187]
    v_pk_fma_f32 v[152:153], v[152:153], s[82:83], v[186:187]
    v_pk_fma_f32 v[154:155], v[154:155], s[82:83], v[186:187]
    v_pk_mul_f32 v[148:149], v[148:149], v[132:133]
    v_pk_mul_f32 v[150:151], v[150:151], v[134:135]
    v_pk_mul_f32 v[152:153], v[152:153], v[136:137]
    v_pk_mul_f32 v[154:155], v[154:155], v[138:139]
    v_exp_f32 v148, v148
    v_exp_f32 v149, v149
    v_exp_f32 v150, v150
    v_exp_f32 v151, v151
    v_exp_f32 v152, v152
    v_exp_f32 v153, v153
    v_exp_f32 v154, v154
    v_exp_f32 v155, v155
    v_pk_add_f32 v[148:149], v[148:149], s[84:85]
    v_pk_add_f32 v[150:151], v[150:151], s[84:85]
    v_pk_add_f32 v[152:153], v[152:153], s[84:85]
    v_pk_add_f32 v[154:155], v[154:155], s[84:85]
    v_rcp_f32 v148, v148
    v_rcp_f32 v149, v149
    v_rcp_f32 v150, v150
    v_rcp_f32 v151, v151
    v_rcp_f32 v152, v152
    s_add_u32 m0, s71, 8192
    s_add_u32 s77, s87, 106496
    buffer_load_dwordx4 v4, s[28:31], s77 offen lds
    v_rcp_f32 v153, v153
    v_rcp_f32 v154, v154
    v_rcp_f32 v155, v155
    v_pk_mul_f32 v[148:149], v[148:149], v[132:133]
    v_pk_mul_f32 v[150:151], v[150:151], v[134:135]
    v_pk_mul_f32 v[152:153], v[152:153], v[136:137]
    v_pk_mul_f32 v[154:155], v[154:155], v[138:139]
    v_cvt_pk_bf16_f32 v156, v148, v149
    v_cvt_pk_bf16_f32 v157, v150, v151
    v_cvt_pk_bf16_f32 v158, v152, v153
    v_cvt_pk_bf16_f32 v159, v154, v155
    v_pk_mul_f32 v[164:165], v[140:141], v[140:141]
    v_pk_mul_f32 v[166:167], v[142:143], v[142:143]
    s_add_u32 s76, s86, 655360
    buffer_store_dwordx4 v[156:159], v28, s[36:39], s76 offen offset:0 sc1
    v_pk_mul_f32 v[168:169], v[144:145], v[144:145]
    v_pk_mul_f32 v[170:171], v[146:147], v[146:147]
    v_pk_fma_f32 v[164:165], v[164:165], s[82:83], v[186:187]
    v_pk_fma_f32 v[166:167], v[166:167], s[82:83], v[186:187]
    v_pk_fma_f32 v[168:169], v[168:169], s[82:83], v[186:187]
    v_pk_fma_f32 v[170:171], v[170:171], s[82:83], v[186:187]
    v_pk_mul_f32 v[164:165], v[164:165], v[140:141]
    v_pk_mul_f32 v[166:167], v[166:167], v[142:143]
    v_pk_mul_f32 v[168:169], v[168:169], v[144:145]
    v_pk_mul_f32 v[170:171], v[170:171], v[146:147]
    v_exp_f32 v164, v164
    v_exp_f32 v165, v165
    v_exp_f32 v166, v166
    v_exp_f32 v167, v167
    v_exp_f32 v168, v168
    v_exp_f32 v169, v169
    s_waitcnt lgkmcnt(0)
    s_add_u32 m0, s71, 81920
    s_add_u32 s77, s87, 122880
    buffer_load_dwordx4 v4, s[28:31], s77 offen lds
    ds_read_b64_tr_b16 v[220:221], v7 offset:32768
    ds_read_b64_tr_b16 v[222:223], v5 offset:16384
    ds_read_b64_tr_b16 v[224:225], v8 offset:32768
    ds_read_b64_tr_b16 v[226:227], v6 offset:16384
    v_exp_f32 v170, v170
    v_exp_f32 v171, v171
    v_pk_add_f32 v[164:165], v[164:165], s[84:85]
    v_pk_add_f32 v[166:167], v[166:167], s[84:85]
    v_pk_add_f32 v[168:169], v[168:169], s[84:85]
    v_pk_add_f32 v[170:171], v[170:171], s[84:85]
    v_rcp_f32 v164, v164
    v_rcp_f32 v165, v165
    v_rcp_f32 v166, v166
    v_rcp_f32 v167, v167
    v_rcp_f32 v168, v168
    v_rcp_f32 v169, v169
    v_rcp_f32 v170, v170
    v_rcp_f32 v171, v171
    v_pk_mul_f32 v[164:165], v[164:165], v[140:141]
    v_pk_mul_f32 v[166:167], v[166:167], v[142:143]
    v_pk_mul_f32 v[168:169], v[168:169], v[144:145]
    v_pk_mul_f32 v[170:171], v[170:171], v[146:147]
LIFb_7:
    s_cmp_eq_u32 s63, 1
    s_cbranch_scc1 LIFb_ret
LJFb_1:
    s_cmp_eq_u32 s63, 2
    s_cbranch_scc1 LJFb_5
    v_cvt_pk_bf16_f32 v160, v164, v165
    v_cvt_pk_bf16_f32 v161, v166, v167
    v_cvt_pk_bf16_f32 v162, v168, v169
    v_cvt_pk_bf16_f32 v163, v170, v171
    s_add_u32 s76, s86, 655360
    buffer_store_dwordx4 v[160:163], v28, s[36:39], s76 offen offset:256 sc1
    s_add_u32 m0, s71, 90112
    s_add_u32 s77, s88, 0
    buffer_load_dwordx4 v4, s[40:43], s77 offen lds
    s_buffer_load_dwordx16 s[4:19], s[36:39], s96 offset:16384 glc
    s_barrier
    s_waitcnt vmcnt(6)
    buffer_store_dword v17, v13, s[36:39], 0 offen offset:24 sc1
    s_waitcnt lgkmcnt(0)
    s_cmp_eq_u64 s[4:5], s[94:95]
    s_cselect_b32 s79, 0, 0x40000000
    s_or_b32 s75, s89, s79
    buffer_load_dwordx4 v[100:103], v11, s[36:39], s75 offen offset:0 sc1
    buffer_load_dwordx4 v[104:107], v12, s[36:39], s75 offen offset:0 sc1
    buffer_load_dwordx4 v[108:111], v11, s[36:39], s75 offen offset:1024 sc1
    buffer_load_dwordx4 v[112:115], v12, s[36:39], s75 offen offset:1024 sc1
    s_cmp_eq_u64 s[8:9], s[94:95]
    s_cselect_b32 s80, 0, 0x40000000
    s_add_u32 s75, s89, 262144
    s_or_b32 s75, s75, s80
    buffer_load_dwordx4 v[116:119], v11, s[36:39], s75 offen offset:0 sc1
    buffer_load_dwordx4 v[120:123], v12, s[36:39], s75 offen offset:0 sc1
    buffer_load_dwordx4 v[124:127], v11, s[36:39], s75 offen offset:1024 sc1
    buffer_load_dwordx4 v[128:131], v12, s[36:39], s75 offen offset:1024 sc1
    s_cmp_eq_u64 s[12:13], s[94:95]
    s_cselect_b32 s81, 0, 0x40000000
    s_add_u32 s75, s89, 524288
    s_or_b32 s75, s75, s81
    buffer_load_dwordx4 v[132:135], v11, s[36:39], s75 offen offset:0 sc1
    buffer_load_dwordx4 v[136:139], v12, s[36:39], s75 offen offset:0 sc1
    buffer_load_dwordx4 v[140:143], v11, s[36:39], s75 offen offset:1024 sc1
    buffer_load_dwordx4 v[144:147], v12, s[36:39], s75 offen offset:1024 sc1
    s_buffer_load_dwordx16 s[4:19], s[36:39], s96 offset:16384 glc
    s_waitcnt vmcnt(14)
    buffer_store_dword v17, v13, s[36:39], 0 offen offset:40 sc1
    s_cmp_eq_u32 s79, 0
    s_cbranch_scc0 Lcfix_86i
Lcok_85:
    s_cmp_eq_u32 s80, 0
    s_cbranch_scc0 Lcfix_88i
Lcok_87:
    s_add_u32 m0, s71, 98304
    s_add_u32 s77, s88, 16384
    buffer_load_dwordx4 v4, s[40:43], s77 offen lds
    s_add_u32 m0, s71, 16384
    s_add_u32 s77, s88, 8192
    buffer_load_dwordx4 v4, s[40:43], s77 offen lds
    s_add_u32 m0, s71, 139264
    s_add_u32 s77, s88, 24576
    buffer_load_dwordx4 v4, s[40:43], s77 offen lds
    s_add_u32 m0, s71, 147456
    s_add_u32 s77, s88, 32768
    buffer_load_dwordx4 v4, s[40:43], s77 offen lds
    s_add_u32 m0, s71, 49152
    s_add_u32 s77, s88, 49152
    buffer_load_dwordx4 v4, s[40:43], s77 offen lds
    s_add_u32 m0, s71, 57344
    s_add_u32 s77, s88, 40960
    buffer_load_dwordx4 v4, s[40:43], s77 offen lds
    s_add_u32 m0, s71, 155648
    s_add_u32 s77, s88, 57344
    buffer_load_dwordx4 v4, s[40:43], s77 offen lds
    s_setprio 0
    s_waitcnt vmcnt(7)
    v_mfma_f32_32x32x16_bf16 v[36:51], v[196:199], v[100:103], 0
    v_mfma_f32_32x32x16_bf16 v[52:67], v[200:203], v[100:103], 0
    v_mfma_f32_32x32x16_bf16 v[68:83], v[196:199], v[104:107], 0
    v_mfma_f32_32x32x16_bf16 v[84:99], v[200:203], v[104:107], 0
    v_mfma_f32_32x32x16_bf16 v[36:51], v[204:207], v[108:111], v[36:51]
    v_mfma_f32_32x32x16_bf16 v[52:67], v[208:211], v[108:111], v[52:67]
    v_mfma_f32_32x32x16_bf16 v[68:83], v[204:207], v[112:115], v[68:83]
    v_mfma_f32_32x32x16_bf16 v[84:99], v[208:211], v[112:115], v[84:99]
    s_cmp_eq_u32 s81, 0
    s_cbranch_scc0 Lcfix_90i
Lcok_89:
    s_cmp_eq_u64 s[6:7], s[94:95]
    s_cselect_b32 s73, 0, 0x40000000
    s_add_u32 s75, s89, 131072
    s_or_b32 s75, s75, s73
    buffer_load_dwordx4 v[148:151], v11, s[36:39], s75 offen offset:0 sc1
    buffer_load_dwordx4 v[152:155], v12, s[36:39], s75 offen offset:0 sc1
    buffer_load_dwordx4 v[156:159], v11, s[36:39], s75 offen offset:1024 sc1
    buffer_load_dwordx4 v[160:163], v12, s[36:39], s75 offen offset:1024 sc1
    s_buffer_load_dwordx16 s[4:19], s[36:39], s96 offset:16384 glc
    ds_read_b64_tr_b16 v[228:229], v5 offset:24576
    ds_read_b64_tr_b16 v[230:231], v7 offset:40960
    ds_read_b64_tr_b16 v[232:233], v6 offset:24576
    ds_read_b64_tr_b16 v[234:235], v8 offset:40960
    v_mfma_f32_32x32x16_bf16 v[36:51], v[212:215], v[116:119], v[36:51]
    v_mfma_f32_32x32x16_bf16 v[52:67], v[216:219], v[116:119], v[52:67]
    v_mfma_f32_32x32x16_bf16 v[68:83], v[212:215], v[120:123], v[68:83]
    v_mfma_f32_32x32x16_bf16 v[84:99], v[216:219], v[120:123], v[84:99]
    ds_read_b64_tr_b16 v[236:237], v7 offset:49152
    ds_read_b64_tr_b16 v[238:239], v7 offset:57344
    ds_read_b64_tr_b16 v[240:241], v8 offset:49152
    ds_read_b64_tr_b16 v[242:243], v8 offset:57344
    v_mfma_f32_32x32x16_bf16 v[36:51], v[220:223], v[124:127], v[36:51]
    v_mfma_f32_32x32x16_bf16 v[52:67], v[224:227], v[124:127], v[52:67]
    v_mfma_f32_32x32x16_bf16 v[68:83], v[220:223], v[128:131], v[68:83]
    v_mfma_f32_32x32x16_bf16 v[84:99], v[224:227], v[128:131], v[84:99]
    s_cmp_eq_u32 s73, 0
    s_cbranch_scc0 Lcfix_92i
Lcok_91:
    s_cmp_eq_u64 s[10:11], s[94:95]
    s_cselect_b32 s79, 0, 0x40000000
    s_add_u32 s75, s89, 393216
    s_or_b32 s75, s75, s79
    buffer_load_dwordx4 v[164:167], v11, s[36:39], s75 offen offset:0 sc1
    buffer_load_dwordx4 v[168:171], v12, s[36:39], s75 offen offset:0 sc1
    buffer_load_dwordx4 v[172:175], v11, s[36:39], s75 offen offset:1024 sc1
    buffer_load_dwordx4 v[176:179], v12, s[36:39], s75 offen offset:1024 sc1
    s_buffer_load_dwordx16 s[4:19], s[36:39], s96 offset:16384 glc
    ds_read_b64_tr_b16 v[244:245], v5 offset:32768
    ds_read_b64_tr_b16 v[246:247], v5 offset:40960
    ds_read_b64_tr_b16 v[248:249], v6 offset:32768
    ds_read_b64_tr_b16 v[250:251], v6 offset:40960
    s_waitcnt vmcnt(8) lgkmcnt(10)
    v_mfma_f32_32x32x16_bf16 v[36:51], v[228:231], v[132:135], v[36:51]
    s_waitcnt lgkmcnt(8)
    v_mfma_f32_32x32x16_bf16 v[52:67], v[232:235], v[132:135], v[52:67]
    v_mfma_f32_32x32x16_bf16 v[68:83], v[228:231], v[136:139], v[68:83]
    v_mfma_f32_32x32x16_bf16 v[84:99], v[232:235], v[136:139], v[84:99]
    ds_read_b64_tr_b16 v[196:197], v9 offset:0
    ds_read_b64_tr_b16 v[198:199], v7 offset:0
    ds_read_b64_tr_b16 v[200:201], v10 offset:0
    ds_read_b64_tr_b16 v[202:203], v8 offset:0
    s_waitcnt lgkmcnt(10)
    v_mfma_f32_32x32x16_bf16 v[36:51], v[236:239], v[140:143], v[36:51]
    s_waitcnt lgkmcnt(8)
    v_mfma_f32_32x32x16_bf16 v[52:67], v[240:243], v[140:143], v[52:67]
    v_mfma_f32_32x32x16_bf16 v[68:83], v[236:239], v[144:147], v[68:83]
    v_mfma_f32_32x32x16_bf16 v[84:99], v[240:243], v[144:147], v[84:99]
    s_cmp_eq_u32 s79, 0
    s_cbranch_scc0 Lcfix_94i
Lcok_93:
    s_buffer_load_dwordx4 s[20:23], s[36:39], s96 glc
    ds_read_b64_tr_b16 v[204:205], v7 offset:8192
    ds_read_b64_tr_b16 v[206:207], v5 offset:0
    ds_read_b64_tr_b16 v[208:209], v8 offset:8192
    ds_read_b64_tr_b16 v[210:211], v6 offset:0
    s_waitcnt vmcnt(4) lgkmcnt(10)
    v_mfma_f32_32x32x16_bf16 v[36:51], v[244:247], v[148:151], v[36:51]
    s_waitcnt lgkmcnt(8)
    v_mfma_f32_32x32x16_bf16 v[52:67], v[248:251], v[148:151], v[52:67]
    v_mfma_f32_32x32x16_bf16 v[68:83], v[244:247], v[152:155], v[68:83]
LIFb_8:
    s_cmp_eq_u32 s63, 1
    s_cbranch_scc1 LIFb_ret
LJFb_2:
    s_cmp_eq_u32 s63, 2
    s_cbranch_scc1 LJFb_6
    v_mfma_f32_32x32x16_bf16 v[84:99], v[248:251], v[152:155], v[84:99]
    ds_read_b64_tr_b16 v[212:213], v5 offset:8192
    ds_read_b64_tr_b16 v[214:215], v7 offset:16384
    ds_read_b64_tr_b16 v[216:217], v6 offset:8192
    ds_read_b64_tr_b16 v[218:219], v8 offset:16384
    s_waitcnt lgkmcnt(10)
    v_mfma_f32_32x32x16_bf16 v[36:51], v[196:199], v[156:159], v[36:51]
    s_waitcnt lgkmcnt(8)
    v_mfma_f32_32x32x16_bf16 v[52:67], v[200:203], v[156:159], v[52:67]
    v_mfma_f32_32x32x16_bf16 v[68:83], v[196:199], v[160:163], v[68:83]
    v_mfma_f32_32x32x16_bf16 v[84:99], v[200:203], v[160:163], v[84:99]
    s_waitcnt lgkmcnt(0)
    s_cmp_eq_u64 s[20:21], s[94:95]
    s_cselect_b32 s80, 0, 0x40000000
    s_or_b32 s75, s90, s80
    buffer_load_dwordx4 v[180:183], v11, s[36:39], s75 offen offset:0 sc1
    buffer_load_dwordx4 v[184:187], v12, s[36:39], s75 offen offset:0 sc1
    buffer_load_dwordx4 v[188:191], v11, s[36:39], s75 offen offset:1024 sc1
    buffer_load_dwordx4 v[192:195], v12, s[36:39], s75 offen offset:1024 sc1
    s_buffer_load_dwordx4 s[20:23], s[36:39], s96 glc
    ds_read_b64_tr_b16 v[220:221], v7 offset:24576
    ds_read_b64_tr_b16 v[222:223], v7 offset:32768
    ds_read_b64_tr_b16 v[224:225], v8 offset:24576
    ds_read_b64_tr_b16 v[226:227], v8 offset:32768
    s_waitcnt vmcnt(4)
    v_mfma_f32_32x32x16_bf16 v[36:51], v[204:207], v[164:167], v[36:51]
    v_mfma_f32_32x32x16_bf16 v[52:67], v[208:211], v[164:167], v[52:67]
    v_mfma_f32_32x32x16_bf16 v[68:83], v[204:207], v[168:171], v[68:83]
    v_mfma_f32_32x32x16_bf16 v[84:99], v[208:211], v[168:171], v[84:99]
    ds_read_b64_tr_b16 v[228:229], v5 offset:16384
    ds_read_b64_tr_b16 v[230:231], v9 offset:8192
    ds_read_b64_tr_b16 v[232:233], v6 offset:16384
    ds_read_b64_tr_b16 v[234:235], v10 offset:8192
    v_mfma_f32_32x32x16_bf16 v[36:51], v[212:215], v[172:175], v[36:51]
    v_mfma_f32_32x32x16_bf16 v[52:67], v[216:219], v[172:175], v[52:67]
    v_mfma_f32_32x32x16_bf16 v[68:83], v[212:215], v[176:179], v[68:83]
    v_mfma_f32_32x32x16_bf16 v[84:99], v[216:219], v[176:179], v[84:99]
    s_cmp_eq_u32 s80, 0
    s_cbranch_scc0 Lcfix_96i
Lcok_95:
    s_cmp_eq_u64 s[22:23], s[94:95]
    s_cbranch_scc0 Lretry_98i
Lok_97:
    s_add_u32 s75, s90, 131072
    buffer_load_dwordx4 v[100:103], v11, s[36:39], s75 offen offset:0 sc1
    buffer_load_dwordx4 v[104:107], v12, s[36:39], s75 offen offset:0 sc1
    buffer_load_dwordx4 v[108:111], v11, s[36:39], s75 offen offset:1024 sc1
    buffer_load_dwordx4 v[112:115], v12, s[36:39], s75 offen offset:1024 sc1
    buffer_load_dword v18, v29, s[36:39], 0 offen sc1
    ds_read_b64_tr_b16 v[236:237], v9 offset:16384
    ds_read_b64_tr_b16 v[238:239], v5 offset:49152
    ds_read_b64_tr_b16 v[240:241], v10 offset:16384
    ds_read_b64_tr_b16 v[242:243], v6 offset:49152
    s_waitcnt vmcnt(5) lgkmcnt(10)
    v_mfma_f32_32x32x16_bf16 v[36:51], v[220:223], v[180:183], v[36:51]
    s_waitcnt lgkmcnt(8)
    v_mfma_f32_32x32x16_bf16 v[52:67], v[224:227], v[180:183], v[52:67]
    v_mfma_f32_32x32x16_bf16 v[68:83], v[220:223], v[184:187], v[68:83]
    v_mfma_f32_32x32x16_bf16 v[84:99], v[224:227], v[184:187], v[84:99]
    ds_read_b64_tr_b16 v[244:245], v5 offset:57344
    ds_read_b64_tr_b16 v[246:247], v9 offset:24576
    ds_read_b64_tr_b16 v[248:249], v6 offset:57344
    ds_read_b64_tr_b16 v[250:251], v10 offset:24576
    s_waitcnt lgkmcnt(10)
    v_mfma_f32_32x32x16_bf16 v[36:51], v[228:231], v[188:191], v[36:51]
    s_waitcnt lgkmcnt(8)
    v_mfma_f32_32x32x16_bf16 v[52:67], v[232:235], v[188:191], v[52:67]
    v_mfma_f32_32x32x16_bf16 v[68:83], v[228:231], v[192:195], v[68:83]
    v_mfma_f32_32x32x16_bf16 v[84:99], v[232:235], v[192:195], v[84:99]
    s_waitcnt vmcnt(4) lgkmcnt(4)
    v_mfma_f32_32x32x16_bf16 v[52:67], v[240:243], v[100:103], v[52:67]
    s_waitcnt vmcnt(2) lgkmcnt(0)
    v_mfma_f32_32x32x16_bf16 v[52:67], v[248:251], v[108:111], v[52:67]
    v_add_u32 v22, s71, v2
    v_add_u32 v23, 0x10000, v22
    s_lshl_b32 s74, s65, 10
    v_add_u32 v20, s74, v2
    v_xor_b32 v5, 0x0, v20
    v_mfma_f32_32x32x16_bf16 v[68:83], v[236:239], v[104:107], v[68:83]
    v_xor_b32 v6, 0x8400, v20
    v_xor_b32 v7, 0x10800, v20
    v_xor_b32 v8, 0x18c00, v20
    s_lshl_b32 s74, s69, 1
    s_lshr_b32 s75, s65, 1
    s_waitcnt vmcnt(1)
    v_mfma_f32_32x32x16_bf16 v[68:83], v[244:247], v[112:115], v[68:83]
    ds_write_b128 v22, v[52:55] offset:16384
    ds_write_b128 v22, v[56:59] offset:24576
    ds_write_b128 v22, v[60:63] offset:32768
    ds_write_b128 v22, v[64:67] offset:40960
    v_mfma_f32_32x32x16_bf16 v[84:99], v[240:243], v[104:107], v[84:99]
    s_add_u32 s74, s74, s75
    s_lshl_b32 s74, s74, 15
    s_lshl_b32 s75, s70, 7
    s_add_u32 s74, s74, s75
    s_and_b32 s75, s65, 1
    s_lshl_b32 s75, s75, 6
    v_mfma_f32_32x32x16_bf16 v[84:99], v[248:251], v[112:115], v[84:99]
    ds_write_b128 v22, v[68:71] offset:49152
    ds_write_b128 v22, v[72:75] offset:57344
    ds_write_b128 v23, v[76:79] offset:0
    ds_write_b128 v23, v[80:83] offset:8192
    v_mfma_f32_32x32x16_bf16 v[36:51], v[236:239], v[100:103], v[36:51]
    s_add_u32 s74, s74, s75
    v_lshrrev_b32 v11, 5, v1
    v_lshlrev_b32 v11, 4, v11
    v_and_b32 v21, 31, v1
    v_lshl_add_u32 v11, v21, 10, v11
    v_lshlrev_b32 v180, 16, v24
    v_mfma_f32_32x32x16_bf16 v[36:51], v[244:247], v[108:111], v[36:51]
    ds_write_b128 v23, v[84:87] offset:16384
    ds_write_b128 v23, v[88:91] offset:24576
    ds_write_b128 v23, v[92:95] offset:32768
    ds_write_b128 v23, v[96:99] offset:40960
    v_and_b32 v181, 0xffff0000, v24
    v_lshlrev_b32 v182, 16, v25
    v_and_b32 v183, 0xffff0000, v25
    v_lshlrev_b32 v184, 16, v26
    v_and_b32 v185, 0xffff0000, v26
    v_lshlrev_b32 v186, 16, v27
    v_and_b32 v187, 0xffff0000, v27
    s_nop 0
    ds_write_b128 v22, v[36:39] offset:0
    s_waitcnt lgkmcnt(12)
    ds_write_b128 v22, v[40:43] offset:8192
    v_pk_add_f32 v[44:45], v[44:45], v[180:181]
    v_pk_add_f32 v[46:47], v[46:47], v[182:183]
    v_pk_add_f32 v[48:49], v[48:49], v[184:185]
    v_pk_add_f32 v[50:51], v[50:51], v[186:187]
    s_waitcnt lgkmcnt(0)
    s_barrier
    ds_read_b128 v[100:103], v5 offset:0
    ds_read_b128 v[108:111], v6 offset:0
    ds_read_b128 v[116:119], v7 offset:0
    ds_read_b128 v[124:127], v8 offset:0
    ds_read_b128 v[132:135], v6 offset:4096
    ds_read_b128 v[140:143], v7 offset:4096
    ds_read_b128 v[148:151], v8 offset:4096
    ds_read_b128 v[104:107], v5 offset:8192
    ds_read_b128 v[112:115], v6 offset:8192
    ds_read_b128 v[120:123], v7 offset:8192
    ds_read_b128 v[128:131], v8 offset:8192
    ds_read_b128 v[136:139], v6 offset:12288
    ds_read_b128 v[144:147], v7 offset:12288
    s_waitcnt lgkmcnt(12)
    ds_read_b128 v[152:155], v8 offset:12288
    s_waitcnt vmcnt(0)
    v_add_f32 v18, 1.0, v18
    v_rcp_f32 v18, v18
    s_nop 0
    v_mov_b32 v19, v18
    v_pk_add_f32 v[44:45], v[44:45], v[100:101]
LIFb_9:
    s_cmp_eq_u32 s63, 1
    s_cbranch_scc1 LIFb_ret
LJFb_3:
    s_cmp_eq_u32 s63, 2
    s_cbranch_scc1 LJFb_7
    v_pk_add_f32 v[46:47], v[46:47], v[102:103]
    s_waitcnt lgkmcnt(12)
    v_pk_add_f32 v[44:45], v[44:45], v[108:109]
    v_pk_add_f32 v[46:47], v[46:47], v[110:111]
    s_waitcnt lgkmcnt(11)
    v_pk_add_f32 v[44:45], v[44:45], v[116:117]
    v_pk_add_f32 v[46:47], v[46:47], v[118:119]
    s_waitcnt lgkmcnt(10)
    v_pk_add_f32 v[44:45], v[44:45], v[124:125]
    v_pk_add_f32 v[46:47], v[46:47], v[126:127]
    s_waitcnt lgkmcnt(9)
    v_pk_add_f32 v[44:45], v[44:45], v[132:133]
    v_pk_add_f32 v[46:47], v[46:47], v[134:135]
    s_waitcnt lgkmcnt(8)
    v_pk_add_f32 v[44:45], v[44:45], v[140:141]
    v_pk_add_f32 v[46:47], v[46:47], v[142:143]
    s_waitcnt lgkmcnt(7)
    v_pk_add_f32 v[44:45], v[44:45], v[148:149]
    v_pk_add_f32 v[46:47], v[46:47], v[150:151]
    v_pk_mul_f32 v[44:45], v[44:45], v[18:19]
    v_pk_mul_f32 v[46:47], v[46:47], v[18:19]
    v_cvt_pk_bf16_f32 v164, v44, v45
    v_cvt_pk_bf16_f32 v165, v46, v47
    s_waitcnt lgkmcnt(6)
    v_pk_add_f32 v[48:49], v[48:49], v[104:105]
    v_pk_add_f32 v[50:51], v[50:51], v[106:107]
    s_waitcnt lgkmcnt(5)
    v_pk_add_f32 v[48:49], v[48:49], v[112:113]
    v_pk_add_f32 v[50:51], v[50:51], v[114:115]
    s_waitcnt lgkmcnt(4)
    v_pk_add_f32 v[48:49], v[48:49], v[120:121]
    v_pk_add_f32 v[50:51], v[50:51], v[122:123]
    s_waitcnt lgkmcnt(3)
    v_pk_add_f32 v[48:49], v[48:49], v[128:129]
    v_pk_add_f32 v[50:51], v[50:51], v[130:131]
    s_waitcnt lgkmcnt(2)
    v_pk_add_f32 v[48:49], v[48:49], v[136:137]
    v_pk_add_f32 v[50:51], v[50:51], v[138:139]
    s_waitcnt lgkmcnt(1)
    v_pk_add_f32 v[48:49], v[48:49], v[144:145]
    v_pk_add_f32 v[50:51], v[50:51], v[146:147]
    s_waitcnt lgkmcnt(0)
    v_pk_add_f32 v[48:49], v[48:49], v[152:153]
    v_pk_add_f32 v[50:51], v[50:51], v[154:155]
    v_pk_mul_f32 v[48:49], v[48:49], v[18:19]
    v_pk_mul_f32 v[50:51], v[50:51], v[18:19]
    v_cvt_pk_bf16_f32 v166, v48, v49
    v_cvt_pk_bf16_f32 v167, v50, v51
    s_nop 0
    v_permlane32_swap_b32 v164, v166
    v_permlane32_swap_b32 v165, v167
    buffer_store_dwordx4 v[164:167], v11, s[32:35], s74 offen offset:32
    s_endpgm
Lretry_84i:
    s_mov_b32 s0, 20000
Lretry_84:
    s_sub_u32 s0, s0, 1
    s_cbranch_scc1 Lok_83
    s_sleep 1
    s_buffer_load_dword s94, s[24:27], 0 glc
Lretry_84w:
    s_waitcnt lgkmcnt(0)
    s_cmp_lg_u32 s94, 0
    s_cbranch_scc0 Lretry_84
    s_branch Lok_83
Lcfix_86i:
    s_mov_b32 s0, 20000
    s_branch Lcfix_86w
Lcfix_86:
    s_sub_u32 s0, s0, 1
    s_cbranch_scc1 Lcfix_86g
    s_sleep 1
    s_buffer_load_dwordx16 s[4:19], s[36:39], s96 offset:16384 glc
Lcfix_86w:
    s_waitcnt lgkmcnt(0)
    s_cmp_eq_u64 s[4:5], s[94:95]
    s_cbranch_scc0 Lcfix_86
Lcfix_86g:
    buffer_load_dwordx4 v[100:103], v11, s[36:39], s89 offen offset:0 sc1
    buffer_load_dwordx4 v[104:107], v12, s[36:39], s89 offen offset:0 sc1
    buffer_load_dwordx4 v[108:111], v11, s[36:39], s89 offen offset:1024 sc1
    buffer_load_dwordx4 v[112:115], v12, s[36:39], s89 offen offset:1024 sc1
    s_branch Lcok_85
Lcfix_88i:
    s_mov_b32 s0, 20000
    s_branch Lcfix_88w
Lcfix_88:
    s_sub_u32 s0, s0, 1
    s_cbranch_scc1 Lcfix_88g
    s_sleep 1
    s_buffer_load_dwordx16 s[4:19], s[36:39], s96 offset:16384 glc
Lcfix_88w:
    s_waitcnt lgkmcnt(0)
    s_cmp_eq_u64 s[8:9], s[94:95]
    s_cbranch_scc0 Lcfix_88
Lcfix_88g:
    s_add_u32 s75, s89, 262144
    buffer_load_dwordx4 v[116:119], v11, s[36:39], s75 offen offset:0 sc1
    buffer_load_dwordx4 v[120:123], v12, s[36:39], s75 offen offset:0 sc1
    buffer_load_dwordx4 v[124:127], v11, s[36:39], s75 offen offset:1024 sc1
    buffer_load_dwordx4 v[128:131], v12, s[36:39], s75 offen offset:1024 sc1
    s_branch Lcok_87
Lcfix_90i:
    s_mov_b32 s0, 20000
    s_branch Lcfix_90w
Lcfix_90:
    s_sub_u32 s0, s0, 1
    s_cbranch_scc1 Lcfix_90g
    s_sleep 1
    s_buffer_load_dwordx16 s[4:19], s[36:39], s96 offset:16384 glc
Lcfix_90w:
    s_waitcnt lgkmcnt(0)
    s_cmp_eq_u64 s[12:13], s[94:95]
    s_cbranch_scc0 Lcfix_90
Lcfix_90g:
    s_add_u32 s75, s89, 524288
    buffer_load_dwordx4 v[132:135], v11, s[36:39], s75 offen offset:0 sc1
    buffer_load_dwordx4 v[136:139], v12, s[36:39], s75 offen offset:0 sc1
    buffer_load_dwordx4 v[140:143], v11, s[36:39], s75 offen offset:1024 sc1
    buffer_load_dwordx4 v[144:147], v12, s[36:39], s75 offen offset:1024 sc1
    s_branch Lcok_89
Lcfix_92i:
    s_mov_b32 s0, 20000
    s_branch Lcfix_92w
Lcfix_92:
    s_sub_u32 s0, s0, 1
    s_cbranch_scc1 Lcfix_92g
    s_sleep 1
    s_buffer_load_dwordx16 s[4:19], s[36:39], s96 offset:16384 glc
Lcfix_92w:
    s_waitcnt lgkmcnt(0)
    s_cmp_eq_u64 s[6:7], s[94:95]
    s_cbranch_scc0 Lcfix_92
Lcfix_92g:
    s_add_u32 s75, s89, 131072
    buffer_load_dwordx4 v[148:151], v11, s[36:39], s75 offen offset:0 sc1
    buffer_load_dwordx4 v[152:155], v12, s[36:39], s75 offen offset:0 sc1
    buffer_load_dwordx4 v[156:159], v11, s[36:39], s75 offen offset:1024 sc1
    buffer_load_dwordx4 v[160:163], v12, s[36:39], s75 offen offset:1024 sc1
    s_branch Lcok_91
Lcfix_94i:
    s_mov_b32 s0, 20000
    s_branch Lcfix_94w
Lcfix_94:
    s_sub_u32 s0, s0, 1
    s_cbranch_scc1 Lcfix_94g
    s_sleep 1
    s_buffer_load_dwordx16 s[4:19], s[36:39], s96 offset:16384 glc
Lcfix_94w:
    s_waitcnt lgkmcnt(0)
    s_cmp_eq_u64 s[10:11], s[94:95]
    s_cbranch_scc0 Lcfix_94
Lcfix_94g:
    s_add_u32 s75, s89, 393216
    buffer_load_dwordx4 v[164:167], v11, s[36:39], s75 offen offset:0 sc1
    buffer_load_dwordx4 v[168:171], v12, s[36:39], s75 offen offset:0 sc1
    buffer_load_dwordx4 v[172:175], v11, s[36:39], s75 offen offset:1024 sc1
    buffer_load_dwordx4 v[176:179], v12, s[36:39], s75 offen offset:1024 sc1
    s_branch Lcok_93
Lcfix_96i:
    s_mov_b32 s0, 20000
    s_branch Lcfix_96w
Lcfix_96:
    s_sub_u32 s0, s0, 1
    s_cbranch_scc1 Lcfix_96g
    s_sleep 1
    s_buffer_load_dwordx4 s[20:23], s[36:39], s96 glc
Lcfix_96w:
    s_waitcnt lgkmcnt(0)
    s_cmp_eq_u64 s[20:21], s[94:95]
    s_cbranch_scc0 Lcfix_96
Lcfix_96g:
    buffer_load_dwordx4 v[180:183], v11, s[36:39], s90 offen offset:0 sc1
    buffer_load_dwordx4 v[184:187], v12, s[36:39], s90 offen offset:0 sc1
    buffer_load_dwordx4 v[188:191], v11, s[36:39], s90 offen offset:1024 sc1
    buffer_load_dwordx4 v[192:195], v12, s[36:39], s90 offen offset:1024 sc1
    s_branch Lcok_95
Lretry_98i:
    s_mov_b32 s0, 20000
    s_branch Lretry_98w
Lretry_98:
    s_sub_u32 s0, s0, 1
    s_cbranch_scc1 Lok_97
    s_sleep 1
    s_buffer_load_dwordx4 s[20:23], s[36:39], s96 glc
Lretry_98w:
    s_waitcnt lgkmcnt(0)
    s_cmp_eq_u64 s[22:23], s[94:95]
    s_cbranch_scc0 Lretry_98
    s_branch Lok_97
.p2align 12
L_pathGb:
    s_load_dwordx2 s[12:13], s[0:1], 64
    s_load_dwordx2 s[24:25], s[0:1], 80
    s_load_dwordx2 s[28:29], s[0:1], 48
    s_load_dwordx2 s[40:41], s[0:1], 16
    s_load_dwordx2 s[32:33], s[0:1], 72
    s_load_dwordx2 s[16:17], s[0:1], 40
    v_lshrrev_b32 v20, 3, v1
    v_and_b32 v21, 7, v1
    v_lshrrev_b32 v22, 4, v1
    v_xor_b32 v23, v21, v22
    v_lshlrev_b32 v23, 4, v23
    v_lshl_add_u32 v23, v20, 10, v23
    s_lshl_b32 s76, s66, 3
    s_add_u32 s76, s76, s64
    s_lshl_b32 s77, s76, 14
    v_add_u32 v96, s77, v23
    v_xor_b32 v97, 64, v96
    v_add_u32 v97, 7168, v97
    v_and_b32 v22, 1, v22
    v_lshlrev_b32 v22, 2, v22
    v_xor_b32 v21, v21, v22
    v_lshlrev_b32 v21, 4, v21
    s_and_b32 s62, s92, 7
    s_and_b32 s75, s93, 6
    s_xor_b32 s62, s62, s75
    s_lshl_b32 s62, s62, 7
    s_mul_i32 s75, s62, 1376
    s_lshl_b32 s72, s64, 11
    s_lshl_b32 s71, s64, 10
    s_add_u32 s73, s71, 65536
    s_mov_b32 m0, s72
    s_mov_b32 s6, 0x200000
    s_mov_b32 s7, 0x20000
    s_mov_b32 s22, 0x158000
    s_mov_b32 s23, 0x20000
    s_mul_i32 s3, s68, 5
    s_min_u32 s77, s68, 3
    s_add_u32 s3, s3, s77
    s_lshl_b32 s3, s3, 6
    s_mul_i32 s77, s64, 22016
    s_add_u32 s77, s77, s3
    v_mul_u32_u24 v98, 2752, v20
    v_lshl_add_u32 v4, v20, 10, v21
    s_and_b32 s76, s64, 1
    s_lshl_b32 s76, s76, 5
    v_xor_b32 v21, s76, v21
    v_and_b32 v22, 0x30, v21
    v_add3_u32 v99, v98, v22, s77
    v_add3_u32 v98, v98, v21, s77
    v_lshrrev_b32 v23, 4, v1
    v_lshlrev_b32 v15, 3, v23
    s_mov_b32 s18, 0xac0
    s_mov_b32 s19, 0x20000
    v_and_b32 v22, 15, v1
    v_lshlrev_b32 v22, 6, v22
    v_lshrrev_b32 v23, 4, v1
    v_lshl_add_u32 v30, v23, 4, v22
    v_xor_b32 v30, s62, v30
    s_mov_b32 s14, 0x400
    s_mov_b32 s15, 0x20000
    s_waitcnt lgkmcnt(0)
    buffer_load_dwordx4 v96, s[4:7], s62 offen offset:0 lds
    buffer_load_dwordx4 v97, s[4:7], s62 offen offset:1024 lds
    s_add_u32 m0, s73, 0
    s_nop 0
    buffer_load_dwordx4 v98, s[20:23], s75 offen offset:0 lds
    s_add_u32 m0, s73, 8064
    s_nop 0
    buffer_load_dwordx4 v98, s[20:23], s75 offen offset:128 lds
    s_add_u32 m0, s73, 16128
    s_nop 0
    buffer_load_dwordx4 v99, s[20:23], s75 offen offset:256 lds
    s_load_dwordx2 s[8:9], s[0:1], 56
    s_lshl_b32 s76, s2, 3
    s_add_u32 s76, s76, s64
    s_lshl_b32 s77, s76, 10
    s_add_u32 s77, s77, 0x800000
    s_lshl_b32 s76, s76, 7
    s_add_u32 s76, s76, 0x77a000
    s_cmp_lt_u32 s2, 64
    s_cselect_b32 s76, s77, s76
    s_cmp_lt_u32 s2, 80
    s_cbranch_scc0 Lnop_99
    s_load_dword s95, s[36:37], s76 glc
Lnop_99:
    s_mov_b32 s63, 1
    s_and_b32 s76, s93, 3
    s_lshl_b32 s76, s76, 2
    s_add_u32 s76, s76, s64
    s_cmp_eq_u32 s76, 4
    s_cbranch_scc1 LIGb_0
    s_cmp_eq_u32 s76, 5
    s_cbranch_scc1 LIGb_1
    s_cmp_eq_u32 s76, 6
    s_cbranch_scc1 LIGb_2
    s_cmp_eq_u32 s76, 7
    s_cbranch_scc1 LIGb_3
    s_cmp_eq_u32 s76, 8
    s_cbranch_scc1 LIGb_4
    s_cmp_eq_u32 s76, 9
    s_cbranch_scc1 LIGb_5
    s_cmp_eq_u32 s76, 10
    s_cbranch_scc1 LIGb_6
    s_cmp_eq_u32 s76, 11
    s_cbranch_scc1 LIGb_7
    s_cmp_eq_u32 s76, 12
    s_cbranch_scc1 LIGb_8
    s_cmp_eq_u32 s76, 13
    s_cbranch_scc1 LIGb_9
    s_cmp_eq_u32 s76, 14
    s_cbranch_scc1 LIGb_10
    s_cmp_eq_u32 s76, 15
    s_cbranch_scc1 LIGb_11
    s_cmp_eq_u32 s76, 16
    s_cbranch_scc1 LIGb_12
LIGb_10:
LIGb_11:
LIGb_12:
LIGb_ret:
    s_mov_b32 s63, 0
    s_barrier
    buffer_load_dwordx2 v[150:151], v15, s[16:19], s3 offen offset:64
    buffer_load_dwordx2 v[154:155], v15, s[16:19], s3 offen offset:96
    buffer_load_dwordx2 v[158:159], v15, s[16:19], s3 offen offset:192
    buffer_load_dwordx2 v[162:163], v15, s[16:19], s3 offen offset:224
    buffer_load_dwordx4 v[188:191], v30, s[12:15], 0 offen
    s_add_u32 m0, s72, 16384
    s_xor_b32 s74, s62, 128
    buffer_load_dwordx4 v96, s[4:7], s74 offen offset:0 lds
    buffer_load_dwordx4 v97, s[4:7], s74 offen offset:1024 lds
    s_add_u32 m0, s73, 24576
    s_xor_b32 s75, s62, 128
    s_mul_i32 s75, s75, 1376
    buffer_load_dwordx4 v98, s[20:23], s75 offen offset:0 lds
    s_add_u32 m0, s73, 32640
    s_nop 0
    buffer_load_dwordx4 v98, s[20:23], s75 offen offset:128 lds
    s_add_u32 m0, s73, 40704
    s_nop 0
    buffer_load_dwordx4 v99, s[20:23], s75 offen offset:256 lds
    s_and_b32 s65, s64, 3
    v_and_b32 v20, 15, v1
    v_lshrrev_b32 v21, 4, v1
    v_bfe_u32 v22, v1, 1, 3
    v_xor_b32 v22, v22, v21
    v_lshlrev_b32 v22, 4, v22
    v_lshl_add_u32 v22, v20, 7, v22
    s_lshl_b32 s76, s65, 12
    v_add_u32 v180, s76, v22
    v_xor_b32 v181, 64, v180
    v_bfe_u32 v20, v1, 2, 2
    v_and_b32 v22, 3, v1
    v_lshlrev_b32 v22, 3, v22
    v_bfe_u32 v23, v1, 4, 1
    v_lshl_add_u32 v22, v23, 5, v22
    v_bfe_u32 v23, v1, 3, 1
    v_lshl_add_u32 v22, v23, 6, v22
    v_lshl_add_u32 v22, v20, 7, v22
    v_lshl_add_u32 v23, v21, 10, v22
    v_xor_b32 v182, 0x10040, v23
    v_add_u32 v183, 49152, v182
    v_xor_b32 v184, 32, v182
    v_xor_b32 v185, 32, v183
    v_lshrrev_b32 v21, 5, v1
    v_lshl_add_u32 v5, v21, 9, v22
    v_lshlrev_b32 v2, 4, v1
    v_mov_b32 v33, 0
    s_mov_b32 s38, 0x900080
    s_mov_b32 s39, 0x20000
    s_mov_b32 s26, 0x100
    s_mov_b32 s27, 0x20000
    s_waitcnt lgkmcnt(0)
    s_lshl_b32 s80, s66, 2
    s_add_u32 s80, s80, s65
    s_lshl_b32 s79, s80, 11
    v_and_b32 v20, 15, v1
    v_lshrrev_b32 v22, 4, v1
    v_lshlrev_b32 v22, 9, v22
    v_lshl_add_u32 v22, v20, 4, v22
    v_add_u32 v28, s79, v22
    s_lshl_b32 s79, s68, 13
    s_lshl_b32 s80, s80, 7
    s_add_u32 s79, s79, s80
    s_add_u32 s79, s79, 0x790000
    v_and_b32 v20, 31, v1
    v_lshl_add_u32 v35, v20, 2, s79
    s_lshl_b32 s86, s3, 11
    s_add_u32 s86, s86, 2097152
LIGb_0:
    s_cmp_eq_u32 s63, 1
    s_cbranch_scc1 LIGb_ret
    s_lshl_b32 s69, s92, 2
    s_and_b32 s79, s93, 3
    s_add_u32 s69, s69, s79
    s_lshr_b32 s70, s93, 2
    s_lshl_b32 s79, s70, 7
    v_add_u32 v4, s79, v4
    s_waitcnt lgkmcnt(0)
    s_waitcnt vmcnt(10)
    s_barrier
    ds_read_b128 v[72:75], v180 offset:0
    ds_read_b64_tr_b16 v[36:37], v182 offset:0
    ds_read_b64_tr_b16 v[38:39], v182 offset:512
    ds_read_b64_tr_b16 v[40:41], v182 offset:8192
    ds_read_b64_tr_b16 v[42:43], v182 offset:8704
    s_waitcnt vmcnt(5)
    v_mov_b32_dpp v44, v188 row_newbcast:0 row_mask:0xf bank_mask:0xf
    v_mov_b32_dpp v45, v189 row_newbcast:0 row_mask:0xf bank_mask:0xf
    v_mov_b32_dpp v46, v190 row_newbcast:0 row_mask:0xf bank_mask:0xf
    v_mov_b32_dpp v47, v191 row_newbcast:0 row_mask:0xf bank_mask:0xf
    ds_read_b128 v[76:79], v180 offset:2048
    ds_read_b64_tr_b16 v[48:49], v184 offset:0
    ds_read_b64_tr_b16 v[50:51], v184 offset:512
    ds_read_b64_tr_b16 v[52:53], v184 offset:8192
    ds_read_b64_tr_b16 v[54:55], v184 offset:8704
    v_lshlrev_b32 v148, 16, v150
    v_and_b32 v149, 0xffff0000, v150
    v_lshlrev_b32 v150, 16, v151
    v_and_b32 v151, 0xffff0000, v151
    v_lshlrev_b32 v152, 16, v154
    v_and_b32 v153, 0xffff0000, v154
    v_lshlrev_b32 v154, 16, v155
    v_and_b32 v155, 0xffff0000, v155
    v_lshlrev_b32 v156, 16, v158
    v_and_b32 v157, 0xffff0000, v158
    v_lshlrev_b32 v158, 16, v159
    v_and_b32 v159, 0xffff0000, v159
    v_lshlrev_b32 v160, 16, v162
    v_and_b32 v161, 0xffff0000, v162
    v_lshlrev_b32 v162, 16, v163
    v_and_b32 v163, 0xffff0000, v163
    s_waitcnt lgkmcnt(7)
    v_mfma_f32_16x16x32_bf16 v[100:103], v[36:39], v[72:75], v[148:151]
    ds_read_b128 v[80:83], v181 offset:0
    ds_read_b64_tr_b16 v[60:61], v182 offset:4096
    s_waitcnt lgkmcnt(6)
    v_mfma_f32_16x16x32_bf16 v[108:111], v[36:39], v[76:79], v[148:151]
    ds_read_b64_tr_b16 v[62:63], v182 offset:4608
    s_add_u32 m0, s72, 32768
    s_xor_b32 s74, s62, 256
    buffer_load_dwordx4 v96, s[4:7], s74 offen offset:0 lds
    s_mov_b32 s30, 0x158000
    s_mov_b32 s31, 0x20000
    v_mfma_f32_16x16x32_bf16 v[116:119], v[40:43], v[72:75], v[156:159]
    ds_read_b64_tr_b16 v[64:65], v182 offset:12288
    ds_read_b64_tr_b16 v[66:67], v182 offset:12800
    v_mfma_f32_16x16x32_bf16 v[124:127], v[40:43], v[76:79], v[156:159]
    s_mov_b32 s42, 0x80000
    s_mov_b32 s43, 0x20000
    v_mfma_f32_16x16x32_bf16 v[132:135], v[44:47], v[72:75], 0
    v_mov_b32_dpp v68, v188 row_newbcast:1 row_mask:0xf bank_mask:0xf
    v_mov_b32_dpp v69, v189 row_newbcast:1 row_mask:0xf bank_mask:0xf
    v_mov_b32_dpp v70, v190 row_newbcast:1 row_mask:0xf bank_mask:0xf
    v_mov_b32_dpp v71, v191 row_newbcast:1 row_mask:0xf bank_mask:0xf
    s_mul_i32 s79, s64, 5
    s_min_u32 s80, s64, 3
    s_add_u32 s79, s79, s80
    s_lshl_b32 s87, s79, 15
    s_add_u32 s79, s79, 16
    s_lshl_b32 s89, s79, 17
    s_waitcnt lgkmcnt(7)
    v_mfma_f32_16x16x32_bf16 v[104:107], v[48:51], v[72:75], v[152:155]
    ds_read_b128 v[84:87], v181 offset:2048
    ds_read_b64_tr_b16 v[36:37], v184 offset:4096
    v_mfma_f32_16x16x32_bf16 v[112:115], v[48:51], v[76:79], v[152:155]
    ds_read_b64_tr_b16 v[38:39], v184 offset:4608
    buffer_load_dwordx4 v97, s[4:7], s74 offen offset:1024 lds
    s_lshl_b32 s88, s64, 16
    s_lshl_b32 s90, s64, 18
    s_waitcnt lgkmcnt(8)
    v_mfma_f32_16x16x32_bf16 v[120:123], v[52:55], v[72:75], v[160:163]
    ds_read_b64_tr_b16 v[40:41], v184 offset:12288
    ds_read_b64_tr_b16 v[42:43], v184 offset:12800
    v_mfma_f32_16x16x32_bf16 v[128:131], v[52:55], v[76:79], v[160:163]
    s_add_u32 m0, s73, 49152
    s_xor_b32 s75, s62, 256
    s_mul_i32 s75, s75, 1376
    buffer_load_dwordx4 v98, s[20:23], s75 offen offset:0 lds
    s_mov_b32 s82, 0xbdd2d3e8
    s_mov_b32 s83, 0xbdd2d3e8
    v_mfma_f32_16x16x32_bf16 v[136:139], v[44:47], v[76:79], 0
    s_mov_b32 s84, 1.0
    s_mov_b32 s85, 1.0
    s_waitcnt vmcnt(3) lgkmcnt(0)
    s_barrier
    v_mfma_f32_16x16x32_bf16 v[100:103], v[60:63], v[80:83], v[100:103]
    ds_read_b128 v[72:75], v180 offset:16384
    ds_read_b64_tr_b16 v[48:49], v182 offset:24576
    v_mfma_f32_16x16x32_bf16 v[108:111], v[60:63], v[84:87], v[108:111]
    ds_read_b64_tr_b16 v[50:51], v182 offset:25088
    s_add_u32 m0, s73, 57216
    s_nop 0
    buffer_load_dwordx4 v98, s[20:23], s75 offen offset:128 lds
    v_mov_b32 v186, 0xc0135761
    v_mov_b32 v187, 0xc0135761
    v_mfma_f32_16x16x32_bf16 v[116:119], v[64:67], v[80:83], v[116:119]
    ds_read_b64_tr_b16 v[52:53], v182 offset:32768
    ds_read_b64_tr_b16 v[54:55], v182 offset:33280
    v_mfma_f32_16x16x32_bf16 v[124:127], v[64:67], v[84:87], v[124:127]
    s_lshl_b32 s81, s66, 15
    s_lshr_b32 s79, s65, 1
    s_lshl_b32 s79, s79, 10
    s_add_u32 s81, s81, s79
    s_and_b32 s79, s65, 1
    s_lshl_b32 s79, s79, 2
    s_add_u32 s81, s81, s79
    s_add_u32 s81, s81, 0x800000
    v_mfma_f32_16x16x32_bf16 v[132:135], v[68:71], v[80:83], v[132:135]
    v_mov_b32_dpp v56, v188 row_newbcast:2 row_mask:0xf bank_mask:0xf
    v_mov_b32_dpp v57, v189 row_newbcast:2 row_mask:0xf bank_mask:0xf
    v_mov_b32_dpp v58, v190 row_newbcast:2 row_mask:0xf bank_mask:0xf
    v_mov_b32_dpp v59, v191 row_newbcast:2 row_mask:0xf bank_mask:0xf
    s_lshl_b32 s79, s67, 11
    s_add_u32 s79, s79, s81
    v_mov_b32 v13, s79
    v_mfma_f32_16x16x32_bf16 v[104:107], v[36:39], v[80:83], v[104:107]
    ds_read_b128 v[76:79], v180 offset:18432
    ds_read_b64_tr_b16 v[60:61], v184 offset:24576
    v_mfma_f32_16x16x32_bf16 v[112:115], v[36:39], v[84:87], v[112:115]
    ds_read_b64_tr_b16 v[62:63], v184 offset:25088
    s_add_u32 m0, s73, 65280
    s_nop 0
    buffer_load_dwordx4 v99, s[20:23], s75 offen offset:256 lds
    s_lshl_b32 s79, s68, 12
    s_add_u32 s79, s79, s81
    s_add_u32 s79, s79, -16360
    s_add_u32 s80, s81, 22568
    s_cmp_eq_u32 s68, 3
    s_cselect_b32 s79, s80, s79
    s_cselect_b32 s80, 0, 2048
    v_and_b32 v20, 1, v1
    v_mul_u32_u24 v20, s80, v20
    v_add_u32 v34, s79, v20
    v_mfma_f32_16x16x32_bf16 v[120:123], v[40:43], v[80:83], v[120:123]
    ds_read_b64_tr_b16 v[64:65], v184 offset:32768
    ds_read_b64_tr_b16 v[66:67], v184 offset:33280
    v_mfma_f32_16x16x32_bf16 v[128:131], v[40:43], v[84:87], v[128:131]
    s_add_u32 m0, s72, 49152
    s_xor_b32 s74, s62, 384
    buffer_load_dwordx4 v96, s[4:7], s74 offen offset:0 lds
    s_and_b32 s79, s64, 1
    s_lshl_b32 s79, s79, 6
    s_add_u32 s79, s79, s71
    v_xor_b32 v5, s79, v5
    v_xor_b32 v6, 64, v5
    v_mfma_f32_16x16x32_bf16 v[136:139], v[68:71], v[84:87], v[136:139]
    v_add_u32 v7, 0x10000, v5
LIGb_1:
    s_cmp_eq_u32 s63, 1
    s_cbranch_scc1 LIGb_ret
    v_add_u32 v8, 0x10000, v6
    s_waitcnt lgkmcnt(7)
    v_mfma_f32_16x16x32_bf16 v[100:103], v[48:51], v[72:75], v[100:103]
    ds_read_b128 v[80:83], v181 offset:16384
    ds_read_b64_tr_b16 v[36:37], v182 offset:28672
    s_waitcnt lgkmcnt(6)
    v_mfma_f32_16x16x32_bf16 v[108:111], v[48:51], v[76:79], v[108:111]
    ds_read_b64_tr_b16 v[38:39], v182 offset:29184
    buffer_load_dwordx4 v97, s[4:7], s74 offen offset:1024 lds
    v_add_u32 v9, 0x10000, v7
    v_add_u32 v10, 0x10000, v8
    v_mfma_f32_16x16x32_bf16 v[116:119], v[52:55], v[72:75], v[116:119]
    ds_read_b64_tr_b16 v[40:41], v182 offset:36864
    ds_read_b64_tr_b16 v[42:43], v182 offset:37376
    v_mfma_f32_16x16x32_bf16 v[124:127], v[52:55], v[76:79], v[124:127]
    s_mov_b32 s34, 0x200000
    s_mov_b32 s35, 0x20000
    v_mfma_f32_16x16x32_bf16 v[132:135], v[56:59], v[72:75], v[132:135]
    v_mov_b32_dpp v44, v188 row_newbcast:3 row_mask:0xf bank_mask:0xf
    v_mov_b32_dpp v45, v189 row_newbcast:3 row_mask:0xf bank_mask:0xf
    v_mov_b32_dpp v46, v190 row_newbcast:3 row_mask:0xf bank_mask:0xf
    v_mov_b32_dpp v47, v191 row_newbcast:3 row_mask:0xf bank_mask:0xf
    s_lshl_b32 s79, s69, 1
    s_lshr_b32 s80, s65, 1
    s_add_u32 s79, s79, s80
    s_lshl_b32 s80, s79, 11
    v_add_u32 v11, s80, v2
    v_xor_b32 v12, 2048, v11
    s_lshl_b32 s79, s79, 7
    s_lshr_b32 s80, s64, 1
    s_lshl_b32 s80, s80, 13
    s_add_u32 s79, s79, s80
    s_add_u32 s79, s79, 0x798000
    v_and_b32 v20, 31, v1
    v_lshl_add_u32 v29, v20, 2, s79
    v_lshlrev_b32 v206, 7, v1
    v_mov_b32 v207, 0x40000000
    v_cmp_gt_u32 vcc, 8, v1
    s_lshl_b32 s76, s2, 3
    s_add_u32 s76, s76, s64
    v_cndmask_b32 v206, v207, v206, vcc
    s_lshl_b32 s76, s76, 10
    s_sub_u32 s77, s76, 1409024
    s_cbranch_scc0 Ltu_100
    buffer_load_dword v207, v206, s[28:31], s76 offen
    s_branch Ltv_101
Ltu_100:
    buffer_load_dword v207, v206, s[40:43], s77 offen
Ltv_101:
    s_mov_b32 s10, 0x400
    s_mov_b32 s11, 0x20000
    s_lshl_b32 s79, s70, 7
    s_and_b32 s80, s65, 1
    s_lshl_b32 s80, s80, 6
    s_add_u32 s79, s79, s80
    v_lshlrev_b32 v22, 3, v21
    buffer_load_dwordx2 v[24:25], v22, s[8:11], s79 offen offset:32
    buffer_load_dwordx2 v[26:27], v22, s[8:11], s79 offen offset:48
    s_waitcnt lgkmcnt(7)
    v_mfma_f32_16x16x32_bf16 v[104:107], v[60:63], v[72:75], v[104:107]
    ds_read_b128 v[84:87], v181 offset:18432
    ds_read_b64_tr_b16 v[48:49], v184 offset:28672
    v_mfma_f32_16x16x32_bf16 v[112:115], v[60:63], v[76:79], v[112:115]
    ds_read_b64_tr_b16 v[50:51], v184 offset:29184
    s_add_u32 m0, s73, 73728
    s_xor_b32 s75, s62, 384
    s_mul_i32 s75, s75, 1376
    buffer_load_dwordx4 v98, s[20:23], s75 offen offset:0 lds
    s_lshr_b32 s79, s69, 1
    s_lshl_b32 s79, s79, 15
    s_and_b32 s80, s69, 1
    s_lshl_b32 s80, s80, 10
    s_add_u32 s79, s79, s80
    s_add_u32 s79, s79, 0x800000
    s_add_u32 s96, s79, s72
    s_waitcnt lgkmcnt(8)
    v_mfma_f32_16x16x32_bf16 v[120:123], v[64:67], v[72:75], v[120:123]
    ds_read_b64_tr_b16 v[52:53], v184 offset:36864
    ds_read_b64_tr_b16 v[54:55], v184 offset:37376
    v_mfma_f32_16x16x32_bf16 v[128:131], v[64:67], v[76:79], v[128:131]
    s_add_u32 m0, s73, 81792
    s_nop 0
    buffer_load_dwordx4 v98, s[20:23], s75 offen offset:128 lds
    v_mfma_f32_16x16x32_bf16 v[136:139], v[56:59], v[76:79], v[136:139]
    s_waitcnt vmcnt(7) lgkmcnt(0)
    s_barrier
    v_mfma_f32_16x16x32_bf16 v[100:103], v[36:39], v[80:83], v[100:103]
    ds_read_b128 v[72:75], v180 offset:32768
    ds_read_b64_tr_b16 v[60:61], v183 offset:0
    v_mfma_f32_16x16x32_bf16 v[108:111], v[36:39], v[84:87], v[108:111]
    ds_read_b64_tr_b16 v[62:63], v183 offset:512
    s_add_u32 m0, s73, 89856
    s_nop 0
    buffer_load_dwordx4 v99, s[20:23], s75 offen offset:256 lds
    v_mfma_f32_16x16x32_bf16 v[116:119], v[40:43], v[80:83], v[116:119]
    ds_read_b64_tr_b16 v[64:65], v183 offset:8192
    ds_read_b64_tr_b16 v[66:67], v183 offset:8704
    v_mfma_f32_16x16x32_bf16 v[124:127], v[40:43], v[84:87], v[124:127]
    v_mfma_f32_16x16x32_bf16 v[132:135], v[44:47], v[80:83], v[132:135]
    v_mov_b32_dpp v68, v188 row_newbcast:4 row_mask:0xf bank_mask:0xf
    v_mov_b32_dpp v69, v189 row_newbcast:4 row_mask:0xf bank_mask:0xf
    v_mov_b32_dpp v70, v190 row_newbcast:4 row_mask:0xf bank_mask:0xf
    v_mov_b32_dpp v71, v191 row_newbcast:4 row_mask:0xf bank_mask:0xf
    v_mfma_f32_16x16x32_bf16 v[104:107], v[48:51], v[80:83], v[104:107]
    ds_read_b128 v[76:79], v180 offset:34816
    ds_read_b64_tr_b16 v[36:37], v185 offset:0
    v_mfma_f32_16x16x32_bf16 v[112:115], v[48:51], v[84:87], v[112:115]
    ds_read_b64_tr_b16 v[38:39], v185 offset:512
    s_add_u32 m0, s72, 0
    s_xor_b32 s74, s62, 512
    buffer_load_dwordx4 v96, s[4:7], s74 offen offset:0 lds
    v_mfma_f32_16x16x32_bf16 v[120:123], v[52:55], v[80:83], v[120:123]
    ds_read_b64_tr_b16 v[40:41], v185 offset:8192
    ds_read_b64_tr_b16 v[42:43], v185 offset:8704
    v_mfma_f32_16x16x32_bf16 v[128:131], v[52:55], v[84:87], v[128:131]
    buffer_load_dwordx4 v97, s[4:7], s74 offen offset:1024 lds
    v_mfma_f32_16x16x32_bf16 v[136:139], v[44:47], v[84:87], v[136:139]
    s_waitcnt lgkmcnt(7)
    v_mfma_f32_16x16x32_bf16 v[100:103], v[60:63], v[72:75], v[100:103]
    ds_read_b128 v[80:83], v181 offset:32768
    ds_read_b64_tr_b16 v[48:49], v183 offset:4096
    s_waitcnt lgkmcnt(6)
    v_mfma_f32_16x16x32_bf16 v[108:111], v[60:63], v[76:79], v[108:111]
    ds_read_b64_tr_b16 v[50:51], v183 offset:4608
    s_add_u32 m0, s73, 0
    s_xor_b32 s75, s62, 512
    s_mul_i32 s75, s75, 1376
    buffer_load_dwordx4 v98, s[20:23], s75 offen offset:0 lds
    v_mfma_f32_16x16x32_bf16 v[116:119], v[64:67], v[72:75], v[116:119]
    ds_read_b64_tr_b16 v[52:53], v183 offset:12288
    ds_read_b64_tr_b16 v[54:55], v183 offset:12800
    v_mfma_f32_16x16x32_bf16 v[124:127], v[64:67], v[76:79], v[124:127]
    v_mfma_f32_16x16x32_bf16 v[132:135], v[68:71], v[72:75], v[132:135]
    v_mov_b32_dpp v56, v188 row_newbcast:5 row_mask:0xf bank_mask:0xf
    v_mov_b32_dpp v57, v189 row_newbcast:5 row_mask:0xf bank_mask:0xf
    v_mov_b32_dpp v58, v190 row_newbcast:5 row_mask:0xf bank_mask:0xf
    v_mov_b32_dpp v59, v191 row_newbcast:5 row_mask:0xf bank_mask:0xf
    s_waitcnt lgkmcnt(7)
    v_mfma_f32_16x16x32_bf16 v[104:107], v[36:39], v[72:75], v[104:107]
    ds_read_b128 v[84:87], v181 offset:34816
    ds_read_b64_tr_b16 v[60:61], v185 offset:4096
    v_mfma_f32_16x16x32_bf16 v[112:115], v[36:39], v[76:79], v[112:115]
    ds_read_b64_tr_b16 v[62:63], v185 offset:4608
    s_add_u32 m0, s73, 8064
    s_nop 0
    buffer_load_dwordx4 v98, s[20:23], s75 offen offset:128 lds
    s_waitcnt lgkmcnt(8)
    v_mfma_f32_16x16x32_bf16 v[120:123], v[40:43], v[72:75], v[120:123]
    ds_read_b64_tr_b16 v[64:65], v185 offset:12288
    ds_read_b64_tr_b16 v[66:67], v185 offset:12800
    v_mfma_f32_16x16x32_bf16 v[128:131], v[40:43], v[76:79], v[128:131]
    s_add_u32 m0, s73, 16128
LIGb_2:
    s_cmp_eq_u32 s63, 1
    s_cbranch_scc1 LIGb_ret
    s_nop 0
    buffer_load_dwordx4 v99, s[20:23], s75 offen offset:256 lds
    v_mfma_f32_16x16x32_bf16 v[136:139], v[68:71], v[76:79], v[136:139]
    s_waitcnt vmcnt(5) lgkmcnt(0)
    s_barrier
    v_mfma_f32_16x16x32_bf16 v[100:103], v[48:51], v[80:83], v[100:103]
    ds_read_b128 v[72:75], v180 offset:49152
    ds_read_b64_tr_b16 v[36:37], v183 offset:24576
    v_mfma_f32_16x16x32_bf16 v[108:111], v[48:51], v[84:87], v[108:111]
    ds_read_b64_tr_b16 v[38:39], v183 offset:25088
    s_add_u32 m0, s72, 16384
    s_xor_b32 s74, s62, 640
    buffer_load_dwordx4 v96, s[4:7], s74 offen offset:0 lds
    v_mfma_f32_16x16x32_bf16 v[116:119], v[52:55], v[80:83], v[116:119]
    ds_read_b64_tr_b16 v[40:41], v183 offset:32768
    ds_read_b64_tr_b16 v[42:43], v183 offset:33280
    v_mfma_f32_16x16x32_bf16 v[124:127], v[52:55], v[84:87], v[124:127]
    v_mfma_f32_16x16x32_bf16 v[132:135], v[56:59], v[80:83], v[132:135]
    v_mov_b32_dpp v44, v188 row_newbcast:6 row_mask:0xf bank_mask:0xf
    v_mov_b32_dpp v45, v189 row_newbcast:6 row_mask:0xf bank_mask:0xf
    v_mov_b32_dpp v46, v190 row_newbcast:6 row_mask:0xf bank_mask:0xf
    v_mov_b32_dpp v47, v191 row_newbcast:6 row_mask:0xf bank_mask:0xf
    v_mfma_f32_16x16x32_bf16 v[104:107], v[60:63], v[80:83], v[104:107]
    ds_read_b128 v[76:79], v180 offset:51200
    ds_read_b64_tr_b16 v[48:49], v185 offset:24576
    v_mfma_f32_16x16x32_bf16 v[112:115], v[60:63], v[84:87], v[112:115]
    ds_read_b64_tr_b16 v[50:51], v185 offset:25088
    buffer_load_dwordx4 v97, s[4:7], s74 offen offset:1024 lds
    v_mfma_f32_16x16x32_bf16 v[120:123], v[64:67], v[80:83], v[120:123]
    ds_read_b64_tr_b16 v[52:53], v185 offset:32768
    ds_read_b64_tr_b16 v[54:55], v185 offset:33280
    v_mfma_f32_16x16x32_bf16 v[128:131], v[64:67], v[84:87], v[128:131]
    s_add_u32 m0, s73, 24576
    s_xor_b32 s75, s62, 640
    s_mul_i32 s75, s75, 1376
    buffer_load_dwordx4 v98, s[20:23], s75 offen offset:0 lds
    v_mfma_f32_16x16x32_bf16 v[136:139], v[56:59], v[84:87], v[136:139]
    s_waitcnt lgkmcnt(7)
    v_mfma_f32_16x16x32_bf16 v[100:103], v[36:39], v[72:75], v[100:103]
    ds_read_b128 v[80:83], v181 offset:49152
    ds_read_b64_tr_b16 v[60:61], v183 offset:28672
    s_waitcnt lgkmcnt(6)
    v_mfma_f32_16x16x32_bf16 v[108:111], v[36:39], v[76:79], v[108:111]
    ds_read_b64_tr_b16 v[62:63], v183 offset:29184
    s_add_u32 m0, s73, 32640
    s_nop 0
    buffer_load_dwordx4 v98, s[20:23], s75 offen offset:128 lds
    v_mfma_f32_16x16x32_bf16 v[116:119], v[40:43], v[72:75], v[116:119]
    ds_read_b64_tr_b16 v[64:65], v183 offset:36864
    ds_read_b64_tr_b16 v[66:67], v183 offset:37376
    v_mfma_f32_16x16x32_bf16 v[124:127], v[40:43], v[76:79], v[124:127]
    v_mfma_f32_16x16x32_bf16 v[132:135], v[44:47], v[72:75], v[132:135]
    v_mov_b32_dpp v68, v188 row_newbcast:7 row_mask:0xf bank_mask:0xf
    v_mov_b32_dpp v69, v189 row_newbcast:7 row_mask:0xf bank_mask:0xf
    v_mov_b32_dpp v70, v190 row_newbcast:7 row_mask:0xf bank_mask:0xf
    v_mov_b32_dpp v71, v191 row_newbcast:7 row_mask:0xf bank_mask:0xf
    s_waitcnt lgkmcnt(7)
    v_mfma_f32_16x16x32_bf16 v[104:107], v[48:51], v[72:75], v[104:107]
    ds_read_b128 v[84:87], v181 offset:51200
    ds_read_b64_tr_b16 v[36:37], v185 offset:28672
    v_mfma_f32_16x16x32_bf16 v[112:115], v[48:51], v[76:79], v[112:115]
    ds_read_b64_tr_b16 v[38:39], v185 offset:29184
    s_add_u32 m0, s73, 40704
    s_nop 0
    buffer_load_dwordx4 v99, s[20:23], s75 offen offset:256 lds
    s_waitcnt lgkmcnt(8)
    v_mfma_f32_16x16x32_bf16 v[120:123], v[52:55], v[72:75], v[120:123]
    ds_read_b64_tr_b16 v[40:41], v185 offset:36864
    ds_read_b64_tr_b16 v[42:43], v185 offset:37376
    v_mfma_f32_16x16x32_bf16 v[128:131], v[52:55], v[76:79], v[128:131]
    s_add_u32 m0, s72, 32768
    s_xor_b32 s74, s62, 768
    buffer_load_dwordx4 v96, s[4:7], s74 offen offset:0 lds
    v_mfma_f32_16x16x32_bf16 v[136:139], v[44:47], v[76:79], v[136:139]
    s_waitcnt vmcnt(6) lgkmcnt(0)
    s_barrier
    v_mfma_f32_16x16x32_bf16 v[100:103], v[60:63], v[80:83], v[100:103]
    ds_read_b128 v[72:75], v180 offset:0
    ds_read_b64_tr_b16 v[48:49], v182 offset:0
    v_mfma_f32_16x16x32_bf16 v[108:111], v[60:63], v[84:87], v[108:111]
    ds_read_b64_tr_b16 v[50:51], v182 offset:512
    buffer_load_dwordx4 v97, s[4:7], s74 offen offset:1024 lds
    v_mfma_f32_16x16x32_bf16 v[116:119], v[64:67], v[80:83], v[116:119]
    ds_read_b64_tr_b16 v[52:53], v182 offset:8192
    ds_read_b64_tr_b16 v[54:55], v182 offset:8704
    v_mfma_f32_16x16x32_bf16 v[124:127], v[64:67], v[84:87], v[124:127]
    v_mfma_f32_16x16x32_bf16 v[132:135], v[68:71], v[80:83], v[132:135]
    v_mov_b32_dpp v56, v188 row_newbcast:8 row_mask:0xf bank_mask:0xf
    v_mov_b32_dpp v57, v189 row_newbcast:8 row_mask:0xf bank_mask:0xf
    v_mov_b32_dpp v58, v190 row_newbcast:8 row_mask:0xf bank_mask:0xf
    v_mov_b32_dpp v59, v191 row_newbcast:8 row_mask:0xf bank_mask:0xf
    v_mfma_f32_16x16x32_bf16 v[104:107], v[36:39], v[80:83], v[104:107]
    ds_read_b128 v[76:79], v180 offset:2048
    ds_read_b64_tr_b16 v[60:61], v184 offset:0
    v_mfma_f32_16x16x32_bf16 v[112:115], v[36:39], v[84:87], v[112:115]
    ds_read_b64_tr_b16 v[62:63], v184 offset:512
    s_add_u32 m0, s73, 49152
    s_xor_b32 s75, s62, 768
    s_mul_i32 s75, s75, 1376
    buffer_load_dwordx4 v98, s[20:23], s75 offen offset:0 lds
    v_mfma_f32_16x16x32_bf16 v[120:123], v[40:43], v[80:83], v[120:123]
    ds_read_b64_tr_b16 v[64:65], v184 offset:8192
    ds_read_b64_tr_b16 v[66:67], v184 offset:8704
    v_mfma_f32_16x16x32_bf16 v[128:131], v[40:43], v[84:87], v[128:131]
    s_add_u32 m0, s73, 57216
    s_nop 0
    buffer_load_dwordx4 v98, s[20:23], s75 offen offset:128 lds
    v_mfma_f32_16x16x32_bf16 v[136:139], v[68:71], v[84:87], v[136:139]
    s_waitcnt lgkmcnt(7)
    v_mfma_f32_16x16x32_bf16 v[100:103], v[48:51], v[72:75], v[100:103]
    ds_read_b128 v[80:83], v181 offset:0
    ds_read_b64_tr_b16 v[36:37], v182 offset:4096
    s_waitcnt lgkmcnt(6)
    v_mfma_f32_16x16x32_bf16 v[108:111], v[48:51], v[76:79], v[108:111]
    ds_read_b64_tr_b16 v[38:39], v182 offset:4608
    s_add_u32 m0, s73, 65280
    s_nop 0
    buffer_load_dwordx4 v99, s[20:23], s75 offen offset:256 lds
    v_mfma_f32_16x16x32_bf16 v[116:119], v[52:55], v[72:75], v[116:119]
    ds_read_b64_tr_b16 v[40:41], v182 offset:12288
    ds_read_b64_tr_b16 v[42:43], v182 offset:12800
    v_mfma_f32_16x16x32_bf16 v[124:127], v[52:55], v[76:79], v[124:127]
    v_mfma_f32_16x16x32_bf16 v[132:135], v[56:59], v[72:75], v[132:135]
    v_mov_b32_dpp v44, v188 row_newbcast:9 row_mask:0xf bank_mask:0xf
    v_mov_b32_dpp v45, v189 row_newbcast:9 row_mask:0xf bank_mask:0xf
    v_mov_b32_dpp v46, v190 row_newbcast:9 row_mask:0xf bank_mask:0xf
    v_mov_b32_dpp v47, v191 row_newbcast:9 row_mask:0xf bank_mask:0xf
    s_and_b32 s76, s93, 15
    s_lshl_b32 s76, s76, 3
    s_add_u32 s76, s76, s64
    v_mov_b32 v30, 0x40000000
    v_lshlrev_b32 v31, 10, v1
    v_cmp_gt_u32 vcc, 11, v1
    s_mul_i32 s77, s76, 11264
    s_nop 0
    v_cndmask_b32 v19, v30, v31, vcc
    v_cmp_gt_u32 vcc, 4, v1
    s_lshl_b32 s76, s76, 12
    s_nop 0
    v_cndmask_b32 v31, v30, v31, vcc
LIGb_3:
    s_cmp_eq_u32 s63, 1
    s_cbranch_scc1 LIGb_ret
    buffer_load_dword v30, v19, s[28:31], s77 offen offset:384
    buffer_load_dword v31, v31, s[40:43], s76 offen offset:384
    s_waitcnt lgkmcnt(7)
    v_mfma_f32_16x16x32_bf16 v[104:107], v[60:63], v[72:75], v[104:107]
    ds_read_b128 v[84:87], v181 offset:2048
    ds_read_b64_tr_b16 v[48:49], v184 offset:4096
    v_mfma_f32_16x16x32_bf16 v[112:115], v[60:63], v[76:79], v[112:115]
    ds_read_b64_tr_b16 v[50:51], v184 offset:4608
    s_add_u32 m0, s72, 49152
    s_xor_b32 s74, s62, 896
    buffer_load_dwordx4 v96, s[4:7], s74 offen offset:0 lds
    s_waitcnt lgkmcnt(8)
    v_mfma_f32_16x16x32_bf16 v[120:123], v[64:67], v[72:75], v[120:123]
    ds_read_b64_tr_b16 v[52:53], v184 offset:12288
    ds_read_b64_tr_b16 v[54:55], v184 offset:12800
    v_mfma_f32_16x16x32_bf16 v[128:131], v[64:67], v[76:79], v[128:131]
    buffer_load_dwordx4 v97, s[4:7], s74 offen offset:1024 lds
    v_mfma_f32_16x16x32_bf16 v[136:139], v[56:59], v[76:79], v[136:139]
    s_waitcnt vmcnt(9) lgkmcnt(0)
    s_barrier
    v_mfma_f32_16x16x32_bf16 v[100:103], v[36:39], v[80:83], v[100:103]
    ds_read_b128 v[72:75], v180 offset:16384
    ds_read_b64_tr_b16 v[60:61], v182 offset:24576
    v_mfma_f32_16x16x32_bf16 v[108:111], v[36:39], v[84:87], v[108:111]
    ds_read_b64_tr_b16 v[62:63], v182 offset:25088
    s_add_u32 m0, s73, 73728
    s_xor_b32 s75, s62, 896
    s_mul_i32 s75, s75, 1376
    buffer_load_dwordx4 v98, s[20:23], s75 offen offset:0 lds
    v_mfma_f32_16x16x32_bf16 v[116:119], v[40:43], v[80:83], v[116:119]
    ds_read_b64_tr_b16 v[64:65], v182 offset:32768
    ds_read_b64_tr_b16 v[66:67], v182 offset:33280
    v_mfma_f32_16x16x32_bf16 v[124:127], v[40:43], v[84:87], v[124:127]
    v_mfma_f32_16x16x32_bf16 v[132:135], v[44:47], v[80:83], v[132:135]
    v_mov_b32_dpp v68, v188 row_newbcast:10 row_mask:0xf bank_mask:0xf
    v_mov_b32_dpp v69, v189 row_newbcast:10 row_mask:0xf bank_mask:0xf
    v_mov_b32_dpp v70, v190 row_newbcast:10 row_mask:0xf bank_mask:0xf
    v_mov_b32_dpp v71, v191 row_newbcast:10 row_mask:0xf bank_mask:0xf
    v_mfma_f32_16x16x32_bf16 v[104:107], v[48:51], v[80:83], v[104:107]
    ds_read_b128 v[76:79], v180 offset:18432
    ds_read_b64_tr_b16 v[36:37], v184 offset:24576
    v_mfma_f32_16x16x32_bf16 v[112:115], v[48:51], v[84:87], v[112:115]
    ds_read_b64_tr_b16 v[38:39], v184 offset:25088
    s_add_u32 m0, s73, 81792
    s_nop 0
    buffer_load_dwordx4 v98, s[20:23], s75 offen offset:128 lds
    v_mfma_f32_16x16x32_bf16 v[120:123], v[52:55], v[80:83], v[120:123]
    ds_read_b64_tr_b16 v[40:41], v184 offset:32768
    ds_read_b64_tr_b16 v[42:43], v184 offset:33280
    v_mfma_f32_16x16x32_bf16 v[128:131], v[52:55], v[84:87], v[128:131]
    s_add_u32 m0, s73, 89856
    s_nop 0
    buffer_load_dwordx4 v99, s[20:23], s75 offen offset:256 lds
    v_mfma_f32_16x16x32_bf16 v[136:139], v[44:47], v[84:87], v[136:139]
    s_waitcnt lgkmcnt(7)
    v_mfma_f32_16x16x32_bf16 v[100:103], v[60:63], v[72:75], v[100:103]
    ds_read_b128 v[80:83], v181 offset:16384
    ds_read_b64_tr_b16 v[48:49], v182 offset:28672
    s_waitcnt lgkmcnt(6)
    v_mfma_f32_16x16x32_bf16 v[108:111], v[60:63], v[76:79], v[108:111]
    ds_read_b64_tr_b16 v[50:51], v182 offset:29184
    s_add_u32 m0, s71, 65536
    s_add_u32 s77, s87, 0
    buffer_load_dwordx4 v4, s[28:31], s77 offen lds
    v_mfma_f32_16x16x32_bf16 v[116:119], v[64:67], v[72:75], v[116:119]
    ds_read_b64_tr_b16 v[52:53], v182 offset:36864
    ds_read_b64_tr_b16 v[54:55], v182 offset:37376
    v_mfma_f32_16x16x32_bf16 v[124:127], v[64:67], v[76:79], v[124:127]
    v_mfma_f32_16x16x32_bf16 v[132:135], v[68:71], v[72:75], v[132:135]
    v_mov_b32_dpp v56, v188 row_newbcast:11 row_mask:0xf bank_mask:0xf
    v_mov_b32_dpp v57, v189 row_newbcast:11 row_mask:0xf bank_mask:0xf
    v_mov_b32_dpp v58, v190 row_newbcast:11 row_mask:0xf bank_mask:0xf
    v_mov_b32_dpp v59, v191 row_newbcast:11 row_mask:0xf bank_mask:0xf
    s_waitcnt lgkmcnt(7)
    v_mfma_f32_16x16x32_bf16 v[104:107], v[36:39], v[72:75], v[104:107]
    ds_read_b128 v[84:87], v181 offset:18432
    ds_read_b64_tr_b16 v[60:61], v184 offset:28672
    v_mfma_f32_16x16x32_bf16 v[112:115], v[36:39], v[76:79], v[112:115]
    ds_read_b64_tr_b16 v[62:63], v184 offset:29184
    s_add_u32 m0, s71, 73728
    s_add_u32 s77, s87, 16384
    buffer_load_dwordx4 v4, s[28:31], s77 offen lds
    s_waitcnt lgkmcnt(8)
    v_mfma_f32_16x16x32_bf16 v[120:123], v[40:43], v[72:75], v[120:123]
    ds_read_b64_tr_b16 v[64:65], v184 offset:36864
    ds_read_b64_tr_b16 v[66:67], v184 offset:37376
    v_mfma_f32_16x16x32_bf16 v[128:131], v[40:43], v[76:79], v[128:131]
    v_mfma_f32_16x16x32_bf16 v[136:139], v[68:71], v[76:79], v[136:139]
    s_waitcnt vmcnt(9) lgkmcnt(0)
    s_barrier
    v_mfma_f32_16x16x32_bf16 v[100:103], v[48:51], v[80:83], v[100:103]
    ds_read_b128 v[72:75], v180 offset:32768
    ds_read_b64_tr_b16 v[36:37], v183 offset:0
    v_mfma_f32_16x16x32_bf16 v[108:111], v[48:51], v[84:87], v[108:111]
    ds_read_b64_tr_b16 v[38:39], v183 offset:512
    s_add_u32 m0, s71, 0
    s_add_u32 s77, s87, 8192
    buffer_load_dwordx4 v4, s[28:31], s77 offen lds
    v_mfma_f32_16x16x32_bf16 v[116:119], v[52:55], v[80:83], v[116:119]
    ds_read_b64_tr_b16 v[40:41], v183 offset:8192
    ds_read_b64_tr_b16 v[42:43], v183 offset:8704
    v_mfma_f32_16x16x32_bf16 v[124:127], v[52:55], v[84:87], v[124:127]
    v_mfma_f32_16x16x32_bf16 v[132:135], v[56:59], v[80:83], v[132:135]
    v_mov_b32_dpp v44, v188 row_newbcast:12 row_mask:0xf bank_mask:0xf
    v_mov_b32_dpp v45, v189 row_newbcast:12 row_mask:0xf bank_mask:0xf
    v_mov_b32_dpp v46, v190 row_newbcast:12 row_mask:0xf bank_mask:0xf
    v_mov_b32_dpp v47, v191 row_newbcast:12 row_mask:0xf bank_mask:0xf
    s_buffer_load_dword s94, s[24:27], 0
    v_mfma_f32_16x16x32_bf16 v[104:107], v[60:63], v[80:83], v[104:107]
    ds_read_b128 v[76:79], v180 offset:34816
    ds_read_b64_tr_b16 v[48:49], v185 offset:0
    v_mfma_f32_16x16x32_bf16 v[112:115], v[60:63], v[84:87], v[112:115]
    ds_read_b64_tr_b16 v[50:51], v185 offset:512
    s_add_u32 m0, s71, 8192
    s_add_u32 s77, s87, 24576
    buffer_load_dwordx4 v4, s[28:31], s77 offen lds
    v_mfma_f32_16x16x32_bf16 v[120:123], v[64:67], v[80:83], v[120:123]
    ds_read_b64_tr_b16 v[52:53], v185 offset:8192
    ds_read_b64_tr_b16 v[54:55], v185 offset:8704
    v_mfma_f32_16x16x32_bf16 v[128:131], v[64:67], v[84:87], v[128:131]
    s_add_u32 m0, s71, 81920
    s_add_u32 s77, s87, 65536
    buffer_load_dwordx4 v4, s[28:31], s77 offen lds
    v_mfma_f32_16x16x32_bf16 v[136:139], v[56:59], v[84:87], v[136:139]
    s_waitcnt lgkmcnt(7)
    v_mfma_f32_16x16x32_bf16 v[100:103], v[36:39], v[72:75], v[100:103]
    ds_read_b128 v[80:83], v181 offset:32768
    ds_read_b64_tr_b16 v[60:61], v183 offset:4096
    s_waitcnt lgkmcnt(6)
    v_mfma_f32_16x16x32_bf16 v[108:111], v[36:39], v[76:79], v[108:111]
    ds_read_b64_tr_b16 v[62:63], v183 offset:4608
    s_add_u32 m0, s71, 90112
    s_add_u32 s77, s87, 81920
    buffer_load_dwordx4 v4, s[28:31], s77 offen lds
    v_mfma_f32_16x16x32_bf16 v[116:119], v[40:43], v[72:75], v[116:119]
LIGb_4:
    s_cmp_eq_u32 s63, 1
    s_cbranch_scc1 LIGb_ret
    ds_read_b64_tr_b16 v[64:65], v183 offset:12288
    ds_read_b64_tr_b16 v[66:67], v183 offset:12800
    v_mfma_f32_16x16x32_bf16 v[124:127], v[40:43], v[76:79], v[124:127]
    v_mfma_f32_16x16x32_bf16 v[132:135], v[44:47], v[72:75], v[132:135]
    v_mov_b32_dpp v68, v188 row_newbcast:13 row_mask:0xf bank_mask:0xf
    v_mov_b32_dpp v69, v189 row_newbcast:13 row_mask:0xf bank_mask:0xf
    v_mov_b32_dpp v70, v190 row_newbcast:13 row_mask:0xf bank_mask:0xf
    v_mov_b32_dpp v71, v191 row_newbcast:13 row_mask:0xf bank_mask:0xf
    s_waitcnt lgkmcnt(7)
    v_mfma_f32_16x16x32_bf16 v[104:107], v[48:51], v[72:75], v[104:107]
    ds_read_b128 v[84:87], v181 offset:34816
    ds_read_b64_tr_b16 v[36:37], v185 offset:4096
    v_mfma_f32_16x16x32_bf16 v[112:115], v[48:51], v[76:79], v[112:115]
    ds_read_b64_tr_b16 v[38:39], v185 offset:4608
    s_add_u32 m0, s71, 98304
    s_add_u32 s77, s87, 73728
    buffer_load_dwordx4 v4, s[28:31], s77 offen lds
    s_waitcnt lgkmcnt(8)
    v_mfma_f32_16x16x32_bf16 v[120:123], v[52:55], v[72:75], v[120:123]
    ds_read_b64_tr_b16 v[40:41], v185 offset:12288
    ds_read_b64_tr_b16 v[42:43], v185 offset:12800
    v_mfma_f32_16x16x32_bf16 v[128:131], v[52:55], v[76:79], v[128:131]
    v_mfma_f32_16x16x32_bf16 v[136:139], v[44:47], v[76:79], v[136:139]
    s_waitcnt lgkmcnt(0)
    s_cmp_lg_u32 s94, 0
    s_cbranch_scc0 Lretry_103i
Lok_102:
    s_mov_b32 s95, s94
    v_mov_b32 v17, s94
    s_waitcnt vmcnt(7)
    s_barrier
    v_mfma_f32_16x16x32_bf16 v[100:103], v[60:63], v[80:83], v[100:103]
    ds_read_b128 v[72:75], v180 offset:49152
    ds_read_b64_tr_b16 v[48:49], v183 offset:24576
    v_mfma_f32_16x16x32_bf16 v[108:111], v[60:63], v[84:87], v[108:111]
    ds_read_b64_tr_b16 v[50:51], v183 offset:25088
    s_add_u32 m0, s71, 16384
    s_add_u32 s77, s87, 90112
    buffer_load_dwordx4 v4, s[28:31], s77 offen lds
    v_mfma_f32_16x16x32_bf16 v[116:119], v[64:67], v[80:83], v[116:119]
    ds_read_b64_tr_b16 v[52:53], v183 offset:32768
    ds_read_b64_tr_b16 v[54:55], v183 offset:33280
    v_mfma_f32_16x16x32_bf16 v[124:127], v[64:67], v[84:87], v[124:127]
    v_mfma_f32_16x16x32_bf16 v[132:135], v[68:71], v[80:83], v[132:135]
    v_mov_b32_dpp v56, v188 row_newbcast:14 row_mask:0xf bank_mask:0xf
    v_mov_b32_dpp v57, v189 row_newbcast:14 row_mask:0xf bank_mask:0xf
    v_mov_b32_dpp v58, v190 row_newbcast:14 row_mask:0xf bank_mask:0xf
    v_mov_b32_dpp v59, v191 row_newbcast:14 row_mask:0xf bank_mask:0xf
    v_mfma_f32_16x16x32_bf16 v[104:107], v[36:39], v[80:83], v[104:107]
    ds_read_b128 v[76:79], v180 offset:51200
    ds_read_b64_tr_b16 v[60:61], v185 offset:24576
    v_mfma_f32_16x16x32_bf16 v[112:115], v[36:39], v[84:87], v[112:115]
    ds_read_b64_tr_b16 v[62:63], v185 offset:25088
    s_add_u32 m0, s71, 24576
    s_add_u32 s77, s87, 131072
    buffer_load_dwordx4 v4, s[28:31], s77 offen lds
    v_mfma_f32_16x16x32_bf16 v[120:123], v[40:43], v[80:83], v[120:123]
    ds_read_b64_tr_b16 v[64:65], v185 offset:32768
    ds_read_b64_tr_b16 v[66:67], v185 offset:33280
    v_mfma_f32_16x16x32_bf16 v[128:131], v[40:43], v[84:87], v[128:131]
    s_add_u32 m0, s71, 106496
    s_add_u32 s77, s87, 147456
    buffer_load_dwordx4 v4, s[28:31], s77 offen lds
    v_mfma_f32_16x16x32_bf16 v[136:139], v[68:71], v[84:87], v[136:139]
    s_waitcnt lgkmcnt(7)
    v_mfma_f32_16x16x32_bf16 v[100:103], v[48:51], v[72:75], v[100:103]
    ds_read_b128 v[80:83], v181 offset:49152
    ds_read_b64_tr_b16 v[36:37], v183 offset:28672
    s_waitcnt lgkmcnt(6)
    v_mfma_f32_16x16x32_bf16 v[108:111], v[48:51], v[76:79], v[108:111]
    ds_read_b64_tr_b16 v[38:39], v183 offset:29184
    s_add_u32 m0, s71, 114688
    s_add_u32 s77, s87, 139264
    buffer_load_dwordx4 v4, s[28:31], s77 offen lds
    v_mfma_f32_16x16x32_bf16 v[116:119], v[52:55], v[72:75], v[116:119]
    ds_read_b64_tr_b16 v[40:41], v183 offset:36864
    ds_read_b64_tr_b16 v[42:43], v183 offset:37376
    v_mfma_f32_16x16x32_bf16 v[124:127], v[52:55], v[76:79], v[124:127]
    v_mfma_f32_16x16x32_bf16 v[132:135], v[56:59], v[72:75], v[132:135]
    v_mov_b32_dpp v44, v188 row_newbcast:15 row_mask:0xf bank_mask:0xf
    v_mov_b32_dpp v45, v189 row_newbcast:15 row_mask:0xf bank_mask:0xf
    v_mov_b32_dpp v46, v190 row_newbcast:15 row_mask:0xf bank_mask:0xf
    v_mov_b32_dpp v47, v191 row_newbcast:15 row_mask:0xf bank_mask:0xf
    s_waitcnt lgkmcnt(7)
    v_mfma_f32_16x16x32_bf16 v[104:107], v[60:63], v[72:75], v[104:107]
    ds_read_b128 v[84:87], v181 offset:51200
    ds_read_b64_tr_b16 v[48:49], v185 offset:28672
    v_mfma_f32_16x16x32_bf16 v[112:115], v[60:63], v[76:79], v[112:115]
    ds_read_b64_tr_b16 v[50:51], v185 offset:29184
    s_add_u32 m0, s71, 122880
    s_add_u32 s77, s87, 155648
    buffer_load_dwordx4 v4, s[28:31], s77 offen lds
    s_waitcnt lgkmcnt(8)
    v_mfma_f32_16x16x32_bf16 v[120:123], v[64:67], v[72:75], v[120:123]
    ds_read_b64_tr_b16 v[52:53], v185 offset:36864
    ds_read_b64_tr_b16 v[54:55], v185 offset:37376
    v_mfma_f32_16x16x32_bf16 v[128:131], v[64:67], v[76:79], v[128:131]
    v_mfma_f32_16x16x32_bf16 v[136:139], v[56:59], v[76:79], v[136:139]
    s_waitcnt lgkmcnt(7)
    v_mfma_f32_16x16x32_bf16 v[100:103], v[36:39], v[80:83], v[100:103]
    s_waitcnt lgkmcnt(4)
    v_mfma_f32_16x16x32_bf16 v[108:111], v[36:39], v[84:87], v[108:111]
    s_add_u32 m0, s71, 32768
    s_add_u32 s77, s87, 32768
    buffer_load_dwordx4 v4, s[28:31], s77 offen lds
    v_mfma_f32_16x16x32_bf16 v[116:119], v[40:43], v[80:83], v[116:119]
    v_mfma_f32_16x16x32_bf16 v[124:127], v[40:43], v[84:87], v[124:127]
    v_mfma_f32_16x16x32_bf16 v[132:135], v[44:47], v[80:83], v[132:135]
    s_waitcnt lgkmcnt(2)
    v_mfma_f32_16x16x32_bf16 v[104:107], v[48:51], v[80:83], v[104:107]
    v_mfma_f32_16x16x32_bf16 v[112:115], v[48:51], v[84:87], v[112:115]
    s_add_u32 m0, s71, 40960
    s_add_u32 s77, s87, 49152
    buffer_load_dwordx4 v4, s[28:31], s77 offen lds
    s_waitcnt lgkmcnt(0)
    v_mfma_f32_16x16x32_bf16 v[120:123], v[52:55], v[80:83], v[120:123]
    v_mfma_f32_16x16x32_bf16 v[128:131], v[52:55], v[84:87], v[128:131]
    s_add_u32 m0, s71, 131072
    s_add_u32 s77, s87, 40960
    buffer_load_dwordx4 v4, s[28:31], s77 offen lds
    v_mfma_f32_16x16x32_bf16 v[136:139], v[44:47], v[84:87], v[136:139]
LDGb:
    s_setprio 3
    s_mov_b32 vcc_lo, 0xffff0000
    s_mov_b32 vcc_hi, 0xffff0000
    s_nop 4
    v_cndmask_b32 v132, v132, v136, vcc
    v_mul_f32 v30, 0x3fb8aa3b, v132
    v_min_f32 v30, 0x42ac0000, v30
    v_exp_f32 v30, v30
    s_nop 0
    buffer_store_dword v30, v35, s[36:39], 0 offen sc1
    s_mov_b32 s63, 2
    s_cmp_eq_u32 s64, 4
    s_cbranch_scc1 LJGb_0
    s_cmp_eq_u32 s64, 5
    s_cbranch_scc1 LJGb_1
    s_cmp_eq_u32 s64, 6
    s_cbranch_scc1 LJGb_2
    s_cmp_eq_u32 s64, 7
    s_cbranch_scc1 LJGb_3
LJGb_5:
LJGb_6:
LJGb_7:
LJGb_8:
LJGb_ret:
    s_mov_b32 s63, 0
    s_waitcnt vmcnt(0)
    buffer_store_dword v17, v34, s[36:39], 0 offen sc1
    s_setprio 1
    v_pk_mul_f32 v[148:149], v[100:101], v[100:101]
LIGb_5:
    s_cmp_eq_u32 s63, 1
    s_cbranch_scc1 LIGb_ret
LJGb_0:
    s_cmp_eq_u32 s63, 2
    s_cbranch_scc1 LJGb_4
    v_pk_mul_f32 v[150:151], v[102:103], v[102:103]
    v_pk_mul_f32 v[152:153], v[104:105], v[104:105]
    v_pk_mul_f32 v[154:155], v[106:107], v[106:107]
    v_pk_fma_f32 v[148:149], v[148:149], s[82:83], v[186:187]
    v_pk_fma_f32 v[150:151], v[150:151], s[82:83], v[186:187]
    v_pk_fma_f32 v[152:153], v[152:153], s[82:83], v[186:187]
    v_pk_fma_f32 v[154:155], v[154:155], s[82:83], v[186:187]
    v_pk_mul_f32 v[148:149], v[148:149], v[100:101]
    v_pk_mul_f32 v[150:151], v[150:151], v[102:103]
    v_pk_mul_f32 v[152:153], v[152:153], v[104:105]
    v_pk_mul_f32 v[154:155], v[154:155], v[106:107]
    v_exp_f32 v148, v148
    v_exp_f32 v149, v149
    v_exp_f32 v150, v150
    v_exp_f32 v151, v151
    v_exp_f32 v152, v152
    v_exp_f32 v153, v153
    v_exp_f32 v154, v154
    v_exp_f32 v155, v155
    v_pk_add_f32 v[148:149], v[148:149], s[84:85]
    v_pk_add_f32 v[150:151], v[150:151], s[84:85]
    v_pk_add_f32 v[152:153], v[152:153], s[84:85]
    v_pk_add_f32 v[154:155], v[154:155], s[84:85]
    v_rcp_f32 v148, v148
    v_rcp_f32 v149, v149
    v_rcp_f32 v150, v150
    v_rcp_f32 v151, v151
    v_rcp_f32 v152, v152
    v_rcp_f32 v153, v153
    ds_read_b64_tr_b16 v[196:197], v7 offset:0
    ds_read_b64_tr_b16 v[198:199], v7 offset:8192
    ds_read_b64_tr_b16 v[200:201], v8 offset:0
    ds_read_b64_tr_b16 v[202:203], v8 offset:8192
    v_rcp_f32 v154, v154
    v_rcp_f32 v155, v155
    v_pk_mul_f32 v[148:149], v[148:149], v[100:101]
    v_pk_mul_f32 v[150:151], v[150:151], v[102:103]
    v_pk_mul_f32 v[152:153], v[152:153], v[104:105]
    v_pk_mul_f32 v[154:155], v[154:155], v[106:107]
    v_cvt_pk_bf16_f32 v156, v148, v149
    v_cvt_pk_bf16_f32 v157, v150, v151
    v_cvt_pk_bf16_f32 v158, v152, v153
    v_cvt_pk_bf16_f32 v159, v154, v155
    v_pk_mul_f32 v[164:165], v[108:109], v[108:109]
    v_pk_mul_f32 v[166:167], v[110:111], v[110:111]
    s_add_u32 s76, s86, 131072
    buffer_store_dwordx4 v[156:159], v28, s[36:39], s76 offen offset:0 sc1
    v_pk_mul_f32 v[168:169], v[112:113], v[112:113]
    v_pk_mul_f32 v[170:171], v[114:115], v[114:115]
    v_pk_fma_f32 v[164:165], v[164:165], s[82:83], v[186:187]
    v_pk_fma_f32 v[166:167], v[166:167], s[82:83], v[186:187]
    v_pk_fma_f32 v[168:169], v[168:169], s[82:83], v[186:187]
    v_pk_fma_f32 v[170:171], v[170:171], s[82:83], v[186:187]
    v_pk_mul_f32 v[164:165], v[164:165], v[108:109]
    v_pk_mul_f32 v[166:167], v[166:167], v[110:111]
    v_pk_mul_f32 v[168:169], v[168:169], v[112:113]
    v_pk_mul_f32 v[170:171], v[170:171], v[114:115]
    v_exp_f32 v164, v164
    v_exp_f32 v165, v165
    v_exp_f32 v166, v166
    v_exp_f32 v167, v167
    v_exp_f32 v168, v168
    v_exp_f32 v169, v169
    v_exp_f32 v170, v170
    s_waitcnt lgkmcnt(0)
    s_add_u32 m0, s71, 65536
    s_add_u32 s77, s87, 57344
    buffer_load_dwordx4 v4, s[28:31], s77 offen lds
    ds_read_b64_tr_b16 v[204:205], v5 offset:0
    ds_read_b64_tr_b16 v[206:207], v5 offset:8192
    ds_read_b64_tr_b16 v[208:209], v6 offset:0
    ds_read_b64_tr_b16 v[210:211], v6 offset:8192
    v_exp_f32 v171, v171
    v_pk_add_f32 v[164:165], v[164:165], s[84:85]
    v_pk_add_f32 v[166:167], v[166:167], s[84:85]
    v_pk_add_f32 v[168:169], v[168:169], s[84:85]
    v_pk_add_f32 v[170:171], v[170:171], s[84:85]
    v_rcp_f32 v164, v164
    v_rcp_f32 v165, v165
    v_rcp_f32 v166, v166
    v_rcp_f32 v167, v167
    v_rcp_f32 v168, v168
    v_rcp_f32 v169, v169
    v_rcp_f32 v170, v170
    v_rcp_f32 v171, v171
    v_pk_mul_f32 v[164:165], v[164:165], v[108:109]
    v_pk_mul_f32 v[166:167], v[166:167], v[110:111]
    v_pk_mul_f32 v[168:169], v[168:169], v[112:113]
    v_pk_mul_f32 v[170:171], v[170:171], v[114:115]
    v_cvt_pk_bf16_f32 v160, v164, v165
    v_cvt_pk_bf16_f32 v161, v166, v167
    v_cvt_pk_bf16_f32 v162, v168, v169
    v_cvt_pk_bf16_f32 v163, v170, v171
    s_add_u32 s76, s86, 131072
    buffer_store_dwordx4 v[160:163], v28, s[36:39], s76 offen offset:256 sc1
    v_pk_mul_f32 v[148:149], v[116:117], v[116:117]
    v_pk_mul_f32 v[150:151], v[118:119], v[118:119]
    v_pk_mul_f32 v[152:153], v[120:121], v[120:121]
    v_pk_mul_f32 v[154:155], v[122:123], v[122:123]
    v_pk_fma_f32 v[148:149], v[148:149], s[82:83], v[186:187]
    v_pk_fma_f32 v[150:151], v[150:151], s[82:83], v[186:187]
    v_pk_fma_f32 v[152:153], v[152:153], s[82:83], v[186:187]
    v_pk_fma_f32 v[154:155], v[154:155], s[82:83], v[186:187]
    v_pk_mul_f32 v[148:149], v[148:149], v[116:117]
    v_pk_mul_f32 v[150:151], v[150:151], v[118:119]
    v_pk_mul_f32 v[152:153], v[152:153], v[120:121]
    v_pk_mul_f32 v[154:155], v[154:155], v[122:123]
    v_exp_f32 v148, v148
    v_exp_f32 v149, v149
    v_exp_f32 v150, v150
    v_exp_f32 v151, v151
    v_exp_f32 v152, v152
    v_exp_f32 v153, v153
    v_exp_f32 v154, v154
    v_exp_f32 v155, v155
    v_pk_add_f32 v[148:149], v[148:149], s[84:85]
    v_pk_add_f32 v[150:151], v[150:151], s[84:85]
    v_pk_add_f32 v[152:153], v[152:153], s[84:85]
    v_pk_add_f32 v[154:155], v[154:155], s[84:85]
    v_rcp_f32 v148, v148
    v_rcp_f32 v149, v149
    v_rcp_f32 v150, v150
    v_rcp_f32 v151, v151
    v_rcp_f32 v152, v152
    v_rcp_f32 v153, v153
    s_add_u32 m0, s71, 73728
    s_add_u32 s77, s87, 98304
    buffer_load_dwordx4 v4, s[28:31], s77 offen lds
    v_rcp_f32 v154, v154
    v_rcp_f32 v155, v155
    v_pk_mul_f32 v[148:149], v[148:149], v[116:117]
    v_pk_mul_f32 v[150:151], v[150:151], v[118:119]
    v_pk_mul_f32 v[152:153], v[152:153], v[120:121]
    v_pk_mul_f32 v[154:155], v[154:155], v[122:123]
    v_cvt_pk_bf16_f32 v172, v148, v149
    v_cvt_pk_bf16_f32 v173, v150, v151
    v_cvt_pk_bf16_f32 v174, v152, v153
    v_cvt_pk_bf16_f32 v175, v154, v155
    v_pk_mul_f32 v[164:165], v[124:125], v[124:125]
    v_pk_mul_f32 v[166:167], v[126:127], v[126:127]
    s_add_u32 s76, s86, 393216
    buffer_store_dwordx4 v[172:175], v28, s[36:39], s76 offen offset:0 sc1
    v_pk_mul_f32 v[168:169], v[128:129], v[128:129]
    v_pk_mul_f32 v[170:171], v[130:131], v[130:131]
    v_pk_fma_f32 v[164:165], v[164:165], s[82:83], v[186:187]
    v_pk_fma_f32 v[166:167], v[166:167], s[82:83], v[186:187]
    v_pk_fma_f32 v[168:169], v[168:169], s[82:83], v[186:187]
    v_pk_fma_f32 v[170:171], v[170:171], s[82:83], v[186:187]
    v_pk_mul_f32 v[164:165], v[164:165], v[124:125]
    v_pk_mul_f32 v[166:167], v[166:167], v[126:127]
    v_pk_mul_f32 v[168:169], v[168:169], v[128:129]
LIGb_6:
    s_cmp_eq_u32 s63, 1
    s_cbranch_scc1 LIGb_ret
LJGb_1:
    s_cmp_eq_u32 s63, 2
    s_cbranch_scc1 LJGb_5
    v_pk_mul_f32 v[170:171], v[170:171], v[130:131]
    v_exp_f32 v164, v164
    v_exp_f32 v165, v165
    v_exp_f32 v166, v166
    v_exp_f32 v167, v167
    v_exp_f32 v168, v168
    v_exp_f32 v169, v169
    v_exp_f32 v170, v170
    s_waitcnt lgkmcnt(0)
    s_add_u32 m0, s71, 0
    s_add_u32 s77, s87, 114688
    buffer_load_dwordx4 v4, s[28:31], s77 offen lds
    ds_read_b64_tr_b16 v[212:213], v7 offset:16384
    ds_read_b64_tr_b16 v[214:215], v7 offset:24576
    ds_read_b64_tr_b16 v[216:217], v8 offset:16384
    ds_read_b64_tr_b16 v[218:219], v8 offset:24576
    v_exp_f32 v171, v171
    v_pk_add_f32 v[164:165], v[164:165], s[84:85]
    v_pk_add_f32 v[166:167], v[166:167], s[84:85]
    v_pk_add_f32 v[168:169], v[168:169], s[84:85]
    v_pk_add_f32 v[170:171], v[170:171], s[84:85]
    v_rcp_f32 v164, v164
    v_rcp_f32 v165, v165
    v_rcp_f32 v166, v166
    v_rcp_f32 v167, v167
    v_rcp_f32 v168, v168
    v_rcp_f32 v169, v169
    v_rcp_f32 v170, v170
    v_rcp_f32 v171, v171
    v_pk_mul_f32 v[164:165], v[164:165], v[124:125]
    v_pk_mul_f32 v[166:167], v[166:167], v[126:127]
    v_pk_mul_f32 v[168:169], v[168:169], v[128:129]
    v_pk_mul_f32 v[170:171], v[170:171], v[130:131]
    v_cvt_pk_bf16_f32 v176, v164, v165
    v_cvt_pk_bf16_f32 v177, v166, v167
    v_cvt_pk_bf16_f32 v178, v168, v169
    v_cvt_pk_bf16_f32 v179, v170, v171
    s_add_u32 s76, s86, 393216
    buffer_store_dwordx4 v[176:179], v28, s[36:39], s76 offen offset:256 sc1
    s_waitcnt vmcnt(4)
    buffer_store_dword v17, v13, s[36:39], 0 offen offset:8 sc1
    s_buffer_load_dwordx16 s[4:19], s[36:39], s96 offset:16384 glc
    s_barrier
    s_waitcnt vmcnt(1)
    buffer_store_dword v17, v13, s[36:39], 0 offen offset:24 sc1
    s_waitcnt lgkmcnt(0)
    s_cmp_eq_u64 s[4:5], s[94:95]
    s_cselect_b32 s79, 0, 0x40000000
    s_or_b32 s75, s89, s79
    buffer_load_dwordx4 v[132:135], v11, s[36:39], s75 offen offset:0 sc1
    buffer_load_dwordx4 v[136:139], v12, s[36:39], s75 offen offset:0 sc1
    buffer_load_dwordx4 v[140:143], v11, s[36:39], s75 offen offset:1024 sc1
    buffer_load_dwordx4 v[144:147], v12, s[36:39], s75 offen offset:1024 sc1
    s_cmp_eq_u64 s[8:9], s[94:95]
    s_cselect_b32 s80, 0, 0x40000000
    s_add_u32 s75, s89, 262144
    s_or_b32 s75, s75, s80
    buffer_load_dwordx4 v[100:103], v11, s[36:39], s75 offen offset:0 sc1
    buffer_load_dwordx4 v[104:107], v12, s[36:39], s75 offen offset:0 sc1
    buffer_load_dwordx4 v[108:111], v11, s[36:39], s75 offen offset:1024 sc1
    buffer_load_dwordx4 v[112:115], v12, s[36:39], s75 offen offset:1024 sc1
    s_cmp_eq_u64 s[12:13], s[94:95]
    s_cselect_b32 s81, 0, 0x40000000
    s_add_u32 s75, s89, 524288
    s_or_b32 s75, s75, s81
    buffer_load_dwordx4 v[116:119], v11, s[36:39], s75 offen offset:0 sc1
    buffer_load_dwordx4 v[120:123], v12, s[36:39], s75 offen offset:0 sc1
    buffer_load_dwordx4 v[124:127], v11, s[36:39], s75 offen offset:1024 sc1
    buffer_load_dwordx4 v[128:131], v12, s[36:39], s75 offen offset:1024 sc1
    s_buffer_load_dwordx16 s[4:19], s[36:39], s96 offset:16384 glc
    s_cmp_eq_u32 s79, 0
    s_cbranch_scc0 Lcfix_105i
Lcok_104:
    s_cmp_eq_u32 s80, 0
    s_cbranch_scc0 Lcfix_107i
Lcok_106:
    s_add_u32 m0, s71, 8192
    s_add_u32 s77, s87, 106496
    buffer_load_dwordx4 v4, s[28:31], s77 offen lds
    s_add_u32 m0, s71, 81920
    s_add_u32 s77, s87, 122880
    buffer_load_dwordx4 v4, s[28:31], s77 offen lds
    s_add_u32 m0, s71, 90112
    s_add_u32 s77, s88, 0
    buffer_load_dwordx4 v4, s[40:43], s77 offen lds
    s_add_u32 m0, s71, 139264
    s_add_u32 s77, s88, 16384
    buffer_load_dwordx4 v4, s[40:43], s77 offen lds
    s_add_u32 m0, s71, 147456
    s_add_u32 s77, s88, 8192
    buffer_load_dwordx4 v4, s[40:43], s77 offen lds
    s_add_u32 m0, s71, 49152
    s_add_u32 s77, s88, 24576
    buffer_load_dwordx4 v4, s[40:43], s77 offen lds
    s_add_u32 m0, s71, 57344
    s_add_u32 s77, s88, 32768
    buffer_load_dwordx4 v4, s[40:43], s77 offen lds
    s_add_u32 m0, s71, 155648
    s_add_u32 s77, s88, 49152
    buffer_load_dwordx4 v4, s[40:43], s77 offen lds
    s_setprio 0
    s_waitcnt vmcnt(8)
    v_mfma_f32_32x32x16_bf16 v[36:51], v[196:199], v[132:135], 0
    v_mfma_f32_32x32x16_bf16 v[52:67], v[200:203], v[132:135], 0
    v_mfma_f32_32x32x16_bf16 v[68:83], v[196:199], v[136:139], 0
    v_mfma_f32_32x32x16_bf16 v[84:99], v[200:203], v[136:139], 0
    ds_read_b64_tr_b16 v[220:221], v7 offset:32768
    ds_read_b64_tr_b16 v[222:223], v5 offset:16384
    ds_read_b64_tr_b16 v[224:225], v8 offset:32768
    ds_read_b64_tr_b16 v[226:227], v6 offset:16384
    v_mfma_f32_32x32x16_bf16 v[36:51], v[204:207], v[140:143], v[36:51]
    v_mfma_f32_32x32x16_bf16 v[52:67], v[208:211], v[140:143], v[52:67]
    v_mfma_f32_32x32x16_bf16 v[68:83], v[204:207], v[144:147], v[68:83]
    v_mfma_f32_32x32x16_bf16 v[84:99], v[208:211], v[144:147], v[84:99]
    s_cmp_eq_u32 s81, 0
    s_cbranch_scc0 Lcfix_109i
Lcok_108:
    s_cmp_eq_u64 s[6:7], s[94:95]
    s_cselect_b32 s73, 0, 0x40000000
    s_add_u32 s75, s89, 131072
    s_or_b32 s75, s75, s73
    buffer_load_dwordx4 v[148:151], v11, s[36:39], s75 offen offset:0 sc1
    buffer_load_dwordx4 v[152:155], v12, s[36:39], s75 offen offset:0 sc1
    buffer_load_dwordx4 v[156:159], v11, s[36:39], s75 offen offset:1024 sc1
    buffer_load_dwordx4 v[160:163], v12, s[36:39], s75 offen offset:1024 sc1
    s_buffer_load_dwordx16 s[4:19], s[36:39], s96 offset:16384 glc
    ds_read_b64_tr_b16 v[228:229], v5 offset:24576
    ds_read_b64_tr_b16 v[230:231], v7 offset:40960
    ds_read_b64_tr_b16 v[232:233], v6 offset:24576
    ds_read_b64_tr_b16 v[234:235], v8 offset:40960
    v_mfma_f32_32x32x16_bf16 v[36:51], v[212:215], v[100:103], v[36:51]
    v_mfma_f32_32x32x16_bf16 v[52:67], v[216:219], v[100:103], v[52:67]
    v_mfma_f32_32x32x16_bf16 v[68:83], v[212:215], v[104:107], v[68:83]
    v_mfma_f32_32x32x16_bf16 v[84:99], v[216:219], v[104:107], v[84:99]
    ds_read_b64_tr_b16 v[236:237], v7 offset:49152
    ds_read_b64_tr_b16 v[238:239], v7 offset:57344
    ds_read_b64_tr_b16 v[240:241], v8 offset:49152
    ds_read_b64_tr_b16 v[242:243], v8 offset:57344
    s_waitcnt lgkmcnt(10)
    v_mfma_f32_32x32x16_bf16 v[36:51], v[220:223], v[108:111], v[36:51]
    s_waitcnt lgkmcnt(8)
    v_mfma_f32_32x32x16_bf16 v[52:67], v[224:227], v[108:111], v[52:67]
    s_add_u32 m0, s71, 98304
    s_add_u32 s77, s88, 40960
    buffer_load_dwordx4 v4, s[40:43], s77 offen lds
    v_mfma_f32_32x32x16_bf16 v[68:83], v[220:223], v[112:115], v[68:83]
    s_add_u32 m0, s71, 16384
    s_add_u32 s77, s88, 57344
    buffer_load_dwordx4 v4, s[40:43], s77 offen lds
    v_mfma_f32_32x32x16_bf16 v[84:99], v[224:227], v[112:115], v[84:99]
    s_cmp_eq_u32 s73, 0
    s_cbranch_scc0 Lcfix_111i
Lcok_110:
LIGb_7:
    s_cmp_eq_u32 s63, 1
    s_cbranch_scc1 LIGb_ret
LJGb_2:
    s_cmp_eq_u32 s63, 2
    s_cbranch_scc1 LJGb_6
    s_cmp_eq_u64 s[10:11], s[94:95]
    s_cselect_b32 s79, 0, 0x40000000
    s_add_u32 s75, s89, 393216
    s_or_b32 s75, s75, s79
    buffer_load_dwordx4 v[164:167], v11, s[36:39], s75 offen offset:0 sc1
    buffer_load_dwordx4 v[168:171], v12, s[36:39], s75 offen offset:0 sc1
    buffer_load_dwordx4 v[172:175], v11, s[36:39], s75 offen offset:1024 sc1
    buffer_load_dwordx4 v[176:179], v12, s[36:39], s75 offen offset:1024 sc1
    s_buffer_load_dwordx16 s[4:19], s[36:39], s96 offset:16384 glc
    ds_read_b64_tr_b16 v[244:245], v5 offset:32768
    ds_read_b64_tr_b16 v[246:247], v5 offset:40960
    ds_read_b64_tr_b16 v[248:249], v6 offset:32768
    ds_read_b64_tr_b16 v[250:251], v6 offset:40960
    s_waitcnt vmcnt(10) lgkmcnt(10)
    v_mfma_f32_32x32x16_bf16 v[36:51], v[228:231], v[116:119], v[36:51]
    s_waitcnt lgkmcnt(8)
    v_mfma_f32_32x32x16_bf16 v[52:67], v[232:235], v[116:119], v[52:67]
    v_mfma_f32_32x32x16_bf16 v[68:83], v[228:231], v[120:123], v[68:83]
    v_mfma_f32_32x32x16_bf16 v[84:99], v[232:235], v[120:123], v[84:99]
    ds_read_b64_tr_b16 v[196:197], v9 offset:0
    ds_read_b64_tr_b16 v[198:199], v7 offset:0
    ds_read_b64_tr_b16 v[200:201], v10 offset:0
    ds_read_b64_tr_b16 v[202:203], v8 offset:0
    s_waitcnt lgkmcnt(10)
    v_mfma_f32_32x32x16_bf16 v[36:51], v[236:239], v[124:127], v[36:51]
    s_waitcnt lgkmcnt(8)
    v_mfma_f32_32x32x16_bf16 v[52:67], v[240:243], v[124:127], v[52:67]
    v_mfma_f32_32x32x16_bf16 v[68:83], v[236:239], v[128:131], v[68:83]
    v_mfma_f32_32x32x16_bf16 v[84:99], v[240:243], v[128:131], v[84:99]
    s_cmp_eq_u32 s79, 0
    s_cbranch_scc0 Lcfix_113i
Lcok_112:
    s_buffer_load_dwordx4 s[20:23], s[36:39], s96 glc
    ds_read_b64_tr_b16 v[204:205], v7 offset:8192
    ds_read_b64_tr_b16 v[206:207], v5 offset:0
    ds_read_b64_tr_b16 v[208:209], v8 offset:8192
    ds_read_b64_tr_b16 v[210:211], v6 offset:0
    s_waitcnt vmcnt(4) lgkmcnt(10)
    v_mfma_f32_32x32x16_bf16 v[36:51], v[244:247], v[148:151], v[36:51]
    s_waitcnt lgkmcnt(8)
    v_mfma_f32_32x32x16_bf16 v[52:67], v[248:251], v[148:151], v[52:67]
    v_mfma_f32_32x32x16_bf16 v[68:83], v[244:247], v[152:155], v[68:83]
    v_mfma_f32_32x32x16_bf16 v[84:99], v[248:251], v[152:155], v[84:99]
    ds_read_b64_tr_b16 v[212:213], v5 offset:8192
    ds_read_b64_tr_b16 v[214:215], v7 offset:16384
    ds_read_b64_tr_b16 v[216:217], v6 offset:8192
    ds_read_b64_tr_b16 v[218:219], v8 offset:16384
    s_waitcnt lgkmcnt(10)
    v_mfma_f32_32x32x16_bf16 v[36:51], v[196:199], v[156:159], v[36:51]
    s_waitcnt lgkmcnt(8)
    v_mfma_f32_32x32x16_bf16 v[52:67], v[200:203], v[156:159], v[52:67]
    v_mfma_f32_32x32x16_bf16 v[68:83], v[196:199], v[160:163], v[68:83]
    v_mfma_f32_32x32x16_bf16 v[84:99], v[200:203], v[160:163], v[84:99]
    s_waitcnt lgkmcnt(0)
    s_cmp_eq_u64 s[20:21], s[94:95]
    s_cselect_b32 s80, 0, 0x40000000
    s_or_b32 s75, s90, s80
    buffer_load_dwordx4 v[180:183], v11, s[36:39], s75 offen offset:0 sc1
    buffer_load_dwordx4 v[184:187], v12, s[36:39], s75 offen offset:0 sc1
    buffer_load_dwordx4 v[188:191], v11, s[36:39], s75 offen offset:1024 sc1
    buffer_load_dwordx4 v[192:195], v12, s[36:39], s75 offen offset:1024 sc1
    s_buffer_load_dwordx4 s[20:23], s[36:39], s96 glc
    ds_read_b64_tr_b16 v[220:221], v7 offset:24576
    ds_read_b64_tr_b16 v[222:223], v9 offset:8192
    ds_read_b64_tr_b16 v[224:225], v8 offset:24576
    ds_read_b64_tr_b16 v[226:227], v10 offset:8192
    s_waitcnt vmcnt(4)
    v_mfma_f32_32x32x16_bf16 v[36:51], v[204:207], v[164:167], v[36:51]
    v_mfma_f32_32x32x16_bf16 v[52:67], v[208:211], v[164:167], v[52:67]
    v_mfma_f32_32x32x16_bf16 v[68:83], v[204:207], v[168:171], v[68:83]
    v_mfma_f32_32x32x16_bf16 v[84:99], v[208:211], v[168:171], v[84:99]
    ds_read_b64_tr_b16 v[228:229], v9 offset:16384
    ds_read_b64_tr_b16 v[230:231], v5 offset:49152
    ds_read_b64_tr_b16 v[232:233], v10 offset:16384
    ds_read_b64_tr_b16 v[234:235], v6 offset:49152
    v_mfma_f32_32x32x16_bf16 v[36:51], v[212:215], v[172:175], v[36:51]
    v_mfma_f32_32x32x16_bf16 v[52:67], v[216:219], v[172:175], v[52:67]
    v_mfma_f32_32x32x16_bf16 v[68:83], v[212:215], v[176:179], v[68:83]
    v_mfma_f32_32x32x16_bf16 v[84:99], v[216:219], v[176:179], v[84:99]
    s_cmp_eq_u32 s80, 0
    s_cbranch_scc0 Lcfix_115i
Lcok_114:
    s_cmp_eq_u64 s[22:23], s[94:95]
    s_cbranch_scc0 Lretry_117i
Lok_116:
    s_add_u32 s75, s90, 131072
    buffer_load_dwordx4 v[132:135], v11, s[36:39], s75 offen offset:0 sc1
    buffer_load_dwordx4 v[136:139], v12, s[36:39], s75 offen offset:0 sc1
    buffer_load_dwordx4 v[140:143], v11, s[36:39], s75 offen offset:1024 sc1
    buffer_load_dwordx4 v[144:147], v12, s[36:39], s75 offen offset:1024 sc1
    buffer_load_dword v18, v29, s[36:39], 0 offen sc1
    ds_read_b64_tr_b16 v[236:237], v5 offset:57344
    ds_read_b64_tr_b16 v[238:239], v9 offset:24576
    ds_read_b64_tr_b16 v[240:241], v6 offset:57344
    ds_read_b64_tr_b16 v[242:243], v10 offset:24576
    s_waitcnt vmcnt(5) lgkmcnt(10)
    v_mfma_f32_32x32x16_bf16 v[36:51], v[220:223], v[180:183], v[36:51]
    s_waitcnt lgkmcnt(8)
    v_mfma_f32_32x32x16_bf16 v[52:67], v[224:227], v[180:183], v[52:67]
    v_mfma_f32_32x32x16_bf16 v[68:83], v[220:223], v[184:187], v[68:83]
    v_mfma_f32_32x32x16_bf16 v[84:99], v[224:227], v[184:187], v[84:99]
    ds_read_b64_tr_b16 v[244:245], v7 offset:32768
    ds_read_b64_tr_b16 v[246:247], v5 offset:16384
    ds_read_b64_tr_b16 v[248:249], v8 offset:32768
    ds_read_b64_tr_b16 v[250:251], v6 offset:16384
    s_waitcnt lgkmcnt(10)
    v_mfma_f32_32x32x16_bf16 v[36:51], v[228:231], v[188:191], v[36:51]
    s_waitcnt lgkmcnt(8)
    v_mfma_f32_32x32x16_bf16 v[52:67], v[232:235], v[188:191], v[52:67]
    v_mfma_f32_32x32x16_bf16 v[68:83], v[228:231], v[192:195], v[68:83]
    v_mfma_f32_32x32x16_bf16 v[84:99], v[232:235], v[192:195], v[84:99]
    s_waitcnt vmcnt(4) lgkmcnt(4)
    v_mfma_f32_32x32x16_bf16 v[52:67], v[240:243], v[132:135], v[52:67]
    s_waitcnt vmcnt(2) lgkmcnt(0)
    v_mfma_f32_32x32x16_bf16 v[52:67], v[248:251], v[140:143], v[52:67]
    v_add_u32 v22, s71, v2
    v_add_u32 v23, 0x10000, v22
    s_lshl_b32 s74, s65, 10
    v_add_u32 v20, s74, v2
    v_xor_b32 v5, 0x0, v20
    v_mfma_f32_32x32x16_bf16 v[68:83], v[236:239], v[136:139], v[68:83]
    v_xor_b32 v6, 0x8400, v20
    v_xor_b32 v7, 0x10800, v20
    v_xor_b32 v8, 0x18c00, v20
    s_lshl_b32 s74, s69, 1
    s_lshr_b32 s75, s65, 1
    s_waitcnt vmcnt(1)
    v_mfma_f32_32x32x16_bf16 v[68:83], v[244:247], v[144:147], v[68:83]
    ds_write_b128 v22, v[52:55] offset:16384
    ds_write_b128 v22, v[56:59] offset:24576
    ds_write_b128 v22, v[60:63] offset:32768
    ds_write_b128 v22, v[64:67] offset:40960
    v_mfma_f32_32x32x16_bf16 v[84:99], v[240:243], v[136:139], v[84:99]
    s_add_u32 s74, s74, s75
    s_lshl_b32 s74, s74, 15
    s_lshl_b32 s75, s70, 7
    s_add_u32 s74, s74, s75
    s_and_b32 s75, s65, 1
    s_lshl_b32 s75, s75, 6
    v_mfma_f32_32x32x16_bf16 v[84:99], v[248:251], v[144:147], v[84:99]
    ds_write_b128 v22, v[68:71] offset:49152
    ds_write_b128 v22, v[72:75] offset:57344
    ds_write_b128 v23, v[76:79] offset:0
    ds_write_b128 v23, v[80:83] offset:8192
    v_mfma_f32_32x32x16_bf16 v[36:51], v[236:239], v[132:135], v[36:51]
    s_add_u32 s74, s74, s75
    v_lshrrev_b32 v11, 5, v1
    v_lshlrev_b32 v11, 4, v11
    v_and_b32 v21, 31, v1
    v_lshl_add_u32 v11, v21, 10, v11
    v_lshlrev_b32 v180, 16, v24
    v_mfma_f32_32x32x16_bf16 v[36:51], v[244:247], v[140:143], v[36:51]
LIGb_8:
    s_cmp_eq_u32 s63, 1
    s_cbranch_scc1 LIGb_ret
LJGb_3:
    s_cmp_eq_u32 s63, 2
    s_cbranch_scc1 LJGb_7
    ds_write_b128 v23, v[84:87] offset:16384
    ds_write_b128 v23, v[88:91] offset:24576
    ds_write_b128 v23, v[92:95] offset:32768
    ds_write_b128 v23, v[96:99] offset:40960
    v_and_b32 v181, 0xffff0000, v24
    v_lshlrev_b32 v182, 16, v25
    v_and_b32 v183, 0xffff0000, v25
    v_lshlrev_b32 v184, 16, v26
    v_and_b32 v185, 0xffff0000, v26
    v_lshlrev_b32 v186, 16, v27
    v_and_b32 v187, 0xffff0000, v27
    s_nop 0
    ds_write_b128 v22, v[36:39] offset:0
    s_waitcnt lgkmcnt(12)
    ds_write_b128 v22, v[40:43] offset:8192
    v_pk_add_f32 v[44:45], v[44:45], v[180:181]
    v_pk_add_f32 v[46:47], v[46:47], v[182:183]
    v_pk_add_f32 v[48:49], v[48:49], v[184:185]
    v_pk_add_f32 v[50:51], v[50:51], v[186:187]
    s_waitcnt lgkmcnt(0)
    s_barrier
    ds_read_b128 v[100:103], v5 offset:0
    ds_read_b128 v[108:111], v6 offset:0
    ds_read_b128 v[116:119], v7 offset:0
    ds_read_b128 v[124:127], v8 offset:0
    ds_read_b128 v[132:135], v6 offset:4096
    ds_read_b128 v[140:143], v7 offset:4096
    ds_read_b128 v[148:151], v8 offset:4096
    ds_read_b128 v[104:107], v5 offset:8192
    ds_read_b128 v[112:115], v6 offset:8192
    ds_read_b128 v[120:123], v7 offset:8192
    ds_read_b128 v[128:131], v8 offset:8192
    ds_read_b128 v[136:139], v6 offset:12288
    ds_read_b128 v[144:147], v7 offset:12288
    s_waitcnt lgkmcnt(12)
    ds_read_b128 v[152:155], v8 offset:12288
    s_waitcnt vmcnt(0)
    v_add_f32 v18, 1.0, v18
    v_rcp_f32 v18, v18
    s_nop 0
    v_mov_b32 v19, v18
    v_pk_add_f32 v[44:45], v[44:45], v[100:101]
    v_pk_add_f32 v[46:47], v[46:47], v[102:103]
    s_waitcnt lgkmcnt(12)
    v_pk_add_f32 v[44:45], v[44:45], v[108:109]
    v_pk_add_f32 v[46:47], v[46:47], v[110:111]
    s_waitcnt lgkmcnt(11)
    v_pk_add_f32 v[44:45], v[44:45], v[116:117]
    v_pk_add_f32 v[46:47], v[46:47], v[118:119]
    s_waitcnt lgkmcnt(10)
    v_pk_add_f32 v[44:45], v[44:45], v[124:125]
    v_pk_add_f32 v[46:47], v[46:47], v[126:127]
    s_waitcnt lgkmcnt(9)
    v_pk_add_f32 v[44:45], v[44:45], v[132:133]
    v_pk_add_f32 v[46:47], v[46:47], v[134:135]
    s_waitcnt lgkmcnt(8)
    v_pk_add_f32 v[44:45], v[44:45], v[140:141]
    v_pk_add_f32 v[46:47], v[46:47], v[142:143]
    s_waitcnt lgkmcnt(7)
    v_pk_add_f32 v[44:45], v[44:45], v[148:149]
    v_pk_add_f32 v[46:47], v[46:47], v[150:151]
    v_pk_mul_f32 v[44:45], v[44:45], v[18:19]
    v_pk_mul_f32 v[46:47], v[46:47], v[18:19]
    v_cvt_pk_bf16_f32 v164, v44, v45
    v_cvt_pk_bf16_f32 v165, v46, v47
    s_waitcnt lgkmcnt(6)
    v_pk_add_f32 v[48:49], v[48:49], v[104:105]
    v_pk_add_f32 v[50:51], v[50:51], v[106:107]
    s_waitcnt lgkmcnt(5)
    v_pk_add_f32 v[48:49], v[48:49], v[112:113]
    v_pk_add_f32 v[50:51], v[50:51], v[114:115]
    s_waitcnt lgkmcnt(4)
    v_pk_add_f32 v[48:49], v[48:49], v[120:121]
    v_pk_add_f32 v[50:51], v[50:51], v[122:123]
    s_waitcnt lgkmcnt(3)
    v_pk_add_f32 v[48:49], v[48:49], v[128:129]
    v_pk_add_f32 v[50:51], v[50:51], v[130:131]
    s_waitcnt lgkmcnt(2)
    v_pk_add_f32 v[48:49], v[48:49], v[136:137]
    v_pk_add_f32 v[50:51], v[50:51], v[138:139]
    s_waitcnt lgkmcnt(1)
    v_pk_add_f32 v[48:49], v[48:49], v[144:145]
    v_pk_add_f32 v[50:51], v[50:51], v[146:147]
    s_waitcnt lgkmcnt(0)
    v_pk_add_f32 v[48:49], v[48:49], v[152:153]
    v_pk_add_f32 v[50:51], v[50:51], v[154:155]
    v_pk_mul_f32 v[48:49], v[48:49], v[18:19]
    v_pk_mul_f32 v[50:51], v[50:51], v[18:19]
    v_cvt_pk_bf16_f32 v166, v48, v49
    v_cvt_pk_bf16_f32 v167, v50, v51
    s_nop 0
    v_permlane32_swap_b32 v164, v166
    v_permlane32_swap_b32 v165, v167
    buffer_store_dwordx4 v[164:167], v11, s[32:35], s74 offen offset:32
    s_endpgm
Lretry_103i:
    s_mov_b32 s0, 20000
Lretry_103:
    s_sub_u32 s0, s0, 1
    s_cbranch_scc1 Lok_102
    s_sleep 1
    s_buffer_load_dword s94, s[24:27], 0 glc
Lretry_103w:
    s_waitcnt lgkmcnt(0)
    s_cmp_lg_u32 s94, 0
    s_cbranch_scc0 Lretry_103
    s_branch Lok_102
Lcfix_105i:
    s_mov_b32 s0, 20000
    s_branch Lcfix_105w
Lcfix_105:
    s_sub_u32 s0, s0, 1
    s_cbranch_scc1 Lcfix_105g
    s_sleep 1
    s_buffer_load_dwordx16 s[4:19], s[36:39], s96 offset:16384 glc
Lcfix_105w:
    s_waitcnt lgkmcnt(0)
    s_cmp_eq_u64 s[4:5], s[94:95]
    s_cbranch_scc0 Lcfix_105
Lcfix_105g:
    buffer_load_dwordx4 v[132:135], v11, s[36:39], s89 offen offset:0 sc1
    buffer_load_dwordx4 v[136:139], v12, s[36:39], s89 offen offset:0 sc1
    buffer_load_dwordx4 v[140:143], v11, s[36:39], s89 offen offset:1024 sc1
    buffer_load_dwordx4 v[144:147], v12, s[36:39], s89 offen offset:1024 sc1
    s_branch Lcok_104
Lcfix_107i:
    s_mov_b32 s0, 20000
    s_branch Lcfix_107w
Lcfix_107:
    s_sub_u32 s0, s0, 1
    s_cbranch_scc1 Lcfix_107g
    s_sleep 1
    s_buffer_load_dwordx16 s[4:19], s[36:39], s96 offset:16384 glc
Lcfix_107w:
    s_waitcnt lgkmcnt(0)
    s_cmp_eq_u64 s[8:9], s[94:95]
    s_cbranch_scc0 Lcfix_107
Lcfix_107g:
    s_add_u32 s75, s89, 262144
    buffer_load_dwordx4 v[100:103], v11, s[36:39], s75 offen offset:0 sc1
    buffer_load_dwordx4 v[104:107], v12, s[36:39], s75 offen offset:0 sc1
    buffer_load_dwordx4 v[108:111], v11, s[36:39], s75 offen offset:1024 sc1
    buffer_load_dwordx4 v[112:115], v12, s[36:39], s75 offen offset:1024 sc1
    s_branch Lcok_106
Lcfix_109i:
    s_mov_b32 s0, 20000
    s_branch Lcfix_109w
Lcfix_109:
    s_sub_u32 s0, s0, 1
    s_cbranch_scc1 Lcfix_109g
    s_sleep 1
    s_buffer_load_dwordx16 s[4:19], s[36:39], s96 offset:16384 glc
Lcfix_109w:
    s_waitcnt lgkmcnt(0)
    s_cmp_eq_u64 s[12:13], s[94:95]
    s_cbranch_scc0 Lcfix_109
Lcfix_109g:
    s_add_u32 s75, s89, 524288
    buffer_load_dwordx4 v[116:119], v11, s[36:39], s75 offen offset:0 sc1
    buffer_load_dwordx4 v[120:123], v12, s[36:39], s75 offen offset:0 sc1
    buffer_load_dwordx4 v[124:127], v11, s[36:39], s75 offen offset:1024 sc1
    buffer_load_dwordx4 v[128:131], v12, s[36:39], s75 offen offset:1024 sc1
    s_branch Lcok_108
Lcfix_111i:
    s_mov_b32 s0, 20000
    s_branch Lcfix_111w
Lcfix_111:
    s_sub_u32 s0, s0, 1
    s_cbranch_scc1 Lcfix_111g
    s_sleep 1
    s_buffer_load_dwordx16 s[4:19], s[36:39], s96 offset:16384 glc
Lcfix_111w:
    s_waitcnt lgkmcnt(0)
    s_cmp_eq_u64 s[6:7], s[94:95]
    s_cbranch_scc0 Lcfix_111
Lcfix_111g:
    s_add_u32 s75, s89, 131072
    buffer_load_dwordx4 v[148:151], v11, s[36:39], s75 offen offset:0 sc1
    buffer_load_dwordx4 v[152:155], v12, s[36:39], s75 offen offset:0 sc1
    buffer_load_dwordx4 v[156:159], v11, s[36:39], s75 offen offset:1024 sc1
    buffer_load_dwordx4 v[160:163], v12, s[36:39], s75 offen offset:1024 sc1
    s_branch Lcok_110
Lcfix_113i:
    s_mov_b32 s0, 20000
    s_branch Lcfix_113w
Lcfix_113:
LIGb_9:
    s_cmp_eq_u32 s63, 1
    s_cbranch_scc1 LIGb_ret
LJGb_4:
    s_cmp_eq_u32 s63, 2
    s_cbranch_scc1 LJGb_8
    s_sub_u32 s0, s0, 1
    s_cbranch_scc1 Lcfix_113g
    s_sleep 1
    s_buffer_load_dwordx16 s[4:19], s[36:39], s96 offset:16384 glc
Lcfix_113w:
    s_waitcnt lgkmcnt(0)
    s_cmp_eq_u64 s[10:11], s[94:95]
    s_cbranch_scc0 Lcfix_113
Lcfix_113g:
    s_add_u32 s75, s89, 393216
    buffer_load_dwordx4 v[164:167], v11, s[36:39], s75 offen offset:0 sc1
    buffer_load_dwordx4 v[168:171], v12, s[36:39], s75 offen offset:0 sc1
    buffer_load_dwordx4 v[172:175], v11, s[36:39], s75 offen offset:1024 sc1
    buffer_load_dwordx4 v[176:179], v12, s[36:39], s75 offen offset:1024 sc1
    s_branch Lcok_112
Lcfix_115i:
    s_mov_b32 s0, 20000
    s_branch Lcfix_115w
Lcfix_115:
    s_sub_u32 s0, s0, 1
    s_cbranch_scc1 Lcfix_115g
    s_sleep 1
    s_buffer_load_dwordx4 s[20:23], s[36:39], s96 glc
Lcfix_115w:
    s_waitcnt lgkmcnt(0)
    s_cmp_eq_u64 s[20:21], s[94:95]
    s_cbranch_scc0 Lcfix_115
Lcfix_115g:
    buffer_load_dwordx4 v[180:183], v11, s[36:39], s90 offen offset:0 sc1
    buffer_load_dwordx4 v[184:187], v12, s[36:39], s90 offen offset:0 sc1
    buffer_load_dwordx4 v[188:191], v11, s[36:39], s90 offen offset:1024 sc1
    buffer_load_dwordx4 v[192:195], v12, s[36:39], s90 offen offset:1024 sc1
    s_branch Lcok_114
Lretry_117i:
    s_mov_b32 s0, 20000
    s_branch Lretry_117w
Lretry_117:
    s_sub_u32 s0, s0, 1
    s_cbranch_scc1 Lok_116
    s_sleep 1
    s_buffer_load_dwordx4 s[20:23], s[36:39], s96 glc
Lretry_117w:
    s_waitcnt lgkmcnt(0)
    s_cmp_eq_u64 s[22:23], s[94:95]
    s_cbranch_scc0 Lretry_117
    s_branch Lok_116
L_end:
    s_endpgm
.section .rodata,"a"
.p2align 6
.amdhsa_kernel gated_mix__linear_attn_block__dense_activation_gelu__prompt_kernel
  .amdhsa_next_free_vgpr 256
  .amdhsa_next_free_sgpr 102
  .amdhsa_accum_offset 256
  .amdhsa_group_segment_fixed_size 0
  .amdhsa_kernarg_size 96
  .amdhsa_user_sgpr_count 2
  .amdhsa_user_sgpr_kernarg_segment_ptr 1
  .amdhsa_system_sgpr_workgroup_id_x 1
.end_amdhsa_kernel
```
